```python
import torch

def _softmax(x, axis=-1):
    return torch.softmax(x, dim=axis)

def _gelu(x):
    return torch.nn.functional.gelu(x, approximate='tanh')

def _silu(x):
    return torch.nn.functional.silu(x)

def _sigmoid(x):
    return torch.sigmoid(x)

def _layernorm(x, axis=-1, eps=1e-05):
    m = x.mean(dim=axis, keepdim=True)
    v = x.var(dim=axis, keepdim=True, unbiased=False)
    return (x - m) / torch.sqrt(v + eps)

def _scatter_add(tgt, idx, src, axis=0):
    return tgt.clone().index_add_(axis, idx, src)

def _segment_sum(src, seg, n):
    out = torch.zeros((n,) + src.shape[1:], dtype=src.dtype)
    return out.index_add_(0, seg, src)

def _pad(x, pw):
    flat = tuple((v for pair in reversed(pw) for v in pair))
    return torch.nn.functional.pad(x, flat)
kernel_name = 'sequential_preLN__memory_aug_recurrent_mem_tr__mixer_s_mlp__prompt'

def setup_inputs():

    _w = lambda a: (lambda t: t.to(torch.bfloat16) if t.is_floating_point() else t)(torch.as_tensor(a))

    def _A_setup():
        B, S, Dm = (1, 2048, 640)
        H, Dh = (32, 192)
        M, seg = (8, 32)
        seg = min(seg, S)
        S = S // seg * seg
        return {'x': _w((lambda *s: torch.randn(*s, dtype=torch.bfloat16) * 0.05)(B, S, Dm)), 'mem0': _w((lambda *s: torch.randn(*s, dtype=torch.bfloat16) * 0.2)(B, M, Dm)), 'Wq': _w((lambda *s: torch.randn(*s, dtype=torch.bfloat16) * 1.6)(Dm, H, Dh) * Dm ** (-0.5)), 'Wk': _w((lambda *s: torch.randn(*s, dtype=torch.bfloat16) * 1.6)(Dm, H, Dh) * Dm ** (-0.5)), 'Wv': _w((lambda *s: torch.randn(*s, dtype=torch.bfloat16) * 0.2)(Dm, H, Dh) * Dm ** (-0.5)), 'Wo': _w((lambda *s: torch.randn(*s, dtype=torch.bfloat16) * 0.2)(H, Dh, Dm) * (H * Dh) ** (-0.5)), 'seg_len': seg}
    _A_in = _A_setup()

    def _B_setup():
        B, S, D, F = (1, 2048, 640, 1536)
        return {'x': _w((lambda *s: torch.randn(*s, dtype=torch.bfloat16) * 0.05)(B, S, D)), 'w1': _w((lambda *s: torch.randn(*s, dtype=torch.bfloat16) * 0.8)(D, D) * D ** (-0.5)), 'w2': _w((lambda *s: torch.randn(*s, dtype=torch.bfloat16) * 0.8)(D, D) * D ** (-0.5)), 'w3': _w((lambda *s: torch.randn(*s, dtype=torch.bfloat16) * 0.8)(D, F) * D ** (-0.5)), 'w4': _w((lambda *s: torch.randn(*s, dtype=torch.bfloat16) * 0.8)(F, D) * F ** (-0.5))}
    _B_in = _B_setup()
    return {'A_x': _A_in['x'], 'A_mem0': _A_in['mem0'], 'A_Wq': _A_in['Wq'], 'A_Wk': _A_in['Wk'], 'A_Wv': _A_in['Wv'], 'A_Wo': _A_in['Wo'], 'A_seg_len': _A_in['seg_len'], 'B_x': _B_in['x'], 'B_w1': _B_in['w1'], 'B_w2': _B_in['w2'], 'B_w3': _B_in['w3'], 'B_w4': _B_in['w4']}

def reference(A_x, A_mem0, A_Wq, A_Wk, A_Wv, A_Wo, A_seg_len, B_x, B_w1, B_w2, B_w3, B_w4):

    def _A_ref(x, mem0, Wq, Wk, Wv, Wo, seg_len):
        B, S, Dm = x.shape
        H, Dh = (Wq.shape[1], Wq.shape[2])
        M = mem0.shape[1]
        scale = Dh ** (-0.5)
        n_seg = S // seg_len
        L = M + seg_len
        idx = torch.arange(L)
        mask = (idx[:, None] < M) | (idx[:, None] >= idx[None, :])
        mem = mem0
        outs = []
        for s in range(n_seg):
            xs = x[:, s * seg_len:(s + 1) * seg_len, :].clone()
            h = torch.concatenate([mem, xs], axis=1)
            q = torch.einsum('btd,dhe->bhte', h, Wq)
            k = torch.einsum('btd,dhe->bhte', h, Wk)
            v = torch.einsum('btd,dhe->bhte', h, Wv)
            scores = torch.einsum('bhqe,bhke->bhqk', q, k) * scale
            scores = torch.where(mask[None, None], scores, -1000000000.0)
            p = _softmax(scores, axis=-1)
            o = torch.einsum('bhqk,bhke->bhqe', p, v)
            o = torch.einsum('bhte,hed->btd', o, Wo)
            mem = o[:, :M, :].clone()
            outs.append(o[:, M:, :])
        return torch.concatenate(outs, axis=1)

    def _B_ref(x, w1, w2, w3, w4):
        B, S, D = x.shape
        h = _gelu(_layernorm(x, axis=-1) @ w1)
        c = D // 4
        g0 = _pad(h[:, :, 0 * c:1 * c], ((0, 0), (1, 0), (0, 0)))[:, :S, :]
        g1 = _pad(h[:, :, 1 * c:2 * c], ((0, 0), (0, 1), (0, 0)))[:, 1:, :]
        g2 = _pad(h[:, :, 2 * c:3 * c], ((0, 0), (2, 0), (0, 0)))[:, :S, :]
        g3 = _pad(h[:, :, 3 * c:], ((0, 0), (0, 2), (0, 0)))[:, 2:, :]
        hs = torch.concatenate([g0, g1, g2, g3], axis=-1) @ w2
        x1 = x + hs
        h2 = _gelu(_layernorm(x1, axis=-1) @ w3) @ w4
        return x1 + h2
    x = A_x
    h = x + _A_ref(_layernorm(x, axis=-1), A_mem0, A_Wq, A_Wk, A_Wv, A_Wo, A_seg_len)
    h2 = h + _B_ref(_layernorm(h, axis=-1), B_w1, B_w2, B_w3, B_w4)
    return h2
```

```asm
; @launch grid=(256,1,1) block=(512,1,1) lds=163840
.amdgcn_target "amdgcn-amd-amdhsa--gfx950"
.text
.globl sequential_preLN__memory_aug_recurrent_mem_tr__mixer_s_mlp__prompt_kernel
.p2align 8
.type sequential_preLN__memory_aug_recurrent_mem_tr__mixer_s_mlp__prompt_kernel,@function
sequential_preLN__memory_aug_recurrent_mem_tr__mixer_s_mlp__prompt_kernel:
    s_cmp_ge_u32 s2, 256
    s_cbranch_scc1 L_end
    s_load_dwordx16 s[32:47], s[0:1], 0
    s_load_dwordx8 s[48:55], s[0:1], 64
    s_load_dwordx4 s[56:59], s[0:1], 96
    s_load_dwordx2 s[60:61], s[0:1], 112
    v_and_b32 v1, 63, v0
    v_lshrrev_b32 v3, 6, v0
    v_lshlrev_b32 v2, 4, v1
    v_readfirstlane_b32 s24, v3
    s_mov_b32 s25, 0
    s_mov_b32 s89, 0
    s_mov_b32 s91, 0
    s_mov_b32 s62, 0
    s_and_b32 s26, s2, 3
    s_lshr_b32 s27, s2, 3
    s_lshl_b32 s27, s27, 2
    s_add_u32 s3, s26, s27
    s_and_b32 s26, s2, 4
    s_lshl_b32 s26, s26, 5
    s_add_u32 s3, s3, s26
    s_waitcnt lgkmcnt(0)
    s_mov_b32 s4, s60
    s_and_b32 s5, s61, 0xffff
    s_mov_b32 s6, 0x10000000
    s_mov_b32 s7, 0x20000
    s_mov_b32 s16, s58
    s_and_b32 s17, s59, 0xffff
    s_mov_b32 s18, 0x100
    s_mov_b32 s19, 0x20000
    s_mov_b32 s20, s32
    s_and_b32 s21, s33, 0xffff
    s_mov_b32 s22, 0x280000
    s_mov_b32 s23, 0x20000
    s_cmp_lt_u32 s3, 32
    s_cbranch_scc1 nostart_1
    s_sub_u32 s64, s3, 32
    s_cmp_lt_u32 s3, 72
    s_cbranch_scc1 strep_2_go
    s_cmp_lt_u32 s3, 104
    s_cbranch_scc1 nostart_1
    s_sub_u32 s64, s3, 64
    s_cmp_lt_u32 s3, 128
    s_cbranch_scc1 strep_2_go
    s_cmp_lt_u32 s3, 192
    s_cbranch_scc1 nostart_1
    s_sub_u32 s64, s3, 128
strep_2_go:
strep_2:
    s_lshl_b32 s26, s64, 3
    s_add_u32 s26, s26, s24
    s_mul_i32 s26, s26, 1280
    buffer_load_dwordx4 v[12:15], v2, s[20:23], s26 offen
    v_mov_b32 v16, 0
    v_mov_b32 v17, 0
    v_mov_b32 v18, 0
    v_mov_b32 v19, 0
    s_mov_b64 exec, 0xffff
    buffer_load_dwordx4 v[16:19], v2, s[20:23], s26 offen offset:1024
    s_mov_b64 exec, -1
    v_mov_b32 v40, -1
    v_mov_b32 v44, 0
    v_mov_b32 v41, -1
    v_mov_b32 v45, 0
    v_mov_b32 v42, -1
    v_mov_b32 v46, 0
    v_mov_b32 v43, -1
    v_mov_b32 v47, 0
    v_lshlrev_b32 v3, 4, v0
    s_lshl_b32 s27, s64, 13
    s_add_u32 s27, s27, 0xe000000
    buffer_store_dwordx4 v[40:43], v3, s[4:7], s27 offen sc1
    s_lshl_b32 s27, s64, 13
    s_add_u32 s27, s27, 0x4800000
    buffer_store_dwordx4 v[40:43], v3, s[4:7], s27 offen sc1
    s_add_u32 s27, s27, 2097152
    buffer_store_dwordx4 v[40:43], v3, s[4:7], s27 offen sc1
    s_lshl_b32 s27, s64, 9
    s_mov_b32 exec_lo, 0xffffffff
    s_mov_b32 exec_hi, 0x0
    buffer_store_dwordx4 v[44:47], v2, s[4:7], s27 offen sc1
    s_mov_b64 exec, -1
    s_waitcnt vmcnt(4)
    v_lshlrev_b32 v20, 16, v12
    v_and_b32 v21, 0xffff0000, v12
    v_lshlrev_b32 v22, 16, v13
    v_and_b32 v23, 0xffff0000, v13
    v_lshlrev_b32 v24, 16, v14
    v_and_b32 v25, 0xffff0000, v14
    v_lshlrev_b32 v26, 16, v15
    v_and_b32 v27, 0xffff0000, v15
    v_lshlrev_b32 v28, 16, v16
    v_and_b32 v29, 0xffff0000, v16
    v_lshlrev_b32 v30, 16, v17
    v_and_b32 v31, 0xffff0000, v17
    v_lshlrev_b32 v32, 16, v18
    v_and_b32 v33, 0xffff0000, v18
    v_lshlrev_b32 v34, 16, v19
    v_and_b32 v35, 0xffff0000, v19
    v_add_f32 v36, v20, v21
    v_add_f32 v36, v36, v22
    v_add_f32 v36, v36, v23
    v_add_f32 v36, v36, v24
    v_add_f32 v36, v36, v25
    v_add_f32 v36, v36, v26
    v_add_f32 v36, v36, v27
    v_add_f32 v36, v36, v28
    v_add_f32 v36, v36, v29
    v_add_f32 v36, v36, v30
    v_add_f32 v36, v36, v31
    v_add_f32 v36, v36, v32
    v_add_f32 v36, v36, v33
    v_add_f32 v36, v36, v34
    v_add_f32 v36, v36, v35
    s_nop 1
    v_add_f32_dpp v36, v36, v36 row_ror:8 row_mask:0xf bank_mask:0xf
    s_nop 1
    v_add_f32_dpp v36, v36, v36 row_ror:4 row_mask:0xf bank_mask:0xf
    s_nop 1
    v_add_f32_dpp v36, v36, v36 row_ror:2 row_mask:0xf bank_mask:0xf
    s_nop 1
    v_add_f32_dpp v36, v36, v36 row_ror:1 row_mask:0xf bank_mask:0xf
    v_mov_b32 v37, v36
    s_nop 1
    v_permlane16_swap_b32 v36, v37
    v_add_f32 v36, v36, v37
    v_mov_b32 v37, v36
    s_nop 1
    v_permlane32_swap_b32 v36, v37
    v_add_f32 v36, v36, v37
    v_mul_f32 v36, 0x3acccccd, v36
    v_sub_f32 v20, v20, v36
    v_sub_f32 v21, v21, v36
    v_sub_f32 v22, v22, v36
    v_sub_f32 v23, v23, v36
    v_sub_f32 v24, v24, v36
    v_sub_f32 v25, v25, v36
    v_sub_f32 v26, v26, v36
    v_sub_f32 v27, v27, v36
    v_sub_f32 v28, v28, v36
    v_sub_f32 v29, v29, v36
    v_sub_f32 v30, v30, v36
    v_sub_f32 v31, v31, v36
    v_sub_f32 v32, v32, v36
    v_sub_f32 v33, v33, v36
    v_sub_f32 v34, v34, v36
    v_sub_f32 v35, v35, v36
    v_mul_f32 v38, v20, v20
    v_fmac_f32 v38, v21, v21
    v_fmac_f32 v38, v22, v22
    v_fmac_f32 v38, v23, v23
    v_fmac_f32 v38, v24, v24
    v_fmac_f32 v38, v25, v25
    v_fmac_f32 v38, v26, v26
    v_fmac_f32 v38, v27, v27
    s_mov_b64 exec, 0xffff
    v_fmac_f32 v38, v28, v28
    v_fmac_f32 v38, v29, v29
    v_fmac_f32 v38, v30, v30
    v_fmac_f32 v38, v31, v31
    v_fmac_f32 v38, v32, v32
    v_fmac_f32 v38, v33, v33
    v_fmac_f32 v38, v34, v34
    v_fmac_f32 v38, v35, v35
    s_mov_b64 exec, -1
    s_nop 0
    v_add_f32_dpp v38, v38, v38 row_ror:8 row_mask:0xf bank_mask:0xf
    s_nop 1
    v_add_f32_dpp v38, v38, v38 row_ror:4 row_mask:0xf bank_mask:0xf
    s_nop 1
    v_add_f32_dpp v38, v38, v38 row_ror:2 row_mask:0xf bank_mask:0xf
    s_nop 1
    v_add_f32_dpp v38, v38, v38 row_ror:1 row_mask:0xf bank_mask:0xf
    v_mov_b32 v37, v38
    s_nop 1
    v_permlane16_swap_b32 v38, v37
    v_add_f32 v38, v38, v37
    v_mov_b32 v37, v38
    s_nop 1
    v_permlane32_swap_b32 v38, v37
    v_add_f32 v38, v38, v37
    v_mov_b32 v37, 0x3727c5ac
    v_fmac_f32 v37, 0x3acccccd, v38
    v_rsq_f32 v37, v37
    s_nop 0
    v_mul_f32 v20, v20, v37
    v_mul_f32 v21, v21, v37
    v_mul_f32 v22, v22, v37
    v_mul_f32 v23, v23, v37
    v_mul_f32 v24, v24, v37
    v_mul_f32 v25, v25, v37
    v_mul_f32 v26, v26, v37
    v_mul_f32 v27, v27, v37
    v_mul_f32 v28, v28, v37
    v_mul_f32 v29, v29, v37
    v_mul_f32 v30, v30, v37
    v_mul_f32 v31, v31, v37
    v_mul_f32 v32, v32, v37
    v_mul_f32 v33, v33, v37
    v_mul_f32 v34, v34, v37
    v_mul_f32 v35, v35, v37
    v_cvt_pk_bf16_f32 v12, v20, v21
    v_cvt_pk_bf16_f32 v13, v22, v23
    v_cvt_pk_bf16_f32 v14, v24, v25
    v_cvt_pk_bf16_f32 v15, v26, v27
    v_cvt_pk_bf16_f32 v16, v28, v29
    v_cvt_pk_bf16_f32 v17, v30, v31
    v_cvt_pk_bf16_f32 v18, v32, v33
    v_cvt_pk_bf16_f32 v19, v34, v35
    s_lshl_b32 s26, s24, 4
    v_lshlrev_b32 v4, 7, v1
    v_add_u32 v4, s26, v4
    ds_write_b128 v4, v[12:15]
    s_mov_b64 exec, 0xffff
    ds_write_b128 v4, v[16:19] offset:8192
    s_mov_b64 exec, -1
    s_waitcnt lgkmcnt(0)
    s_barrier
    ds_read_b128 v[12:15], v3
    ds_read_b128 v[16:19], v3 offset:8192
    v_lshrrev_b32 v4, 3, v0
    v_lshlrev_b32 v4, 8, v4
    v_and_b32 v5, 7, v0
    v_lshl_add_u32 v4, v5, 4, v4
    s_lshr_b32 s26, s64, 1
    s_mul_i32 s26, s26, 20480
    s_and_b32 s27, s64, 1
    s_lshl_b32 s27, s27, 7
    s_add_u32 s26, s26, s27
    s_add_u32 s26, s26, 0x600000
    s_waitcnt lgkmcnt(0)
    buffer_store_dwordx4 v[12:15], v4, s[4:7], s26 offen sc1
    s_cmp_ge_u32 s24, 2
    s_cbranch_scc1 skip2_3
    s_add_u32 s26, s26, 16384
    buffer_store_dwordx4 v[16:19], v4, s[4:7], s26 offen sc1
    s_nop 1
skip2_3:
    s_barrier
    s_add_u32 s64, s64, 128
    s_cmp_lt_u32 s64, 256
    s_cbranch_scc1 strep_2
    s_waitcnt vmcnt(0)
    s_barrier
    s_cmp_lg_u32 s24, 0
    s_cbranch_scc1 noarr_4
    s_and_b32 s26, s64, 3
    s_lshl_b32 s26, s26, 6
    v_mov_b32 v3, 1
    v_mov_b32 v4, 0
    s_mov_b64 exec, 1
    buffer_atomic_add v3, v4, s[16:19], s26 offen sc1
    s_mov_b64 exec, -1
    s_nop 1
noarr_4:
nostart_1:
    s_cmp_lt_u32 s3, 192
    s_cbranch_scc1 i2_5
    s_cmp_lg_u32 s24, 0
    s_cbranch_scc1 wst_7
    v_and_b32 v5, 3, v1
    v_lshlrev_b32 v5, 6, v5
    s_mov_b32 s100, 0
    s_nop 3
poll_8:
    buffer_load_dword v6, v5, s[16:19], 0 offen sc1
    s_waitcnt vmcnt(0)
    v_cmp_gt_u32 vcc, 32, v6
    s_nop 3
    s_cbranch_vccz polld_9
    s_cmp_lg_u32 s25, 0
    s_cbranch_scc1 polld_9
    s_add_u32 s100, s100, 1
    s_cmp_lt_u32 s100, 400000
    s_sleep 8
    s_cbranch_scc1 poll_8
    s_mov_b32 s25, 1
    s_lshl_b32 s100, s3, 16
    s_lshl_b32 s101, s62, 8
    s_or_b32 s100, s100, s101
    s_or_b32 s100, s100, 1
    v_mov_b32 v3, s100
    v_mov_b32 v4, 36
    buffer_store_dword v3, v4, s[16:19], 0 offen sc1
    s_nop 3
polld_9:
wst_7:
    s_barrier
    v_mov_b32 v5, 8
    s_mov_b32 s100, 0
    s_nop 3
poll_10:
    buffer_load_dword v6, v5, s[16:19], 0 offen sc1
    s_waitcnt vmcnt(0)
    v_cmp_gt_u32 vcc, 64, v6
    s_nop 3
    s_cbranch_vccz polld_11
    s_cmp_lg_u32 s25, 0
    s_cbranch_scc1 polld_11
    s_add_u32 s100, s100, 1
    s_cmp_lt_u32 s100, 400000
    s_sleep 8
    s_cbranch_scc1 poll_10
    s_mov_b32 s25, 1
    s_lshl_b32 s100, s3, 16
    s_lshl_b32 s101, s62, 8
    s_or_b32 s100, s100, s101
    s_or_b32 s100, s100, 2
    v_mov_b32 v3, s100
    v_mov_b32 v4, 40
    buffer_store_dword v3, v4, s[16:19], 0 offen sc1
    s_nop 3
polld_11:
    v_readfirstlane_b32 s26, v6
    s_and_b32 s88, s26, 1
    s_xor_b32 s89, s88, 1
    s_lshl_b32 s89, s89, 13
    s_xor_b32 s91, s89, 8192
    s_mov_b32 s90, 0
    s_cmp_lg_u32 s24, 0
    s_cbranch_scc1 du_12
    v_mov_b32 v5, 4160
    s_mov_b32 s100, 0
    s_nop 3
poll_13:
    buffer_load_dword v6, v5, s[4:7], s89 offen sc1
    s_waitcnt vmcnt(0)
    v_cmp_gt_u32 vcc, 1, v6
    s_nop 3
    s_cbranch_vccz polld_14
    s_cmp_lg_u32 s25, 0
    s_cbranch_scc1 polld_14
    s_add_u32 s100, s100, 1
    s_cmp_lt_u32 s100, 400000
    s_sleep 20
    s_cbranch_scc1 poll_13
    s_mov_b32 s25, 1
    s_lshl_b32 s100, s3, 16
    s_lshl_b32 s101, s62, 8
    s_or_b32 s100, s100, s101
    s_or_b32 s100, s100, 4
    v_mov_b32 v3, s100
    v_mov_b32 v4, 48
    buffer_store_dword v3, v4, s[16:19], 0 offen sc1
    s_nop 3
polld_14:
du_12:
    s_barrier
i2_5:
    s_cmp_lg_u32 s3, 127
    s_cbranch_scc1 L_nomeas
    s_cmp_lg_u32 s24, 0
    s_cbranch_scc1 L_end
    s_mov_b32 s27, 0x200000
    v_lshrrev_b32 v3, 1, v1
    v_mul_u32_u24 v3, 16640, v3
    v_and_b32 v4, 1, v1
    v_lshl_add_u32 v3, v4, 13, v3
    buffer_store_dwordx4 v[40:43], v3, s[4:7], s27 offen offset:0 sc1
    buffer_store_dwordx4 v[40:43], v3, s[4:7], s27 offen offset:16 sc1
    buffer_store_dwordx4 v[40:43], v3, s[4:7], s27 offen offset:32 sc1
    buffer_store_dwordx4 v[40:43], v3, s[4:7], s27 offen offset:48 sc1
    buffer_store_dwordx4 v[40:43], v3, s[4:7], s27 offen offset:64 sc1
    buffer_store_dwordx4 v[40:43], v3, s[4:7], s27 offen offset:80 sc1
    buffer_store_dwordx4 v[40:43], v3, s[4:7], s27 offen offset:96 sc1
    buffer_store_dwordx4 v[40:43], v3, s[4:7], s27 offen offset:112 sc1
    s_waitcnt vmcnt(0)
    s_nop 0
    v_mov_b32 v3, 0
    s_mov_b32 s28, -1
    s_mov_b32 s29, -1
    s_mov_b32 s30, 0
    s_nop 1
mpl_15:
    s_add_u32 s26, s27, 0
    s_memtime s[92:93]
    s_waitcnt lgkmcnt(0)
    buffer_load_dword v4, v3, s[4:7], s26 offen sc1
    s_waitcnt vmcnt(0)
    s_memtime s[94:95]
    s_waitcnt lgkmcnt(0)
    s_sub_u32 s92, s94, s92
    s_cmp_lt_u32 s92, 345
    s_cselect_b32 s92, -1, s92
    s_min_u32 s28, s28, s92
    s_add_u32 s26, s27, 8192
    s_memtime s[92:93]
    s_waitcnt lgkmcnt(0)
    buffer_load_dword v4, v3, s[4:7], s26 offen sc1
    s_waitcnt vmcnt(0)
    s_memtime s[94:95]
    s_waitcnt lgkmcnt(0)
    s_sub_u32 s92, s94, s92
    s_cmp_lt_u32 s92, 345
    s_cselect_b32 s92, -1, s92
    s_min_u32 s29, s29, s92
    s_add_u32 s27, s27, 16640
    s_add_u32 s30, s30, 1
    s_cmp_lt_u32 s30, 10
    s_cbranch_scc1 mpl_15
    s_cmp_lt_u32 s29, s28
    s_cselect_b32 s26, 64, 65
    v_mov_b32 v4, s26
    v_mov_b32 v6, s28
    v_mov_b32 v7, s29
    s_mov_b64 exec, 1
    buffer_store_dword v4, v3, s[16:19], 0 offen offset:8 sc1
    buffer_store_dwordx2 v[6:7], v3, s[16:19], 0 offen offset:16
    s_mov_b64 exec, -1
    s_endpgm
L_nomeas:
    s_mov_b32 s87, 0
    s_cmp_lt_u32 s3, 32
    s_cbranch_scc1 R_S
    s_cmp_lt_u32 s3, 72
    s_cbranch_scc1 R_V
    s_sub_u32 s63, s3, 72
    s_cmp_lt_u32 s3, 104
    s_cbranch_scc1 R_YM
    s_sub_u32 s63, s3, 104
    s_cmp_lt_u32 s3, 124
    s_cbranch_scc1 R_M
    s_cmp_lt_u32 s3, 128
    s_cbranch_scc1 L_end
    s_sub_u32 s63, s3, 128
    s_cmp_lt_u32 s3, 160
    s_cbranch_scc1 R_K
    s_sub_u32 s63, s3, 160
    s_cmp_lt_u32 s3, 192
    s_cbranch_scc1 R_VP
    s_sub_u32 s63, s3, 192
    s_cmp_lt_u32 s3, 224
    s_cbranch_scc1 R_Q
    s_sub_u32 s63, s3, 224
    s_cmp_lt_u32 s3, 244
    s_cbranch_scc1 R_PY
    s_sub_u32 s63, s3, 224
    s_branch R_M
R_S:
    s_mov_b32 s63, s3
    s_lshl_b32 s68, s63, 7
    s_add_u32 s68, s68, 0
    s_mov_b32 s8, s36
    s_and_b32 s9, s37, 0xffff
    s_mov_b32 s10, 0x780000
    s_mov_b32 s11, 0x20000
    s_mov_b32 s12, s38
    s_and_b32 s13, s39, 0xffff
    s_mov_b32 s14, 0x780000
    s_mov_b32 s15, 0x20000
    s_mul_i32 s64, s63, 384
    s_and_b32 s26, s24, 3
    s_mul_i32 s26, s26, 96
    s_lshr_b32 s27, s24, 2
    s_mul_i32 s27, s27, 39936
    s_add_u32 s29, s26, s27
    v_lshrrev_b32 v3, 4, v1
    v_lshlrev_b32 v3, 3, v3
    v_bfe_u32 v4, v1, 2, 2
    v_add_u32 v3, v3, v4
    v_mul_u32_u24 v3, 416, v3
    v_and_b32 v4, 3, v1
    v_lshl_add_u32 v3, v4, 3, v3
    v_add_u32 v13, s29, v3
    s_mov_b32 s26, s24
    s_add_u32 s28, s64, 0
    s_nop 2
stg_16:
    s_min_u32 s27, s26, 38
    s_lshl_b32 s27, s27, 6
    v_add_u32 v10, s27, v1
    s_lshl_b32 s27, s27, 4
    v_mul_u32_u24 v11, 40330, v10
    v_lshrrev_b32 v11, 20, v11
    v_mul_u32_u24 v12, 26, v11
    v_sub_u32 v12, v10, v12
    v_min_u32 v12, 23, v12
    v_mul_u32_u24 v11, 12288, v11
    s_add_u32 m0, s27, 0
    v_lshl_add_u32 v11, v12, 4, v11
    s_add_u32 s26, s26, 8
    buffer_load_dwordx4 v11, s[8:11], s28 offen lds
    s_cmp_lt_u32 s26, 40
    s_nop 0
    s_cbranch_scc1 stg_16
    s_mov_b32 s26, s24
    s_add_u32 s28, s64, 0
stg_17:
    s_min_u32 s27, s26, 38
    s_lshl_b32 s27, s27, 6
    v_add_u32 v10, s27, v1
    s_lshl_b32 s27, s27, 4
    v_mul_u32_u24 v11, 40330, v10
    v_lshrrev_b32 v11, 20, v11
    v_mul_u32_u24 v12, 26, v11
    v_sub_u32 v12, v10, v12
    v_min_u32 v12, 23, v12
    v_mul_u32_u24 v11, 12288, v11
    s_add_u32 m0, s27, 39936
    v_lshl_add_u32 v11, v12, 4, v11
    s_add_u32 s26, s26, 8
    buffer_load_dwordx4 v11, s[12:15], s28 offen lds
    s_cmp_lt_u32 s26, 40
    s_nop 0
    s_cbranch_scc1 stg_17
    s_mov_b32 s26, s24
    s_add_u32 s28, s64, 1179648
stg_18:
    s_min_u32 s27, s26, 38
    s_lshl_b32 s27, s27, 6
    v_add_u32 v10, s27, v1
    s_lshl_b32 s27, s27, 4
    v_mul_u32_u24 v11, 40330, v10
    v_lshrrev_b32 v11, 20, v11
    v_mul_u32_u24 v12, 26, v11
    v_sub_u32 v12, v10, v12
    v_min_u32 v12, 23, v12
    v_mul_u32_u24 v11, 12288, v11
    s_add_u32 m0, s27, 81920
    v_lshl_add_u32 v11, v12, 4, v11
    s_add_u32 s26, s26, 8
    buffer_load_dwordx4 v11, s[8:11], s28 offen lds
    s_cmp_lt_u32 s26, 40
    s_nop 0
    s_cbranch_scc1 stg_18
    s_mov_b32 s26, s24
    s_add_u32 s28, s64, 1179648
stg_19:
    s_min_u32 s27, s26, 38
    s_lshl_b32 s27, s27, 6
    v_add_u32 v10, s27, v1
    s_lshl_b32 s27, s27, 4
    v_mul_u32_u24 v11, 40330, v10
    v_lshrrev_b32 v11, 20, v11
    v_mul_u32_u24 v12, 26, v11
    v_sub_u32 v12, v10, v12
    v_min_u32 v12, 23, v12
    v_mul_u32_u24 v11, 12288, v11
    s_add_u32 m0, s27, 121856
    v_lshl_add_u32 v11, v12, 4, v11
    s_add_u32 s26, s26, 8
    buffer_load_dwordx4 v11, s[12:15], s28 offen lds
    s_cmp_lt_u32 s26, 40
    s_nop 0
    s_cbranch_scc1 stg_19
    s_waitcnt vmcnt(10)
    s_barrier
    v_add_u32 v14, 0, v13
    ds_read_b64_tr_b16 a[0:1], v14 offset:0
    ds_read_b64_tr_b16 a[2:3], v14 offset:1664
    ds_read_b64_tr_b16 a[8:9], v14 offset:32
    ds_read_b64_tr_b16 a[10:11], v14 offset:1696
    ds_read_b64_tr_b16 a[16:17], v14 offset:64
    ds_read_b64_tr_b16 a[18:19], v14 offset:1728
    ds_read_b64_tr_b16 a[4:5], v14 offset:13312
    ds_read_b64_tr_b16 a[6:7], v14 offset:14976
    ds_read_b64_tr_b16 a[12:13], v14 offset:13344
    ds_read_b64_tr_b16 a[14:15], v14 offset:15008
    ds_read_b64_tr_b16 a[20:21], v14 offset:13376
    ds_read_b64_tr_b16 a[22:23], v14 offset:15040
    ds_read_b64_tr_b16 a[24:25], v14 offset:26624
    ds_read_b64_tr_b16 a[26:27], v14 offset:28288
    ds_read_b64_tr_b16 a[32:33], v14 offset:26656
    ds_read_b64_tr_b16 a[34:35], v14 offset:28320
    ds_read_b64_tr_b16 a[40:41], v14 offset:26688
    ds_read_b64_tr_b16 a[42:43], v14 offset:28352
    s_waitcnt lgkmcnt(0)
    s_barrier
    s_mov_b32 s26, s24
    s_add_u32 s28, s64, 2359296
stg_20:
    s_min_u32 s27, s26, 38
    s_lshl_b32 s27, s27, 6
    v_add_u32 v10, s27, v1
    s_lshl_b32 s27, s27, 4
    v_mul_u32_u24 v11, 40330, v10
    v_lshrrev_b32 v11, 20, v11
    v_mul_u32_u24 v12, 26, v11
    v_sub_u32 v12, v10, v12
    v_min_u32 v12, 23, v12
    v_mul_u32_u24 v11, 12288, v11
    s_add_u32 m0, s27, 0
    v_lshl_add_u32 v11, v12, 4, v11
    s_add_u32 s26, s26, 8
    buffer_load_dwordx4 v11, s[8:11], s28 offen lds
    s_cmp_lt_u32 s26, 40
    s_nop 0
    s_cbranch_scc1 stg_20
    s_mov_b32 s26, s24
    s_add_u32 s28, s64, 2359296
stg_21:
    s_min_u32 s27, s26, 38
    s_lshl_b32 s27, s27, 6
    v_add_u32 v10, s27, v1
    s_lshl_b32 s27, s27, 4
    v_mul_u32_u24 v11, 40330, v10
    v_lshrrev_b32 v11, 20, v11
    v_mul_u32_u24 v12, 26, v11
    v_sub_u32 v12, v10, v12
    v_min_u32 v12, 23, v12
    v_mul_u32_u24 v11, 12288, v11
    s_add_u32 m0, s27, 39936
    v_lshl_add_u32 v11, v12, 4, v11
    s_add_u32 s26, s26, 8
    buffer_load_dwordx4 v11, s[12:15], s28 offen lds
    s_cmp_lt_u32 s26, 40
    s_nop 0
    s_cbranch_scc1 stg_21
    s_waitcnt vmcnt(10)
    s_barrier
    v_add_u32 v14, 81920, v13
    ds_read_b64_tr_b16 a[28:29], v14 offset:0
    ds_read_b64_tr_b16 a[30:31], v14 offset:1664
    ds_read_b64_tr_b16 a[36:37], v14 offset:32
    ds_read_b64_tr_b16 a[38:39], v14 offset:1696
    ds_read_b64_tr_b16 a[44:45], v14 offset:64
    ds_read_b64_tr_b16 a[46:47], v14 offset:1728
    ds_read_b64_tr_b16 a[48:49], v14 offset:13312
    ds_read_b64_tr_b16 a[50:51], v14 offset:14976
    ds_read_b64_tr_b16 a[56:57], v14 offset:13344
    ds_read_b64_tr_b16 a[58:59], v14 offset:15008
    ds_read_b64_tr_b16 a[64:65], v14 offset:13376
    ds_read_b64_tr_b16 a[66:67], v14 offset:15040
    ds_read_b64_tr_b16 a[52:53], v14 offset:26624
    ds_read_b64_tr_b16 a[54:55], v14 offset:28288
    ds_read_b64_tr_b16 a[60:61], v14 offset:26656
    ds_read_b64_tr_b16 a[62:63], v14 offset:28320
    ds_read_b64_tr_b16 a[68:69], v14 offset:26688
    ds_read_b64_tr_b16 a[70:71], v14 offset:28352
    s_waitcnt lgkmcnt(0)
    s_barrier
    s_mov_b32 s26, s24
    s_add_u32 s28, s64, 3538944
stg_22:
    s_min_u32 s27, s26, 38
    s_lshl_b32 s27, s27, 6
    v_add_u32 v10, s27, v1
    s_lshl_b32 s27, s27, 4
    v_mul_u32_u24 v11, 40330, v10
    v_lshrrev_b32 v11, 20, v11
    v_mul_u32_u24 v12, 26, v11
    v_sub_u32 v12, v10, v12
    v_min_u32 v12, 23, v12
    v_mul_u32_u24 v11, 12288, v11
    s_add_u32 m0, s27, 81920
    v_lshl_add_u32 v11, v12, 4, v11
    s_add_u32 s26, s26, 8
    buffer_load_dwordx4 v11, s[8:11], s28 offen lds
    s_cmp_lt_u32 s26, 40
    s_nop 0
    s_cbranch_scc1 stg_22
    s_mov_b32 s26, s24
    s_add_u32 s28, s64, 3538944
stg_23:
    s_min_u32 s27, s26, 38
    s_lshl_b32 s27, s27, 6
    v_add_u32 v10, s27, v1
    s_lshl_b32 s27, s27, 4
    v_mul_u32_u24 v11, 40330, v10
    v_lshrrev_b32 v11, 20, v11
    v_mul_u32_u24 v12, 26, v11
    v_sub_u32 v12, v10, v12
    v_min_u32 v12, 23, v12
    v_mul_u32_u24 v11, 12288, v11
    s_add_u32 m0, s27, 121856
    v_lshl_add_u32 v11, v12, 4, v11
    s_add_u32 s26, s26, 8
    buffer_load_dwordx4 v11, s[12:15], s28 offen lds
    s_cmp_lt_u32 s26, 40
    s_nop 0
    s_cbranch_scc1 stg_23
    s_waitcnt vmcnt(10)
    s_barrier
    v_add_u32 v14, 0, v13
    ds_read_b64_tr_b16 a[72:73], v14 offset:0
    ds_read_b64_tr_b16 a[74:75], v14 offset:1664
    ds_read_b64_tr_b16 a[80:81], v14 offset:32
    ds_read_b64_tr_b16 a[82:83], v14 offset:1696
    ds_read_b64_tr_b16 a[88:89], v14 offset:64
    ds_read_b64_tr_b16 a[90:91], v14 offset:1728
    ds_read_b64_tr_b16 a[76:77], v14 offset:13312
    ds_read_b64_tr_b16 a[78:79], v14 offset:14976
    ds_read_b64_tr_b16 a[84:85], v14 offset:13344
    ds_read_b64_tr_b16 a[86:87], v14 offset:15008
    ds_read_b64_tr_b16 a[92:93], v14 offset:13376
    ds_read_b64_tr_b16 a[94:95], v14 offset:15040
    ds_read_b64_tr_b16 a[96:97], v14 offset:26624
    ds_read_b64_tr_b16 a[98:99], v14 offset:28288
    ds_read_b64_tr_b16 a[104:105], v14 offset:26656
    ds_read_b64_tr_b16 a[106:107], v14 offset:28320
    ds_read_b64_tr_b16 a[112:113], v14 offset:26688
    ds_read_b64_tr_b16 a[114:115], v14 offset:28352
    s_waitcnt lgkmcnt(0)
    s_barrier
    s_mov_b32 s26, s24
    s_add_u32 s28, s64, 4718592
stg_24:
    s_min_u32 s27, s26, 38
    s_lshl_b32 s27, s27, 6
    v_add_u32 v10, s27, v1
    s_lshl_b32 s27, s27, 4
    v_mul_u32_u24 v11, 40330, v10
    v_lshrrev_b32 v11, 20, v11
    v_mul_u32_u24 v12, 26, v11
    v_sub_u32 v12, v10, v12
    v_min_u32 v12, 23, v12
    v_mul_u32_u24 v11, 12288, v11
    s_add_u32 m0, s27, 0
    v_lshl_add_u32 v11, v12, 4, v11
    s_add_u32 s26, s26, 8
    buffer_load_dwordx4 v11, s[8:11], s28 offen lds
    s_cmp_lt_u32 s26, 40
    s_nop 0
    s_cbranch_scc1 stg_24
    s_mov_b32 s26, s24
    s_add_u32 s28, s64, 4718592
stg_25:
    s_min_u32 s27, s26, 38
    s_lshl_b32 s27, s27, 6
    v_add_u32 v10, s27, v1
    s_lshl_b32 s27, s27, 4
    v_mul_u32_u24 v11, 40330, v10
    v_lshrrev_b32 v11, 20, v11
    v_mul_u32_u24 v12, 26, v11
    v_sub_u32 v12, v10, v12
    v_min_u32 v12, 23, v12
    v_mul_u32_u24 v11, 12288, v11
    s_add_u32 m0, s27, 39936
    v_lshl_add_u32 v11, v12, 4, v11
    s_add_u32 s26, s26, 8
    buffer_load_dwordx4 v11, s[12:15], s28 offen lds
    s_cmp_lt_u32 s26, 40
    s_nop 0
    s_cbranch_scc1 stg_25
    s_waitcnt vmcnt(10)
    s_barrier
    v_add_u32 v14, 81920, v13
    ds_read_b64_tr_b16 a[100:101], v14 offset:0
    ds_read_b64_tr_b16 a[102:103], v14 offset:1664
    ds_read_b64_tr_b16 a[108:109], v14 offset:32
    ds_read_b64_tr_b16 a[110:111], v14 offset:1696
    ds_read_b64_tr_b16 a[116:117], v14 offset:64
    ds_read_b64_tr_b16 a[118:119], v14 offset:1728
    ds_read_b64_tr_b16 a[120:121], v14 offset:13312
    ds_read_b64_tr_b16 a[122:123], v14 offset:14976
    ds_read_b64_tr_b16 a[128:129], v14 offset:13344
    ds_read_b64_tr_b16 a[130:131], v14 offset:15008
    ds_read_b64_tr_b16 a[136:137], v14 offset:13376
    ds_read_b64_tr_b16 a[138:139], v14 offset:15040
    ds_read_b64_tr_b16 a[124:125], v14 offset:26624
    ds_read_b64_tr_b16 a[126:127], v14 offset:28288
    ds_read_b64_tr_b16 a[132:133], v14 offset:26656
    ds_read_b64_tr_b16 a[134:135], v14 offset:28320
    ds_read_b64_tr_b16 a[140:141], v14 offset:26688
    ds_read_b64_tr_b16 a[142:143], v14 offset:28352
    s_waitcnt lgkmcnt(0)
    s_barrier
    s_mov_b32 s26, s24
    s_add_u32 s28, s64, 5898240
stg_26:
    s_min_u32 s27, s26, 38
    s_lshl_b32 s27, s27, 6
    v_add_u32 v10, s27, v1
    s_lshl_b32 s27, s27, 4
    v_mul_u32_u24 v11, 40330, v10
    v_lshrrev_b32 v11, 20, v11
    v_mul_u32_u24 v12, 26, v11
    v_sub_u32 v12, v10, v12
    v_min_u32 v12, 23, v12
    v_mul_u32_u24 v11, 12288, v11
    s_add_u32 m0, s27, 81920
    v_lshl_add_u32 v11, v12, 4, v11
    s_add_u32 s26, s26, 8
    buffer_load_dwordx4 v11, s[8:11], s28 offen lds
    s_cmp_lt_u32 s26, 40
    s_nop 0
    s_cbranch_scc1 stg_26
    s_mov_b32 s26, s24
    s_add_u32 s28, s64, 5898240
stg_27:
    s_min_u32 s27, s26, 38
    s_lshl_b32 s27, s27, 6
    v_add_u32 v10, s27, v1
    s_lshl_b32 s27, s27, 4
    v_mul_u32_u24 v11, 40330, v10
    v_lshrrev_b32 v11, 20, v11
    v_mul_u32_u24 v12, 26, v11
    v_sub_u32 v12, v10, v12
    v_min_u32 v12, 23, v12
    v_mul_u32_u24 v11, 12288, v11
    s_add_u32 m0, s27, 121856
    v_lshl_add_u32 v11, v12, 4, v11
    s_add_u32 s26, s26, 8
    buffer_load_dwordx4 v11, s[12:15], s28 offen lds
    s_cmp_lt_u32 s26, 40
    s_nop 0
    s_cbranch_scc1 stg_27
    s_waitcnt vmcnt(10)
    s_barrier
    v_add_u32 v14, 0, v13
    ds_read_b64_tr_b16 a[144:145], v14 offset:0
    ds_read_b64_tr_b16 a[146:147], v14 offset:1664
    ds_read_b64_tr_b16 a[152:153], v14 offset:32
    ds_read_b64_tr_b16 a[154:155], v14 offset:1696
    ds_read_b64_tr_b16 v[72:73], v14 offset:64
    ds_read_b64_tr_b16 v[74:75], v14 offset:1728
    ds_read_b64_tr_b16 a[148:149], v14 offset:13312
    ds_read_b64_tr_b16 a[150:151], v14 offset:14976
    ds_read_b64_tr_b16 a[156:157], v14 offset:13344
    ds_read_b64_tr_b16 a[158:159], v14 offset:15008
    ds_read_b64_tr_b16 v[76:77], v14 offset:13376
    ds_read_b64_tr_b16 v[78:79], v14 offset:15040
    ds_read_b64_tr_b16 v[80:81], v14 offset:26624
    ds_read_b64_tr_b16 v[82:83], v14 offset:28288
    ds_read_b64_tr_b16 v[88:89], v14 offset:26656
    ds_read_b64_tr_b16 v[90:91], v14 offset:28320
    ds_read_b64_tr_b16 v[16:17], v14 offset:26688
    ds_read_b64_tr_b16 v[18:19], v14 offset:28352
    s_waitcnt lgkmcnt(0)
    s_barrier
    s_mov_b32 s26, s24
    s_add_u32 s28, s64, 7077888
stg_28:
    s_min_u32 s27, s26, 25
    s_lshl_b32 s27, s27, 6
    v_add_u32 v10, s27, v1
    s_lshl_b32 s27, s27, 4
    v_mul_u32_u24 v11, 40330, v10
    v_lshrrev_b32 v11, 20, v11
    v_mul_u32_u24 v12, 26, v11
    v_sub_u32 v12, v10, v12
    v_min_u32 v12, 23, v12
    v_mul_u32_u24 v11, 12288, v11
    s_add_u32 m0, s27, 0
    v_lshl_add_u32 v11, v12, 4, v11
    s_add_u32 s26, s26, 8
    buffer_load_dwordx4 v11, s[8:11], s28 offen lds
    s_cmp_lt_u32 s26, 32
    s_nop 0
    s_cbranch_scc1 stg_28
    s_mov_b32 s26, s24
    s_add_u32 s28, s64, 7077888
stg_29:
    s_min_u32 s27, s26, 25
    s_lshl_b32 s27, s27, 6
    v_add_u32 v10, s27, v1
    s_lshl_b32 s27, s27, 4
    v_mul_u32_u24 v11, 40330, v10
    v_lshrrev_b32 v11, 20, v11
    v_mul_u32_u24 v12, 26, v11
    v_sub_u32 v12, v10, v12
    v_min_u32 v12, 23, v12
    v_mul_u32_u24 v11, 12288, v11
    s_add_u32 m0, s27, 39936
    v_lshl_add_u32 v11, v12, 4, v11
    s_add_u32 s26, s26, 8
    buffer_load_dwordx4 v11, s[12:15], s28 offen lds
    s_cmp_lt_u32 s26, 32
    s_nop 0
    s_cbranch_scc1 stg_29
    s_cmp_lg_u32 s24, 0
    s_cbranch_scc1 wst_30
    v_and_b32 v5, 3, v1
    v_lshlrev_b32 v5, 6, v5
    s_mov_b32 s100, 0
    s_nop 3
poll_31:
    buffer_load_dword v6, v5, s[16:19], 0 offen sc1
    s_waitcnt vmcnt(0)
    v_cmp_gt_u32 vcc, 32, v6
    s_nop 3
    s_cbranch_vccz polld_32
    s_cmp_lg_u32 s25, 0
    s_cbranch_scc1 polld_32
    s_add_u32 s100, s100, 1
    s_cmp_lt_u32 s100, 400000
    s_sleep 8
    s_cbranch_scc1 poll_31
    s_mov_b32 s25, 1
    s_lshl_b32 s100, s3, 16
    s_lshl_b32 s101, s62, 8
    s_or_b32 s100, s100, s101
    s_or_b32 s100, s100, 1
    v_mov_b32 v3, s100
    v_mov_b32 v4, 36
    buffer_store_dword v3, v4, s[16:19], 0 offen sc1
    s_nop 3
polld_32:
wst_30:
    s_barrier
    v_mov_b32 v5, 8
    s_mov_b32 s100, 0
    s_nop 3
poll_33:
    buffer_load_dword v6, v5, s[16:19], 0 offen sc1
    s_waitcnt vmcnt(0)
    v_cmp_gt_u32 vcc, 64, v6
    s_nop 3
    s_cbranch_vccz polld_34
    s_cmp_lg_u32 s25, 0
    s_cbranch_scc1 polld_34
    s_add_u32 s100, s100, 1
    s_cmp_lt_u32 s100, 400000
    s_sleep 8
    s_cbranch_scc1 poll_33
    s_mov_b32 s25, 1
    s_lshl_b32 s100, s3, 16
    s_lshl_b32 s101, s62, 8
    s_or_b32 s100, s100, s101
    s_or_b32 s100, s100, 2
    v_mov_b32 v3, s100
    v_mov_b32 v4, 40
    buffer_store_dword v3, v4, s[16:19], 0 offen sc1
    s_nop 3
polld_34:
    v_readfirstlane_b32 s26, v6
    s_and_b32 s88, s26, 1
    s_xor_b32 s89, s88, 1
    s_lshl_b32 s89, s89, 13
    s_xor_b32 s91, s89, 8192
    s_mov_b32 s90, 0
    s_waitcnt vmcnt(8)
    s_barrier
    v_add_u32 v14, 81920, v13
    ds_read_b64_tr_b16 v[84:85], v14 offset:0
    ds_read_b64_tr_b16 v[86:87], v14 offset:1664
    ds_read_b64_tr_b16 v[92:93], v14 offset:32
    ds_read_b64_tr_b16 v[94:95], v14 offset:1696
    ds_read_b64_tr_b16 v[20:21], v14 offset:64
    ds_read_b64_tr_b16 v[22:23], v14 offset:1728
    ds_read_b64_tr_b16 v[24:25], v14 offset:13312
    ds_read_b64_tr_b16 v[26:27], v14 offset:14976
    ds_read_b64_tr_b16 v[32:33], v14 offset:13344
    ds_read_b64_tr_b16 v[34:35], v14 offset:15008
    ds_read_b64_tr_b16 v[40:41], v14 offset:13376
    ds_read_b64_tr_b16 v[42:43], v14 offset:15040
    ds_read_b64_tr_b16 v[28:29], v14 offset:26624
    ds_read_b64_tr_b16 v[30:31], v14 offset:28288
    ds_read_b64_tr_b16 v[36:37], v14 offset:26656
    ds_read_b64_tr_b16 v[38:39], v14 offset:28320
    ds_read_b64_tr_b16 v[44:45], v14 offset:26688
    ds_read_b64_tr_b16 v[46:47], v14 offset:28352
    s_waitcnt lgkmcnt(0)
    s_barrier
    s_waitcnt vmcnt(0)
    s_barrier
    v_add_u32 v14, 0, v13
    ds_read_b64_tr_b16 v[48:49], v14 offset:0
    ds_read_b64_tr_b16 v[50:51], v14 offset:1664
    ds_read_b64_tr_b16 v[56:57], v14 offset:32
    ds_read_b64_tr_b16 v[58:59], v14 offset:1696
    ds_read_b64_tr_b16 v[64:65], v14 offset:64
    ds_read_b64_tr_b16 v[66:67], v14 offset:1728
    ds_read_b64_tr_b16 v[52:53], v14 offset:13312
    ds_read_b64_tr_b16 v[54:55], v14 offset:14976
    ds_read_b64_tr_b16 v[60:61], v14 offset:13344
    ds_read_b64_tr_b16 v[62:63], v14 offset:15008
    ds_read_b64_tr_b16 v[68:69], v14 offset:13376
    ds_read_b64_tr_b16 v[70:71], v14 offset:15040
    s_waitcnt lgkmcnt(0)
    s_barrier
    s_mul_i32 s26, s24, 14336
    v_add_u32 v3, s26, v2
    ds_write_b128 v3, v[16:19] offset:0
    ds_write_b128 v3, v[20:23] offset:1024
    ds_write_b128 v3, v[24:27] offset:2048
    ds_write_b128 v3, v[28:31] offset:3072
    ds_write_b128 v3, v[32:35] offset:4096
    ds_write_b128 v3, v[36:39] offset:5120
    ds_write_b128 v3, v[40:43] offset:6144
    ds_write_b128 v3, v[44:47] offset:7168
    ds_write_b128 v3, v[48:51] offset:8192
    ds_write_b128 v3, v[52:55] offset:9216
    ds_write_b128 v3, v[56:59] offset:10240
    ds_write_b128 v3, v[60:63] offset:11264
    ds_write_b128 v3, v[64:67] offset:12288
    ds_write_b128 v3, v[68:71] offset:13312
    s_waitcnt lgkmcnt(0)
    v_mov_b32 v68, v3
    v_and_b32 v3, 48, v1
    v_bfe_u32 v4, v1, 1, 2
    v_lshl_add_u32 v3, v4, 2, v3
    v_bfe_u32 v4, v1, 3, 1
    v_lshl_add_u32 v3, v4, 1, v3
    v_and_b32 v4, 1, v1
    v_add_u32 v3, v3, v4
    v_lshlrev_b32 v10, 4, v3
    v_add_u32 v10, 114688, v10
    v_bfe_u32 v5, v1, 1, 1
    v_mov_b32 v3, 0x4444
    v_mov_b32 v4, 0xeeee
    v_cmp_eq_u32 vcc, 1, v5
    s_nop 1
    v_cndmask_b32 v11, v3, v4, vcc
    v_add_u32 v9, 114688, v2
    v_and_b32 v3, 15, v1
    v_lshrrev_b32 v4, 4, v1
    v_lshlrev_b32 v3, 4, v3
    v_lshl_add_u32 v3, v4, 2, v3
    s_and_b32 s26, s24, 3
    s_mul_i32 s26, s26, 768
    s_lshr_b32 s27, s24, 2
    s_mul_i32 s27, s27, 3072
    s_add_u32 s26, s26, s27
    s_add_u32 s26, s26, 124928
    v_add_u32 v69, s26, v3
    v_lshrrev_b32 v3, 2, v1
    v_lshlrev_b32 v3, 4, v3
    v_and_b32 v4, 1, v1
    v_lshl_add_u32 v3, v4, 3, v3
    v_add_u32 v70, 124928, v3
    s_lshl_b32 s26, s63, 7
    s_add_u32 s26, s26, 65536
    v_mov_b32 v71, s26
    v_mov_b32 v3, 131072
    v_mov_b32 v4, 0
    ds_write_b32 v3, v4
    s_mov_b32 s85, 0
    s_mov_b32 s86, 60
    s_mov_b32 s87, 192
    s_mov_b32 s65, 0
    s_mov_b32 s69, 0xe000000
    s_mov_b32 s70, 0x3dd53b95
    s_mov_b32 s71, 0
    s_mov_b32 s72, 0
    s_mov_b32 s84, 0
    s_lshr_b32 s26, s63, 1
    s_lshr_b32 s27, s26, 3
    s_lshl_b32 s27, s27, 14
    s_and_b32 s26, s26, 7
    s_lshl_b32 s26, s26, 10
    s_add_u32 s74, s26, s27
    s_and_b32 s26, s63, 1
    s_lshl_b32 s26, s26, 7
    s_add_u32 s74, s74, s26
    s_add_u32 s74, s74, 32768
    s_lshr_b32 s75, s63, 3
    s_lshl_b32 s75, s75, 10
    s_and_b32 s26, s63, 3
    s_lshl_b32 s26, s26, 8
    s_add_u32 s75, s75, s26
    s_and_b32 s26, s63, 4
    s_lshl_b32 s26, s26, 5
    s_add_u32 s75, s75, s26
    s_add_u32 s75, s75, 20480
    s_and_b32 s26, s24, 3
    s_mul_i32 s26, s26, 3
    s_add_u32 s27, s26, 0
    s_min_u32 s27, s27, 9
    s_lshl_b32 s80, s27, 10
    s_lshr_b32 s27, s27, 3
    s_lshl_b32 s27, s27, 13
    s_add_u32 s77, s80, s27
    s_add_u32 s27, s26, 1
    s_min_u32 s27, s27, 9
    s_lshl_b32 s81, s27, 10
    s_lshr_b32 s27, s27, 3
    s_lshl_b32 s27, s27, 13
    s_add_u32 s78, s81, s27
    s_add_u32 s27, s26, 2
    s_min_u32 s27, s27, 9
    s_lshl_b32 s82, s27, 10
    s_lshr_b32 s27, s27, 3
    s_lshl_b32 s27, s27, 13
    s_add_u32 s79, s82, s27
    s_waitcnt lgkmcnt(0)
    s_barrier
    s_cmp_lg_u32 s24, 3
    s_cbranch_scc1 sk0_35
    s_add_u32 s73, s62, 1
    s_cmp_ge_u32 s84, s73
    s_cbranch_scc1 pc_36
    s_mov_b32 s100, 0
poll_37:
    buffer_load_dword v6, v71, s[4:7], 0 offen sc1
    s_waitcnt vmcnt(0)
    v_cmp_gt_u32 vcc, s73, v6
    s_nop 3
    s_cbranch_vccz polld_38
    s_cmp_lg_u32 s25, 0
    s_cbranch_scc1 polld_38
    s_add_u32 s100, s100, 1
    s_cmp_lt_u32 s100, 400000
    s_sleep 2
    s_cbranch_scc1 poll_37
    s_mov_b32 s25, 1
    s_lshl_b32 s100, s3, 16
    s_lshl_b32 s101, s62, 8
    s_or_b32 s100, s100, s101
    s_or_b32 s100, s100, 4
    v_mov_b32 v3, s100
    v_mov_b32 v4, 48
    buffer_store_dword v3, v4, s[16:19], 0 offen sc1
    s_nop 3
polld_38:
    v_readfirstlane_b32 s84, v6
    s_nop 4
pc_36:
    s_lshl_b32 s27, s62, 5
    s_add_u32 s27, s27, s63
    s_mul_i32 s27, s27, 12288
    s_add_u32 s27, s27, 0x3000000
    s_add_u32 m0, s71, 132096
    s_nop 0
    buffer_load_dwordx4 v2, s[4:7], s27 offen offset:0 sc1 lds
    buffer_load_dwordx4 v2, s[4:7], s27 offen offset:1024 sc1 lds
    buffer_load_dwordx4 v2, s[4:7], s27 offen offset:2048 sc1 lds
    buffer_load_dwordx4 v2, s[4:7], s27 offen offset:3072 sc1 lds
    s_add_u32 m0, s71, 136192
    s_add_u32 s27, s27, 4096
    buffer_load_dwordx4 v2, s[4:7], s27 offen offset:0 sc1 lds
    buffer_load_dwordx4 v2, s[4:7], s27 offen offset:1024 sc1 lds
    buffer_load_dwordx4 v2, s[4:7], s27 offen offset:2048 sc1 lds
    buffer_load_dwordx4 v2, s[4:7], s27 offen offset:3072 sc1 lds
    s_add_u32 m0, s71, 140288
    s_add_u32 s27, s27, 4096
    buffer_load_dwordx4 v2, s[4:7], s27 offen offset:0 sc1 lds
    buffer_load_dwordx4 v2, s[4:7], s27 offen offset:1024 sc1 lds
    buffer_load_dwordx4 v2, s[4:7], s27 offen offset:2048 sc1 lds
    buffer_load_dwordx4 v2, s[4:7], s27 offen offset:3072 sc1 lds
    s_waitcnt vmcnt(0)
sk0_35:
    s_mov_b32 s76, s69
S_loop:
    s_mov_b32 s83, s76
    s_add_u32 s76, s62, 0
    s_lshr_b32 s76, s76, 3
    s_xor_b32 s76, s76, s88
    s_and_b32 s76, s76, 1
    s_lshl_b32 s76, s76, 13
    s_add_u32 s76, s76, s69
    s_cmp_ge_u32 s24, 4
    s_cbranch_scc1 S_k
    v_mov_b32 v12, 0
    v_mov_b32 v13, 0
    v_mov_b32 v14, 0
    v_mov_b32 v15, 0
    v_mov_b32 v16, 0
    v_mov_b32 v17, 0
    v_mov_b32 v18, 0
    v_mov_b32 v19, 0
    v_mov_b32 v20, 0
    v_mov_b32 v21, 0
    v_mov_b32 v22, 0
    v_mov_b32 v23, 0
    ds_read_b128 v[24:27], v68 offset:8192
    ds_read_b128 v[28:31], v68 offset:9216
    ds_read_b128 v[32:35], v68 offset:10240
    ds_read_b128 v[36:39], v68 offset:11264
    ds_read_b128 v[40:43], v68 offset:12288
    ds_read_b128 v[44:47], v68 offset:13312
    s_cmp_lg_u32 s24, 1
    s_cbranch_scc1 nw_39
    s_cmp_eq_u32 s62, 0
    s_cbranch_scc1 nw_39
    s_add_u32 s31, s83, 18432
    v_and_b32 v5, 1, v1
    v_lshlrev_b32 v5, 2, v5
    s_mov_b32 s100, 0
    s_nop 3
tw_40:
    buffer_load_dword v6, v5, s[4:7], s31 offen sc1
    s_waitcnt vmcnt(0)
    v_cmp_eq_u32 vcc, -1, v6
    s_nop 3
    s_cbranch_vccz twd_41
    s_cmp_lg_u32 s25, 0
    s_cbranch_scc1 twd_41
    s_add_u32 s100, s100, 1
    s_cmp_lt_u32 s100, 400000
    s_sleep 2
    s_cbranch_scc1 tw_40
    s_mov_b32 s25, 1
    s_lshl_b32 s100, s3, 16
    s_lshl_b32 s101, s62, 8
    s_or_b32 s100, s100, s101
    s_or_b32 s100, s100, 5
    v_mov_b32 v3, s100
    v_mov_b32 v4, 52
    buffer_store_dword v3, v4, s[16:19], 0 offen sc1
    s_nop 3
twd_41:
    v_readfirstlane_b32 s31, v6
    s_nop 4
tw2_42:
    s_memrealtime s[92:93]
    s_waitcnt lgkmcnt(0)
    s_sub_u32 s92, s31, s92
    s_sub_u32 s92, s92, 1
    s_cmp_lt_u32 s92, 2000
    s_cbranch_scc1 tw2_42
nw_39:
    s_barrier
    s_branch S_A
S_k:
    s_add_u32 s26, s76, s77
    v_add_u32 v6, s80, v10
    s_add_u32 s27, s76, s78
    v_add_u32 v7, s81, v10
    s_add_u32 s28, s76, s79
    v_add_u32 v8, s82, v10
    s_barrier
    s_mov_b32 s100, 0
    buffer_load_dwordx4 v[12:15], v2, s[4:7], s26 offen sc1
    buffer_load_dwordx4 v[16:19], v2, s[4:7], s27 offen sc1
    buffer_load_dwordx4 v[20:23], v2, s[4:7], s28 offen sc1
    s_sleep 3
    s_add_u32 s29, s26, 65536
    buffer_load_dwordx4 v[24:27], v2, s[4:7], s29 offen sc1
    s_add_u32 s29, s27, 65536
    buffer_load_dwordx4 v[28:31], v2, s[4:7], s29 offen sc1
    s_add_u32 s29, s28, 65536
    buffer_load_dwordx4 v[32:35], v2, s[4:7], s29 offen sc1
    s_waitcnt vmcnt(3)
    v_max3_u32 v4, v12, v13, v14
    v_max3_u32 v4, v4, v15, v16
    v_max_u32 v4, v4, v17
    v_max3_u32 v5, v18, v19, v20
    v_max3_u32 v5, v5, v21, v22
    v_max_u32 v5, v5, v23
    v_max_u32 v4, v4, v5
    v_cmp_eq_u32 vcc, -1, v4
    s_nop 3
    s_cbranch_vccz aok_43
    s_add_u32 s100, s100, 1
    s_add_u32 s29, s26, 131072
    buffer_load_dwordx4 v[36:39], v2, s[4:7], s29 offen sc1
    s_add_u32 s29, s27, 131072
    buffer_load_dwordx4 v[40:43], v2, s[4:7], s29 offen sc1
    s_add_u32 s29, s28, 131072
    buffer_load_dwordx4 v[44:47], v2, s[4:7], s29 offen sc1
    s_waitcnt vmcnt(3)
    v_max3_u32 v4, v24, v25, v26
    v_max3_u32 v4, v4, v27, v28
    v_max_u32 v4, v4, v29
    v_max3_u32 v5, v30, v31, v32
    v_max3_u32 v5, v5, v33, v34
    v_max_u32 v5, v5, v35
    v_max_u32 v4, v4, v5
    v_cmp_eq_u32 vcc, -1, v4
    s_nop 3
    s_cbranch_vccz aok_44
    s_add_u32 s100, s100, 1
    s_sleep 8
    s_add_u32 s29, s26, 196608
    buffer_load_dwordx4 v[48:51], v2, s[4:7], s29 offen sc1
    s_add_u32 s29, s27, 196608
    buffer_load_dwordx4 v[52:55], v2, s[4:7], s29 offen sc1
    s_add_u32 s29, s28, 196608
    buffer_load_dwordx4 v[56:59], v2, s[4:7], s29 offen sc1
    s_waitcnt vmcnt(3)
    v_max3_u32 v4, v36, v37, v38
    v_max3_u32 v4, v4, v39, v40
    v_max_u32 v4, v4, v41
    v_max3_u32 v5, v42, v43, v44
    v_max3_u32 v5, v5, v45, v46
    v_max_u32 v5, v5, v47
    v_max_u32 v4, v4, v5
    v_cmp_eq_u32 vcc, -1, v4
    s_nop 3
    s_cbranch_vccz aok_45
    s_add_u32 s100, s100, 1
alp_48:
    s_waitcnt vmcnt(0)
    v_max3_u32 v4, v48, v49, v50
    v_max3_u32 v4, v4, v51, v52
    v_max_u32 v4, v4, v53
    v_max3_u32 v5, v54, v55, v56
    v_max3_u32 v5, v5, v57, v58
    v_max_u32 v5, v5, v59
    v_max_u32 v4, v4, v5
    v_cmp_eq_u32 vcc, -1, v4
    s_nop 3
    s_cbranch_vccz aok_46
    s_cmp_lg_u32 s25, 0
    s_cbranch_scc1 aok_46
    s_add_u32 s100, s100, 1
    s_cmp_lt_u32 s100, 400000
    s_sleep 2
    s_cbranch_scc1 al2_49
    s_mov_b32 s25, 1
    s_lshl_b32 s100, s3, 16
    s_lshl_b32 s101, s62, 8
    s_or_b32 s100, s100, s101
    s_or_b32 s100, s100, 5
    v_mov_b32 v3, s100
    v_mov_b32 v4, 52
    buffer_store_dword v3, v4, s[16:19], 0 offen sc1
    s_nop 2
    s_branch aok_46
al2_49:
    s_add_u32 s29, s26, 196608
    buffer_load_dwordx4 v[48:51], v2, s[4:7], s29 offen sc1
    s_add_u32 s29, s27, 196608
    buffer_load_dwordx4 v[52:55], v2, s[4:7], s29 offen sc1
    s_add_u32 s29, s28, 196608
    buffer_load_dwordx4 v[56:59], v2, s[4:7], s29 offen sc1
    s_branch alp_48
aok_43:
    ds_write_b128 v6, v[12:15]
    ds_write_b128 v7, v[16:19]
    ds_write_b128 v8, v[20:23]
    s_branch adn_47
aok_44:
    ds_write_b128 v6, v[24:27]
    ds_write_b128 v7, v[28:31]
    ds_write_b128 v8, v[32:35]
    s_branch adn_47
aok_45:
    ds_write_b128 v6, v[36:39]
    ds_write_b128 v7, v[40:43]
    ds_write_b128 v8, v[44:47]
    s_branch adn_47
aok_46:
    ds_write_b128 v6, v[48:51]
    ds_write_b128 v7, v[52:55]
    ds_write_b128 v8, v[56:59]
adn_47:
    s_waitcnt lgkmcnt(0)
    s_barrier
    s_lshl_b32 s26, s63, 3
    s_add_u32 s26, s26, s24
    s_cmp_lg_u32 s26, 7
    s_cbranch_scc1 ts_50
    s_memrealtime s[92:93]
    s_add_u32 s26, s76, 18432
    v_mov_b32 v4, 0
    s_waitcnt lgkmcnt(0)
    s_sub_u32 s93, s92, s85
    s_min_u32 s86, s86, s93
    s_sub_u32 s93, s93, s86
    s_mov_b32 s28, 0
    s_cmp_le_u32 s93, 11
    s_cbranch_scc1 ad_51
    s_cmp_le_u32 s62, 2
    s_cbranch_scc1 ad2_52
    s_cmp_gt_u32 s93, 28
    s_cselect_b32 s28, 16, 16
    s_cselect_b32 s29, 1, 2
    s_add_u32 s87, s87, s29
    s_min_u32 s87, s87, 272
    s_mov_b32 s65, 0
    s_branch ad2_52
ad_51:
    s_add_u32 s65, s65, 1
    s_cmp_lt_u32 s65, 3
    s_cbranch_scc1 ad2_52
    s_mov_b32 s65, 0
    s_sub_u32 s87, s87, 1
    s_max_u32 s87, s87, 152
ad2_52:
    s_add_u32 s92, s92, s28
    s_min_u32 s92, s92, -2
    s_add_u32 s85, s92, s87
    s_min_u32 s85, s85, -2
    v_mov_b32 v6, s85
    v_mov_b32 v7, s92
    s_mov_b64 exec, 1
    buffer_store_dwordx2 v[6:7], v4, s[4:7], s26 offen sc1
    s_mov_b64 exec, -1
    s_waitcnt vmcnt(1)
    s_branch S_k2
ts_50:
    s_sleep 1
    s_waitcnt vmcnt(0)
S_k2:
    v_mov_b32 v12, 0
    v_mov_b32 v13, 0
    v_mov_b32 v14, 0
    v_mov_b32 v15, 0
    v_mov_b32 v16, 0
    v_mov_b32 v17, 0
    v_mov_b32 v18, 0
    v_mov_b32 v19, 0
    v_mov_b32 v20, 0
    v_mov_b32 v21, 0
    v_mov_b32 v22, 0
    v_mov_b32 v23, 0
    ds_read_b128 v[24:27], v68 offset:8192
    ds_read_b128 v[28:31], v68 offset:9216
    ds_read_b128 v[32:35], v68 offset:10240
    ds_read_b128 v[36:39], v68 offset:11264
    ds_read_b128 v[40:43], v68 offset:12288
    ds_read_b128 v[44:47], v68 offset:13312
    s_waitcnt lgkmcnt(0)
    s_branch S_proj
S_A:
    s_waitcnt lgkmcnt(0)
    s_barrier
S_proj:
    ds_read_b128 v[48:51], v9 offset:9216
    ds_read_b128 v[52:55], v9 offset:0
    ds_read_b128 v[56:59], v9 offset:1024
    ds_read_b128 v[60:63], v9 offset:2048
    ds_read_b128 v[64:67], v9 offset:3072
    s_waitcnt lgkmcnt(4)
    v_smfmac_f32_16x16x64_bf16 v[12:15], v[48:51], v[24:31], v11
    ds_read_b128 v[24:27], v68 offset:2048
    ds_read_b128 v[28:31], v68 offset:3072
    v_smfmac_f32_16x16x64_bf16 v[16:19], v[48:51], v[32:39], v11
    ds_read_b128 v[32:35], v68 offset:4096
    ds_read_b128 v[36:39], v68 offset:5120
    v_smfmac_f32_16x16x64_bf16 v[20:23], v[48:51], v[40:47], v11
    ds_read_b128 v[48:51], v9 offset:8192
    ds_read_b128 v[40:43], v68 offset:6144
    ds_read_b128 v[44:47], v68 offset:7168
    s_waitcnt lgkmcnt(10)
    v_smfmac_f32_16x16x64_bf16 v[12:15], v[52:55], a[0:7], v11
    v_smfmac_f32_16x16x64_bf16 v[16:19], v[52:55], a[8:15], v11
    v_smfmac_f32_16x16x64_bf16 v[20:23], v[52:55], a[16:23], v11
    ds_read_b128 v[52:55], v9 offset:4096
    s_waitcnt lgkmcnt(10)
    v_smfmac_f32_16x16x64_bf16 v[12:15], v[56:59], a[24:31], v11
    v_smfmac_f32_16x16x64_bf16 v[16:19], v[56:59], a[32:39], v11
    v_smfmac_f32_16x16x64_bf16 v[20:23], v[56:59], a[40:47], v11
    ds_read_b128 v[56:59], v9 offset:5120
    s_waitcnt lgkmcnt(10)
    v_smfmac_f32_16x16x64_bf16 v[12:15], v[60:63], a[48:55], v11
    v_smfmac_f32_16x16x64_bf16 v[16:19], v[60:63], a[56:63], v11
    v_smfmac_f32_16x16x64_bf16 v[20:23], v[60:63], a[64:71], v11
    ds_read_b128 v[60:63], v9 offset:6144
    s_waitcnt lgkmcnt(10)
    v_smfmac_f32_16x16x64_bf16 v[12:15], v[64:67], a[72:79], v11
    v_smfmac_f32_16x16x64_bf16 v[16:19], v[64:67], a[80:87], v11
    v_smfmac_f32_16x16x64_bf16 v[20:23], v[64:67], a[88:95], v11
    ds_read_b128 v[64:67], v9 offset:7168
    s_waitcnt lgkmcnt(6)
    v_smfmac_f32_16x16x64_bf16 v[12:15], v[48:51], v[24:31], v11
    ds_read_b128 v[24:27], v68 offset:0
    ds_read_b128 v[28:31], v68 offset:1024
    v_smfmac_f32_16x16x64_bf16 v[16:19], v[48:51], v[32:39], v11
    s_waitcnt lgkmcnt(6)
    v_smfmac_f32_16x16x64_bf16 v[20:23], v[48:51], v[40:47], v11
    s_waitcnt lgkmcnt(5)
    v_smfmac_f32_16x16x64_bf16 v[12:15], v[52:55], a[96:103], v11
    v_smfmac_f32_16x16x64_bf16 v[16:19], v[52:55], a[104:111], v11
    v_smfmac_f32_16x16x64_bf16 v[20:23], v[52:55], a[112:119], v11
    s_waitcnt lgkmcnt(4)
    v_smfmac_f32_16x16x64_bf16 v[12:15], v[56:59], a[120:127], v11
    v_smfmac_f32_16x16x64_bf16 v[16:19], v[56:59], a[128:135], v11
    v_smfmac_f32_16x16x64_bf16 v[20:23], v[56:59], a[136:143], v11
    s_waitcnt lgkmcnt(3)
    v_smfmac_f32_16x16x64_bf16 v[12:15], v[60:63], a[144:151], v11
    v_smfmac_f32_16x16x64_bf16 v[16:19], v[60:63], a[152:159], v11
    v_smfmac_f32_16x16x64_bf16 v[20:23], v[60:63], v[72:79], v11
    s_waitcnt lgkmcnt(2)
    v_smfmac_f32_16x16x64_bf16 v[12:15], v[64:67], v[80:87], v11
    v_smfmac_f32_16x16x64_bf16 v[16:19], v[64:67], v[88:95], v11
    s_waitcnt lgkmcnt(0)
    v_smfmac_f32_16x16x64_bf16 v[20:23], v[64:67], v[24:31], v11
    s_nop 4
    v_add_f32 v12, v12, v14
    v_add_f32 v13, v13, v15
    v_cvt_pk_bf16_f32 v12, v12, v13
    ds_write_b32 v69, v12 offset:0
    v_add_f32 v16, v16, v18
    v_add_f32 v17, v17, v19
    v_cvt_pk_bf16_f32 v16, v16, v17
    ds_write_b32 v69, v16 offset:256
    v_add_f32 v20, v20, v22
    v_add_f32 v21, v21, v23
    v_cvt_pk_bf16_f32 v20, v20, v21
    ds_write_b32 v69, v20 offset:512
    s_add_u32 s72, s72, 4
    s_cmp_ge_u32 s24, 4
    s_nop 0
    s_cbranch_scc1 S_kwait
    v_mov_b32 v3, 131072
    v_mov_b32 v4, 1
    s_mov_b64 exec, 1
    ds_add_u32 v3, v4
    s_mov_b64 exec, -1
    s_cmp_lt_u32 s24, 2
    s_cbranch_scc1 S_fin
    s_barrier
    s_cmp_eq_u32 s24, 2
    s_cbranch_scc1 S_km
    s_add_u32 s31, s62, 1
    s_cmp_ge_u32 s31, 64
    s_cbranch_scc1 S_next
    s_sleep 10
    s_xor_b32 s30, s71, 12288
    s_add_u32 s73, s31, 1
    s_cmp_ge_u32 s84, s73
    s_cbranch_scc1 pc_53
    s_mov_b32 s100, 0
poll_54:
    buffer_load_dword v6, v71, s[4:7], 0 offen sc1
    s_waitcnt vmcnt(0)
    v_cmp_gt_u32 vcc, s73, v6
    s_nop 3
    s_cbranch_vccz polld_55
    s_cmp_lg_u32 s25, 0
    s_cbranch_scc1 polld_55
    s_add_u32 s100, s100, 1
    s_cmp_lt_u32 s100, 400000
    s_sleep 2
    s_cbranch_scc1 poll_54
    s_mov_b32 s25, 1
    s_lshl_b32 s100, s3, 16
    s_lshl_b32 s101, s62, 8
    s_or_b32 s100, s100, s101
    s_or_b32 s100, s100, 4
    v_mov_b32 v3, s100
    v_mov_b32 v4, 48
    buffer_store_dword v3, v4, s[16:19], 0 offen sc1
    s_nop 3
polld_55:
    v_readfirstlane_b32 s84, v6
    s_nop 4
pc_53:
    s_lshl_b32 s27, s31, 5
    s_add_u32 s27, s27, s63
    s_mul_i32 s27, s27, 12288
    s_add_u32 s27, s27, 0x3000000
    s_add_u32 m0, s30, 132096
    s_nop 0
    buffer_load_dwordx4 v2, s[4:7], s27 offen offset:0 sc1 lds
    buffer_load_dwordx4 v2, s[4:7], s27 offen offset:1024 sc1 lds
    buffer_load_dwordx4 v2, s[4:7], s27 offen offset:2048 sc1 lds
    buffer_load_dwordx4 v2, s[4:7], s27 offen offset:3072 sc1 lds
    s_add_u32 m0, s30, 136192
    s_add_u32 s27, s27, 4096
    buffer_load_dwordx4 v2, s[4:7], s27 offen offset:0 sc1 lds
    buffer_load_dwordx4 v2, s[4:7], s27 offen offset:1024 sc1 lds
    buffer_load_dwordx4 v2, s[4:7], s27 offen offset:2048 sc1 lds
    buffer_load_dwordx4 v2, s[4:7], s27 offen offset:3072 sc1 lds
    s_add_u32 m0, s30, 140288
    s_add_u32 s27, s27, 4096
    buffer_load_dwordx4 v2, s[4:7], s27 offen offset:0 sc1 lds
    buffer_load_dwordx4 v2, s[4:7], s27 offen offset:1024 sc1 lds
    buffer_load_dwordx4 v2, s[4:7], s27 offen offset:2048 sc1 lds
    buffer_load_dwordx4 v2, s[4:7], s27 offen offset:3072 sc1 lds
    s_waitcnt vmcnt(0)
    s_branch S_next
S_kwait:
    s_waitcnt lgkmcnt(0)
    s_barrier
    s_branch S_next
S_km:
    s_sleep 2
    ds_read_b64_tr_b16 v[24:25], v70 offset:3072
    ds_read_b64_tr_b16 v[26:27], v70 offset:3328
    ds_read_b64_tr_b16 v[28:29], v70 offset:3584
    ds_read_b64_tr_b16 v[30:31], v70 offset:3840
    ds_read_b64_tr_b16 v[32:33], v70 offset:4096
    ds_read_b64_tr_b16 v[34:35], v70 offset:4352
    ds_read_b64_tr_b16 v[36:37], v70 offset:4608
    ds_read_b64_tr_b16 v[38:39], v70 offset:4864
    ds_read_b64_tr_b16 v[40:41], v70 offset:5120
    ds_read_b64_tr_b16 v[42:43], v70 offset:5376
    ds_read_b64_tr_b16 v[44:45], v70 offset:5632
    ds_read_b64_tr_b16 v[46:47], v70 offset:5888
    v_lshrrev_b32 v3, 4, v1
    v_and_b32 v4, 7, v1
    v_lshl_add_u32 v3, v3, 3, v4
    v_lshlrev_b32 v3, 4, v3
    s_lshl_b32 s27, s62, 5
    s_add_u32 s27, s27, s63
    s_mul_i32 s27, s27, 3072
    s_add_u32 s27, s27, 0x2000000
    s_waitcnt lgkmcnt(0)
    s_cmp_ge_u32 s62, 63
    s_cbranch_scc1 kms_56
    s_sleep 6
kms_56:
    s_mov_b32 exec_lo, 0xff00ff
    s_mov_b32 exec_hi, 0xff00ff
    buffer_store_dwordx4 v[24:27], v3, s[4:7], s27 offen offset:0 sc1
    buffer_store_dwordx4 v[28:31], v3, s[4:7], s27 offen offset:512 sc1
    buffer_store_dwordx4 v[32:35], v3, s[4:7], s27 offen offset:1024 sc1
    buffer_store_dwordx4 v[36:39], v3, s[4:7], s27 offen offset:1536 sc1
    buffer_store_dwordx4 v[40:43], v3, s[4:7], s27 offen offset:2048 sc1
    buffer_store_dwordx4 v[44:47], v3, s[4:7], s27 offen offset:2560 sc1
    s_mov_b64 exec, -1
    s_waitcnt vmcnt(0)
    s_add_u32 s26, s62, 1
    v_mov_b32 v3, s26
    v_mov_b32 v4, s91
    s_mov_b64 exec, 1
    buffer_store_dword v3, v4, s[4:7], s68 offen sc1
    s_mov_b64 exec, -1
    s_nop 0
    s_branch S_next
S_fin:
    s_mul_i32 s26, s24, 6144
    s_add_u32 s26, s26, s71
    s_add_u32 s26, s26, 132096
    v_add_u32 v7, s26, v2
    ds_read_b128 v[24:27], v7 offset:0
    ds_read_b128 v[28:31], v7 offset:1024
    s_mov_b32 s100, 0
    s_nop 1
sq_57:
    ds_read_b32 v5, v3
    ds_read_b64_tr_b16 v[40:41], v70 offset:0
    ds_read_b64_tr_b16 v[42:43], v70 offset:256
    ds_read_b64_tr_b16 v[44:45], v70 offset:512
    ds_read_b64_tr_b16 v[46:47], v70 offset:768
    ds_read_b64_tr_b16 v[48:49], v70 offset:1024
    ds_read_b64_tr_b16 v[50:51], v70 offset:1280
    ds_read_b64_tr_b16 v[52:53], v70 offset:1536
    ds_read_b64_tr_b16 v[54:55], v70 offset:1792
    ds_read_b64_tr_b16 v[56:57], v70 offset:2048
    ds_read_b64_tr_b16 v[58:59], v70 offset:2304
    ds_read_b64_tr_b16 v[60:61], v70 offset:2560
    ds_read_b64_tr_b16 v[62:63], v70 offset:2816
    s_waitcnt lgkmcnt(12)
    v_cmp_gt_u32 vcc, s72, v5
    s_nop 3
    s_cbranch_vccz sqd_58
    s_waitcnt lgkmcnt(0)
    s_cmp_lg_u32 s25, 0
    s_cbranch_scc1 sqd_58
    s_add_u32 s100, s100, 1
    s_cmp_lt_u32 s100, 400000
    s_cbranch_scc1 sq_57
    s_mov_b32 s25, 1
    s_lshl_b32 s100, s3, 16
    s_lshl_b32 s101, s62, 8
    s_or_b32 s100, s100, s101
    s_or_b32 s100, s100, 6
    v_mov_b32 v3, s100
    v_mov_b32 v4, 56
    buffer_store_dword v3, v4, s[16:19], 0 offen sc1
    s_nop 3
sqd_58:
    ds_read_b128 v[32:35], v7 offset:2048
    ds_read_b128 v[36:39], v7 offset:3072
    s_waitcnt lgkmcnt(12)
    v_mfma_f32_16x16x32_bf16 v[12:15], v[24:27], v[40:43], 0
    ds_read_b128 v[24:27], v7 offset:4096
    s_waitcnt lgkmcnt(11)
    v_mfma_f32_16x16x32_bf16 v[12:15], v[28:31], v[44:47], v[12:15]
    ds_read_b128 v[28:31], v7 offset:5120
    s_waitcnt lgkmcnt(3)
    v_mfma_f32_16x16x32_bf16 v[12:15], v[32:35], v[48:51], v[12:15]
    s_waitcnt lgkmcnt(2)
    v_mfma_f32_16x16x32_bf16 v[12:15], v[36:39], v[52:55], v[12:15]
    s_waitcnt lgkmcnt(1)
    v_mfma_f32_16x16x32_bf16 v[12:15], v[24:27], v[56:59], v[12:15]
    s_waitcnt lgkmcnt(0)
    v_mfma_f32_16x16x32_bf16 v[12:15], v[28:31], v[60:63], v[12:15]
    s_nop 7
    v_max3_f32 v64, v12, v13, v14
    v_max_f32 v64, v64, v15
    v_mul_f32 v64, s70, v64
    v_fma_f32 v12, v12, s70, -v64
    v_fma_f32 v13, v13, s70, -v64
    v_fma_f32 v14, v14, s70, -v64
    v_fma_f32 v15, v15, s70, -v64
    v_exp_f32 v12, v12
    v_exp_f32 v13, v13
    v_exp_f32 v14, v14
    v_exp_f32 v15, v15
    v_add_f32 v65, v12, v13
    v_add_f32 v66, v14, v15
    v_add_f32 v65, v65, v66
    v_add_u32 v7, 156672, v2
    v_lshrrev_b32 v3, 1, v2
    v_add_u32 v3, 157696, v3
    s_cmp_eq_u32 s24, 0
    s_nop 2
    s_cbranch_scc1 S_fin0
    ds_write_b128 v7, v[12:15]
    ds_write_b64 v3, v[64:65]
    s_waitcnt lgkmcnt(0)
    s_barrier
    s_branch S_next
S_fin0:
    s_add_u32 s26, s76, s74
    s_add_u32 s27, s76, s75
    s_barrier
    ds_read_b64_tr_b16 v[24:25], v70 offset:3072
    ds_read_b64_tr_b16 v[26:27], v70 offset:3328
    ds_read_b64_tr_b16 v[28:29], v70 offset:3584
    ds_read_b64_tr_b16 v[30:31], v70 offset:3840
    ds_read_b64_tr_b16 v[32:33], v70 offset:4096
    ds_read_b64_tr_b16 v[34:35], v70 offset:4352
    ds_read_b64_tr_b16 v[36:37], v70 offset:4608
    ds_read_b64_tr_b16 v[38:39], v70 offset:4864
    s_waitcnt lgkmcnt(6)
    v_mfma_f32_16x16x32_bf16 v[20:23], v[24:27], v[40:43], 0
    ds_read_b64_tr_b16 v[24:25], v70 offset:5120
    ds_read_b64_tr_b16 v[26:27], v70 offset:5376
    s_waitcnt lgkmcnt(6)
    v_mfma_f32_16x16x32_bf16 v[20:23], v[28:31], v[44:47], v[20:23]
    ds_read_b64_tr_b16 v[28:29], v70 offset:5632
    ds_read_b64_tr_b16 v[30:31], v70 offset:5888
    ds_read_b64 v[4:5], v3
    ds_read_b128 v[16:19], v7
    s_waitcnt lgkmcnt(8)
    v_mfma_f32_16x16x32_bf16 v[20:23], v[32:35], v[48:51], v[20:23]
    s_waitcnt lgkmcnt(6)
    v_mfma_f32_16x16x32_bf16 v[20:23], v[36:39], v[52:55], v[20:23]
    s_waitcnt lgkmcnt(4)
    v_mfma_f32_16x16x32_bf16 v[20:23], v[24:27], v[56:59], v[20:23]
    s_waitcnt lgkmcnt(2)
    v_mfma_f32_16x16x32_bf16 v[20:23], v[28:31], v[60:63], v[20:23]
    v_and_b32 v43, 7, v1
    v_lshrrev_b32 v44, 4, v1
    v_lshlrev_b32 v43, 4, v43
    v_lshl_add_u32 v40, v44, 8, v43
    v_lshl_add_u32 v41, v44, 3, v43
    s_waitcnt lgkmcnt(0)
    v_max_f32 v45, v64, v4
    v_mov_b32 v46, v45
    s_nop 1
    v_permlane32_swap_b32 v45, v46
    v_max_f32 v45, v45, v46
    v_max3_f32 v67, v20, v21, v22
    v_max_f32 v67, v67, v23
    v_mul_f32 v67, s70, v67
    v_max_f32 v67, v67, v45
    v_mov_b32 v66, v67
    s_nop 1
    v_permlane16_swap_b32 v67, v66
    v_max_f32 v67, v67, v66
    v_fma_f32 v20, v20, s70, -v67
    v_fma_f32 v21, v21, s70, -v67
    v_fma_f32 v22, v22, s70, -v67
    v_fma_f32 v23, v23, s70, -v67
    v_sub_f32 v8, v64, v67
    v_sub_f32 v42, v4, v67
    v_exp_f32 v8, v8
    v_exp_f32 v42, v42
    v_exp_f32 v20, v20
    v_exp_f32 v21, v21
    v_exp_f32 v22, v22
    v_exp_f32 v23, v23
    v_mul_f32 v65, v65, v8
    v_fmac_f32 v65, v5, v42
    v_add_f32 v67, v20, v21
    v_add_f32 v66, v22, v23
    v_mov_b32 v46, v65
    v_add_f32 v67, v67, v66
    s_nop 0
    v_permlane32_swap_b32 v65, v46
    v_add_f32 v67, v67, v65
    v_add_f32 v67, v67, v46
    v_mov_b32 v66, v67
    s_nop 1
    v_permlane16_swap_b32 v67, v66
    v_add_f32 v67, v67, v66
    v_rcp_f32 v67, v67
    s_nop 0
    v_mul_f32 v8, v8, v67
    v_mul_f32 v42, v42, v67
    v_mul_f32_e64 v12, v12, v8 clamp
    v_mul_f32_e64 v13, v13, v8 clamp
    v_mul_f32_e64 v14, v14, v8 clamp
    v_mul_f32_e64 v15, v15, v8 clamp
    v_mul_f32_e64 v16, v16, v42 clamp
    v_mul_f32_e64 v17, v17, v42 clamp
    v_mul_f32_e64 v18, v18, v42 clamp
    v_mul_f32_e64 v19, v19, v42 clamp
    v_cvt_pk_bf16_f32 v24, v12, v13
    v_cvt_pk_bf16_f32 v25, v14, v15
    v_cvt_pk_bf16_f32 v26, v16, v17
    v_cvt_pk_bf16_f32 v27, v18, v19
    s_mov_b32 exec_lo, 0xff00ff
    s_mov_b32 exec_hi, 0xff00ff
    buffer_store_dwordx4 v[24:27], v40, s[4:7], s26 offen sc1
    v_mul_f32_e64 v20, v20, v67 clamp
    v_mul_f32_e64 v21, v21, v67 clamp
    v_mul_f32_e64 v22, v22, v67 clamp
    v_mul_f32_e64 v23, v23, v67 clamp
    v_cvt_pk_bf16_f32 v28, v20, v21
    v_cvt_pk_bf16_f32 v29, v22, v23
    s_mov_b32 exec_lo, 0xff00ff
    s_mov_b32 exec_hi, 0x0
    buffer_store_dwordx2 v[28:29], v41, s[4:7], s27 offen sc1
    s_add_u32 s26, s26, 65536
    s_add_u32 s27, s27, 65536
    s_mov_b32 exec_lo, 0xff00ff
    s_mov_b32 exec_hi, 0xff00ff
    buffer_store_dwordx4 v[24:27], v40, s[4:7], s26 offen sc1
    s_mov_b32 exec_lo, 0xff00ff
    s_mov_b32 exec_hi, 0x0
    buffer_store_dwordx2 v[28:29], v41, s[4:7], s27 offen sc1
    s_mov_b64 exec, -1
S_next:
    s_add_u32 s62, s62, 1
    s_add_u32 s69, s69, 262144
    s_xor_b32 s71, s71, 12288
    s_cmp_lt_u32 s62, 64
    s_cbranch_scc1 S_loop
    s_endpgm
R_V:
    s_sub_u32 s63, s3, 32
    s_cmp_lg_u32 s24, 0
    s_cbranch_scc1 wst_59
    v_and_b32 v5, 3, v1
    v_lshlrev_b32 v5, 6, v5
    s_mov_b32 s100, 0
    s_nop 3
poll_60:
    buffer_load_dword v6, v5, s[16:19], 0 offen sc1
    s_waitcnt vmcnt(0)
    v_cmp_gt_u32 vcc, 32, v6
    s_nop 3
    s_cbranch_vccz polld_61
    s_cmp_lg_u32 s25, 0
    s_cbranch_scc1 polld_61
    s_add_u32 s100, s100, 1
    s_cmp_lt_u32 s100, 400000
    s_sleep 8
    s_cbranch_scc1 poll_60
    s_mov_b32 s25, 1
    s_lshl_b32 s100, s3, 16
    s_lshl_b32 s101, s62, 8
    s_or_b32 s100, s100, s101
    s_or_b32 s100, s100, 1
    v_mov_b32 v3, s100
    v_mov_b32 v4, 36
    buffer_store_dword v3, v4, s[16:19], 0 offen sc1
    s_nop 3
polld_61:
wst_59:
    s_barrier
    s_cmp_ge_u32 s24, 6
    s_cbranch_scc1 L_end
    v_mov_b32 v5, 8
    s_mov_b32 s100, 0
    s_nop 3
poll_62:
    buffer_load_dword v6, v5, s[16:19], 0 offen sc1
    s_waitcnt vmcnt(0)
    v_cmp_gt_u32 vcc, 64, v6
    s_nop 3
    s_cbranch_vccz polld_63
    s_cmp_lg_u32 s25, 0
    s_cbranch_scc1 polld_63
    s_add_u32 s100, s100, 1
    s_cmp_lt_u32 s100, 400000
    s_sleep 8
    s_cbranch_scc1 poll_62
    s_mov_b32 s25, 1
    s_lshl_b32 s100, s3, 16
    s_lshl_b32 s101, s62, 8
    s_or_b32 s100, s100, s101
    s_or_b32 s100, s100, 2
    v_mov_b32 v3, s100
    v_mov_b32 v4, 40
    buffer_store_dword v3, v4, s[16:19], 0 offen sc1
    s_nop 3
polld_63:
    v_readfirstlane_b32 s26, v6
    s_and_b32 s88, s26, 1
    s_xor_b32 s89, s88, 1
    s_lshl_b32 s89, s89, 13
    s_xor_b32 s91, s89, 8192
    s_mov_b32 s90, 0
    s_mov_b32 s69, 0xe000000
    s_cmp_eq_u32 s24, 4
    s_cbranch_scc1 V_timer
    s_cmp_eq_u32 s24, 5
    s_cbranch_scc1 V_jan
    s_mov_b32 s82, 0
    v_and_b32 v3, 7, v1
    v_lshlrev_b32 v3, 7, v3
    s_lshl_b32 s26, s24, 10
    s_mul_i32 s27, s63, 13
    s_lshr_b32 s27, s27, 7
    s_lshl_b32 s27, s27, 2
    s_add_u32 s26, s26, s27
    s_add_u32 s26, s26, 4096
    v_add_u32 v8, s26, v3
    v_and_b32 v3, 15, v1
    v_lshlrev_b32 v3, 6, v3
    v_lshrrev_b32 v4, 4, v1
    v_lshl_add_u32 v3, v4, 4, v3
    s_lshl_b32 s26, s24, 10
    v_add_u32 v9, s26, v3
    v_lshlrev_b32 v3, 2, v1
    s_and_b32 s26, s24, 1
    s_lshl_b32 s26, s26, 8
    v_add_u32 v10, s26, v3
    v_and_b32 v3, 48, v1
    v_bfe_u32 v4, v1, 1, 1
    v_lshl_add_u32 v11, v4, 7, v3
    s_lshl_b32 s27, s63, 1
    s_and_b32 s26, s24, 1
    s_add_u32 s27, s27, s26
    s_lshr_b32 s26, s27, 6
    s_lshl_b32 s26, s26, 13
    s_lshl_b32 s71, s27, 7
    s_add_u32 s71, s71, s26
    s_and_b32 s26, s24, 1
    s_lshl_b32 s26, s26, 6
    s_sub_u32 s81, s71, s26
    s_lshr_b32 s26, s24, 1
    s_lshl_b32 s26, s26, 14
    s_and_b32 s27, s24, 1
    s_lshl_b32 s27, s27, 12
    s_add_u32 s72, s26, s27
    s_add_u32 s72, s72, 32768
    s_lshl_b32 s73, s24, 10
    s_add_u32 s73, s73, 20480
    s_lshl_b32 s78, s63, 14
    s_lshl_b32 s26, s24, 11
    s_add_u32 s78, s78, s26
    s_mov_b32 s79, 0
    s_cmp_ge_u32 s24, 2
    s_cbranch_scc1 v0_64
    s_mov_b32 s8, s34
    s_and_b32 s9, s35, 0xffff
    s_mov_b32 s10, 0x2800
    s_mov_b32 s11, 0x20000
    v_lshrrev_b32 v3, 2, v1
    v_mul_u32_u24 v3, 1280, v3
    v_and_b32 v4, 3, v1
    v_lshl_add_u32 v3, v4, 3, v3
    s_lshl_b32 s26, s63, 5
    s_lshl_b32 s27, s24, 2
    s_add_u32 s26, s26, s27
    v_lshlrev_b32 v5, 2, v1
    s_mov_b32 exec_lo, 0xffffffff
    s_mov_b32 exec_hi, 0x0
    buffer_load_dword v4, v3, s[8:11], s26 offen
    s_add_u32 s27, s62, 0
    s_lshr_b32 s27, s27, 3
    s_xor_b32 s27, s27, s88
    s_and_b32 s27, s27, 1
    s_lshl_b32 s27, s27, 13
    s_add_u32 s27, s27, s69
    s_add_u32 s27, s27, s71
    s_waitcnt vmcnt(0)
    v_min_u32 v4, -2, v4
    buffer_store_dword v4, v5, s[4:7], s27 offen sc1
    s_add_u32 s27, s27, 65536
    buffer_store_dword v4, v5, s[4:7], s27 offen sc1
    s_add_u32 s27, s27, 65536
    buffer_store_dword v4, v5, s[4:7], s27 offen sc1
    s_add_u32 s27, s27, 65536
    buffer_store_dword v4, v5, s[4:7], s27 offen sc1
    s_add_u32 s27, s27, 65536
    s_mov_b64 exec, -1
v0_64:
V_loop:
    s_barrier
    s_add_u32 s70, s62, 0
    s_lshr_b32 s70, s70, 3
    s_xor_b32 s70, s70, s88
    s_and_b32 s70, s70, 1
    s_lshl_b32 s70, s70, 13
    s_add_u32 s70, s70, s69
    s_add_u32 s30, s62, 1
    s_mov_b32 s100, 0
poll_65:
    buffer_load_dword v6, v8, s[4:7], s89 offen sc1
    s_waitcnt vmcnt(0)
    v_cmp_gt_u32 vcc, s30, v6
    s_nop 3
    s_cbranch_vccz polld_66
    s_cmp_lg_u32 s25, 0
    s_cbranch_scc1 polld_66
    s_add_u32 s100, s100, 1
    s_cmp_lt_u32 s100, 400000
    s_sleep 6
    s_cbranch_scc1 poll_65
    s_mov_b32 s25, 1
    s_lshl_b32 s100, s3, 16
    s_lshl_b32 s101, s62, 8
    s_or_b32 s100, s100, s101
    s_or_b32 s100, s100, 11
    v_mov_b32 v3, s100
    v_mov_b32 v4, 44
    buffer_store_dword v3, v4, s[16:19], 0 offen sc1
    s_nop 3
polld_66:
    s_mul_i32 s26, s62, 40
    s_add_u32 s26, s26, s63
    s_lshl_b32 s26, s26, 2
    s_add_u32 s26, s26, s24
    s_lshl_b32 s27, s26, 13
    s_add_u32 s27, s27, 0x7400000
    buffer_load_dwordx4 a[0:3], v2, s[4:7], s27 offen offset:0 sc1
    buffer_load_dwordx4 a[4:7], v2, s[4:7], s27 offen offset:1024 sc1
    buffer_load_dwordx4 a[8:11], v2, s[4:7], s27 offen offset:2048 sc1
    buffer_load_dwordx4 a[12:15], v2, s[4:7], s27 offen offset:3072 sc1
    s_add_u32 s27, s27, 4096
    buffer_load_dwordx4 a[16:19], v2, s[4:7], s27 offen offset:0 sc1
    buffer_load_dwordx4 a[20:23], v2, s[4:7], s27 offen offset:1024 sc1
    buffer_load_dwordx4 a[24:27], v2, s[4:7], s27 offen offset:2048 sc1
    buffer_load_dwordx4 a[28:31], v2, s[4:7], s27 offen offset:3072 sc1
    s_mul_i32 s26, s62, 171
    s_lshr_b32 s26, s26, 9
    s_mul_i32 s83, s26, 131072
    s_xor_b32 s26, s26, s88
    s_and_b32 s26, s26, 1
    s_lshl_b32 s26, s26, 13
    s_add_u32 s83, s83, s26
    s_mul_i32 s26, s62, 655360
    s_add_u32 s83, s83, s26
    s_add_u32 s83, s83, 0x4800000
    s_add_u32 s83, s83, s78
    s_add_u32 s28, s70, s72
    s_add_u32 s29, s70, s73
    s_add_u32 s31, s62, 1
    s_lshr_b32 s31, s31, 3
    s_xor_b32 s31, s31, s88
    s_and_b32 s31, s31, 1
    s_lshl_b32 s31, s31, 13
    s_add_u32 s31, s31, s69
    s_add_u32 s31, s31, s81
    s_add_u32 s31, s31, 262144
    s_barrier
    s_mov_b32 s100, 0
    buffer_load_dwordx4 v[48:51], v2, s[4:7], s28 offen offset:0 sc1
    buffer_load_dwordx4 v[52:55], v2, s[4:7], s28 offen offset:1024 sc1
    buffer_load_dwordx4 v[56:59], v2, s[4:7], s28 offen offset:2048 sc1
    buffer_load_dwordx4 v[60:63], v2, s[4:7], s28 offen offset:3072 sc1
    buffer_load_dwordx4 v[64:67], v2, s[4:7], s29 offen sc1
    s_sleep 2
    buffer_load_dwordx4 v[40:43], v2, s[4:7], s83 offen offset:0 sc1
    buffer_load_dwordx4 v[44:47], v2, s[4:7], s83 offen offset:1024 sc1
    s_sleep 4
    s_add_u32 s26, s28, 65536
    s_add_u32 s27, s29, 65536
    buffer_load_dwordx4 v[76:79], v2, s[4:7], s26 offen offset:0 sc1
    buffer_load_dwordx4 v[80:83], v2, s[4:7], s26 offen offset:1024 sc1
    buffer_load_dwordx4 v[84:87], v2, s[4:7], s26 offen offset:2048 sc1
    buffer_load_dwordx4 v[88:91], v2, s[4:7], s26 offen offset:3072 sc1
    buffer_load_dwordx4 v[92:95], v2, s[4:7], s27 offen sc1
    buffer_load_dwordx4 v[68:71], v2, s[4:7], s83 offen offset:0 sc1
    buffer_load_dwordx4 v[72:75], v2, s[4:7], s83 offen offset:1024 sc1
    s_waitcnt vmcnt(13)
    v_mfma_f32_16x16x32_bf16 v[12:15], a[0:3], v[48:51], 0
    v_mfma_f32_16x16x32_bf16 v[16:19], a[4:7], v[48:51], 0
    v_max_u32 v5, v48, v49
    v_max_u32 v6, v50, v51
    s_waitcnt vmcnt(12)
    v_mfma_f32_16x16x32_bf16 v[12:15], a[8:11], v[52:55], v[12:15]
    v_mfma_f32_16x16x32_bf16 v[16:19], a[12:15], v[52:55], v[16:19]
    v_max3_u32 v5, v5, v52, v53
    v_max3_u32 v6, v6, v54, v55
    s_waitcnt vmcnt(11)
    v_mfma_f32_16x16x32_bf16 v[12:15], a[16:19], v[56:59], v[12:15]
    v_mfma_f32_16x16x32_bf16 v[16:19], a[20:23], v[56:59], v[16:19]
    v_max3_u32 v5, v5, v56, v57
    v_max3_u32 v6, v6, v58, v59
    s_waitcnt vmcnt(10)
    v_mfma_f32_16x16x32_bf16 v[12:15], a[24:27], v[60:63], v[12:15]
    v_mfma_f32_16x16x32_bf16 v[16:19], a[28:31], v[60:63], v[16:19]
    v_max3_u32 v5, v5, v60, v61
    v_max3_u32 v6, v6, v62, v63
    s_waitcnt vmcnt(9)
    v_max3_u32 v5, v5, v64, v65
    v_max3_u32 v6, v6, v66, v67
    v_max_u32 v5, v5, v6
    v_cmp_eq_u32 s[86:87], -1, v5
    s_waitcnt vmcnt(8)
    v_mfma_f32_16x16x32_bf16 v[12:15], v[40:43], v[64:67], v[12:15]
    v_max_u32 v20, v40, v41
    v_max_u32 v21, v42, v43
    s_waitcnt vmcnt(7)
    v_mfma_f32_16x16x32_bf16 v[16:19], v[44:47], v[64:67], v[16:19]
    v_max3_u32 v20, v20, v44, v45
    v_max3_u32 v21, v21, v46, v47
    s_mov_b32 exec_lo, 0xff00ff
    s_mov_b32 exec_hi, 0xff00ff
    ds_write_b128 v9, v[12:15]
    s_mov_b32 exec_lo, 0xff00ff00
    s_mov_b32 exec_hi, 0xff00ff00
    s_nop 0
    ds_write_b128 v9, v[16:19]
    s_mov_b64 exec, -1
    v_max_u32 v20, v20, v21
    v_cmp_eq_u32 vcc, -1, v20
    s_or_b64 vcc, vcc, s[86:87]
    s_nop 1
    s_cbranch_vccz aok_67
    s_add_u32 s100, s100, 1
alp_70:
    s_waitcnt vmcnt(6)
    v_mfma_f32_16x16x32_bf16 v[12:15], a[0:3], v[76:79], 0
    v_mfma_f32_16x16x32_bf16 v[16:19], a[4:7], v[76:79], 0
    v_max_u32 v5, v76, v77
    v_max_u32 v6, v78, v79
    s_waitcnt vmcnt(5)
    v_mfma_f32_16x16x32_bf16 v[12:15], a[8:11], v[80:83], v[12:15]
    v_mfma_f32_16x16x32_bf16 v[16:19], a[12:15], v[80:83], v[16:19]
    v_max3_u32 v5, v5, v80, v81
    v_max3_u32 v6, v6, v82, v83
    s_waitcnt vmcnt(4)
    v_mfma_f32_16x16x32_bf16 v[12:15], a[16:19], v[84:87], v[12:15]
    v_mfma_f32_16x16x32_bf16 v[16:19], a[20:23], v[84:87], v[16:19]
    v_max3_u32 v5, v5, v84, v85
    v_max3_u32 v6, v6, v86, v87
    s_waitcnt vmcnt(3)
    v_mfma_f32_16x16x32_bf16 v[12:15], a[24:27], v[88:91], v[12:15]
    v_mfma_f32_16x16x32_bf16 v[16:19], a[28:31], v[88:91], v[16:19]
    v_max3_u32 v5, v5, v88, v89
    v_max3_u32 v6, v6, v90, v91
    s_waitcnt vmcnt(2)
    v_max3_u32 v5, v5, v92, v93
    v_max3_u32 v6, v6, v94, v95
    v_max_u32 v5, v5, v6
    v_cmp_eq_u32 s[86:87], -1, v5
    s_waitcnt vmcnt(1)
    v_mfma_f32_16x16x32_bf16 v[12:15], v[68:71], v[92:95], v[12:15]
    v_max_u32 v20, v68, v69
    v_max_u32 v21, v70, v71
    s_waitcnt vmcnt(0)
    v_mfma_f32_16x16x32_bf16 v[16:19], v[72:75], v[92:95], v[16:19]
    v_max3_u32 v20, v20, v72, v73
    v_max3_u32 v21, v21, v74, v75
    s_mov_b32 exec_lo, 0xff00ff
    s_mov_b32 exec_hi, 0xff00ff
    ds_write_b128 v9, v[12:15]
    s_mov_b32 exec_lo, 0xff00ff00
    s_mov_b32 exec_hi, 0xff00ff00
    s_nop 0
    ds_write_b128 v9, v[16:19]
    s_mov_b64 exec, -1
    v_max_u32 v20, v20, v21
    v_cmp_eq_u32 vcc, -1, v20
    s_or_b64 vcc, vcc, s[86:87]
    s_nop 1
    s_cbranch_vccz aok_68
    s_cmp_lg_u32 s25, 0
    s_cbranch_scc1 aok_68
    s_add_u32 s100, s100, 1
    s_cmp_lt_u32 s100, 400000
    s_sleep 2
    s_cbranch_scc1 al2_71
    s_mov_b32 s25, 1
    s_lshl_b32 s100, s3, 16
    s_lshl_b32 s101, s62, 8
    s_or_b32 s100, s100, s101
    s_or_b32 s100, s100, 10
    v_mov_b32 v3, s100
    v_mov_b32 v4, 40
    buffer_store_dword v3, v4, s[16:19], 0 offen sc1
    s_nop 2
    s_branch aok_68
al2_71:
    s_cmp_lg_u64 s[86:87], 0
    s_cbranch_scc1 rf_72
    s_mov_b32 s30, s83
    buffer_load_dwordx4 v[68:71], v2, s[4:7], s30 offen offset:0 sc1
    buffer_load_dwordx4 v[72:75], v2, s[4:7], s30 offen offset:1024 sc1
    s_branch re_73
rf_72:
    s_add_u32 s26, s28, 65536
    s_add_u32 s27, s29, 65536
    buffer_load_dwordx4 v[76:79], v2, s[4:7], s26 offen offset:0 sc1
    buffer_load_dwordx4 v[80:83], v2, s[4:7], s26 offen offset:1024 sc1
    buffer_load_dwordx4 v[84:87], v2, s[4:7], s26 offen offset:2048 sc1
    buffer_load_dwordx4 v[88:91], v2, s[4:7], s26 offen offset:3072 sc1
    buffer_load_dwordx4 v[92:95], v2, s[4:7], s27 offen sc1
    buffer_load_dwordx4 v[68:71], v2, s[4:7], s83 offen offset:0 sc1
    buffer_load_dwordx4 v[72:75], v2, s[4:7], s83 offen offset:1024 sc1
re_73:
    s_branch alp_70
aok_67:
    s_branch adn_69
aok_68:
adn_69:
    s_waitcnt lgkmcnt(0)
    s_barrier
    s_cmp_ge_u32 s24, 2
    s_cbranch_scc1 V_next
    ds_read2st64_b32 v[24:25], v10 offset0:0 offset1:2
    ds_read2st64_b32 v[26:27], v10 offset0:4 offset1:6
    ds_read2st64_b32 v[28:29], v10 offset0:8 offset1:10
    ds_read2st64_b32 v[30:31], v10 offset0:12 offset1:14
    s_waitcnt lgkmcnt(3)
    v_add_f32 v24, v24, v25
    s_waitcnt lgkmcnt(2)
    v_add_f32 v26, v26, v27
    v_add_f32 v24, v24, v26
    s_waitcnt lgkmcnt(1)
    v_add_f32 v28, v28, v29
    s_waitcnt lgkmcnt(0)
    v_add_f32 v30, v30, v31
    v_add_f32 v28, v28, v30
    v_add_f32 v24, v24, v28
    s_nop 1
    v_mov_b32_dpp v25, v24 quad_perm:[1,0,3,2] row_mask:0xf bank_mask:0xf
    v_cvt_pk_bf16_f32 v24, v24, v25
    v_min_u32 v24, -2, v24
    s_nop 1
    v_mov_b32_dpp v25, v24 row_shl:4 row_mask:0xf bank_mask:0xf
    v_mov_b32_dpp v26, v24 row_shl:8 row_mask:0xf bank_mask:0xf
    v_mov_b32_dpp v27, v24 row_shl:12 row_mask:0xf bank_mask:0xf
    s_mov_b32 exec_lo, 0x50005
    s_mov_b32 exec_hi, 0x50005
    buffer_store_dwordx4 v[24:27], v11, s[4:7], s31 offen sc1
    s_add_u32 s31, s31, 65536
    buffer_store_dwordx4 v[24:27], v11, s[4:7], s31 offen sc1
    s_add_u32 s31, s31, 65536
    buffer_store_dwordx4 v[24:27], v11, s[4:7], s31 offen sc1
    s_add_u32 s31, s31, 65536
    buffer_store_dwordx4 v[24:27], v11, s[4:7], s31 offen sc1
    s_mov_b64 exec, -1
    s_nop 0
V_next:
    s_lshl_b32 s26, s24, 2
    s_add_u32 s26, s26, 8192
    v_mov_b32 v3, s26
    v_mov_b32 v4, s100
    ds_write_b32 v3, v4
    s_waitcnt lgkmcnt(0)
    s_add_u32 s62, s62, 1
    s_add_u32 s69, s69, 262144
    s_cmp_lt_u32 s62, 63
    s_cbranch_scc1 V_loop
    s_endpgm
V_timer:
    s_mov_b32 s74, 0
    s_mov_b32 s84, 96
    s_mov_b32 s85, 0
V_tloop:
    s_add_u32 s70, s62, 0
    s_lshr_b32 s70, s70, 3
    s_xor_b32 s70, s70, s88
    s_and_b32 s70, s70, 1
    s_lshl_b32 s70, s70, 13
    s_add_u32 s70, s70, s69
    s_add_u32 s31, s74, 42
tw2_74:
    s_memrealtime s[92:93]
    s_waitcnt lgkmcnt(0)
    s_sub_u32 s92, s31, s92
    s_sub_u32 s92, s92, 1
    s_cmp_lt_u32 s92, 2000
    s_cbranch_scc1 tw2_74
    s_barrier
    s_cmp_le_u32 s62, 3
    s_cbranch_scc1 va_75
    v_mov_b32 v3, 8192
    ds_read_b128 v[8:11], v3
    s_waitcnt lgkmcnt(0)
    v_max3_u32 v8, v8, v9, v10
    v_max_u32 v8, v8, v11
    s_nop 0
    v_readfirstlane_b32 s26, v8
    s_cmp_eq_u32 s26, 0
    s_nop 2
    s_cbranch_scc1 vb_76
    s_add_u32 s84, s84, 2
    s_min_u32 s84, s84, 146
    s_mov_b32 s85, 0
    s_branch va_75
vb_76:
    s_add_u32 s85, s85, 1
    s_cmp_lt_u32 s85, 4
    s_cbranch_scc1 va_75
    s_mov_b32 s85, 0
    s_sub_u32 s84, s84, 1
    s_max_u32 s84, s84, 66
va_75:
    s_add_u32 s31, s74, 76
tw2_77:
    s_memrealtime s[92:93]
    s_waitcnt lgkmcnt(0)
    s_sub_u32 s92, s31, s92
    s_sub_u32 s92, s92, 1
    s_cmp_lt_u32 s92, 2000
    s_cbranch_scc1 tw2_77
    s_add_u32 s74, s70, 18432
    v_and_b32 v5, 1, v1
    v_lshlrev_b32 v5, 2, v5
    s_mov_b32 s100, 0
    s_nop 3
tw_78:
    buffer_load_dword v6, v5, s[4:7], s74 offen sc1
    s_waitcnt vmcnt(0)
    v_cmp_eq_u32 vcc, -1, v6
    s_nop 3
    s_cbranch_vccz twd_79
    s_cmp_lg_u32 s25, 0
    s_cbranch_scc1 twd_79
    s_add_u32 s100, s100, 1
    s_cmp_lt_u32 s100, 400000
    s_sleep 2
    s_cbranch_scc1 tw_78
    s_mov_b32 s25, 1
    s_lshl_b32 s100, s3, 16
    s_lshl_b32 s101, s62, 8
    s_or_b32 s100, s100, s101
    s_or_b32 s100, s100, 12
    v_mov_b32 v3, s100
    v_mov_b32 v4, 48
    buffer_store_dword v3, v4, s[16:19], 0 offen sc1
    s_nop 3
twd_79:
    v_readfirstlane_b32 s74, v6
    v_readlane_b32 s31, v6, 1
    s_add_u32 s31, s31, s84
    s_nop 2
tw2_80:
    s_memrealtime s[92:93]
    s_waitcnt lgkmcnt(0)
    s_sub_u32 s92, s31, s92
    s_sub_u32 s92, s92, 1
    s_cmp_lt_u32 s92, 2000
    s_cbranch_scc1 tw2_80
    s_barrier
    s_barrier
    s_add_u32 s62, s62, 1
    s_add_u32 s69, s69, 262144
    s_cmp_lt_u32 s62, 63
    s_cbranch_scc1 V_tloop
    s_endpgm
V_jan:
    v_mov_b32 v12, -1
    v_mov_b32 v13, -1
    v_mov_b32 v14, -1
    v_mov_b32 v15, -1
    s_nop 4
V_jloop:
    s_waitcnt vmcnt(0)
    s_barrier
    s_add_u32 s31, s62, 6
    s_cmp_ge_u32 s31, 64
    s_cbranch_scc1 jn_81
    s_mul_i32 s26, s31, 171
    s_lshr_b32 s26, s26, 9
    s_mul_i32 s27, s26, 131072
    s_xor_b32 s26, s26, s88
    s_and_b32 s26, s26, 1
    s_lshl_b32 s26, s26, 13
    s_add_u32 s27, s27, s26
    s_mul_i32 s26, s31, 655360
    s_add_u32 s27, s27, s26
    s_add_u32 s27, s27, 0x4800000
    s_lshl_b32 s26, s63, 14
    s_add_u32 s27, s27, s26
    buffer_store_dwordx4 v[12:15], v2, s[4:7], s27 offen offset:0 sc1
    buffer_store_dwordx4 v[12:15], v2, s[4:7], s27 offen offset:1024 sc1
    buffer_store_dwordx4 v[12:15], v2, s[4:7], s27 offen offset:2048 sc1
    buffer_store_dwordx4 v[12:15], v2, s[4:7], s27 offen offset:3072 sc1
    s_add_u32 s27, s27, 4096
    buffer_store_dwordx4 v[12:15], v2, s[4:7], s27 offen offset:0 sc1
    buffer_store_dwordx4 v[12:15], v2, s[4:7], s27 offen offset:1024 sc1
    buffer_store_dwordx4 v[12:15], v2, s[4:7], s27 offen offset:2048 sc1
    buffer_store_dwordx4 v[12:15], v2, s[4:7], s27 offen offset:3072 sc1
    s_cmp_lt_u32 s31, 8
    s_cbranch_scc1 jn_81
    s_cmp_ge_u32 s63, 32
    s_cbranch_scc1 jn_81
    s_add_u32 s27, s31, 0
    s_lshr_b32 s27, s27, 3
    s_xor_b32 s27, s27, s88
    s_and_b32 s27, s27, 1
    s_lshl_b32 s27, s27, 13
    s_lshl_b32 s26, s31, 18
    s_add_u32 s27, s27, s26
    s_lshr_b32 s26, s63, 1
    s_lshl_b32 s26, s26, 14
    s_add_u32 s27, s27, s26
    s_and_b32 s26, s63, 1
    s_lshl_b32 s26, s26, 12
    s_add_u32 s27, s27, s26
    s_add_u32 s27, s27, 0xe000000
    buffer_store_dwordx4 v[12:15], v2, s[4:7], s27 offen offset:0 sc1
    buffer_store_dwordx4 v[12:15], v2, s[4:7], s27 offen offset:1024 sc1
    buffer_store_dwordx4 v[12:15], v2, s[4:7], s27 offen offset:2048 sc1
    buffer_store_dwordx4 v[12:15], v2, s[4:7], s27 offen offset:3072 sc1
    s_nop 1
jn_81:
    s_barrier
    s_barrier
    s_add_u32 s62, s62, 1
    s_cmp_lt_u32 s62, 63
    s_cbranch_scc1 V_jloop
    s_endpgm
R_YM:
    s_lshl_b32 s68, s63, 7
    s_and_b32 s27, s24, 3
    s_lshl_b32 s27, s27, 2
    s_add_u32 s68, s68, s27
    s_add_u32 s68, s68, 4096
    s_mov_b32 s8, s40
    s_and_b32 s9, s41, 0xffff
    s_mov_b32 s10, 0x780000
    s_mov_b32 s11, 0x20000
    s_mov_b32 s12, s42
    s_and_b32 s13, s43, 0xffff
    s_mov_b32 s14, 0x780000
    s_mov_b32 s15, 0x20000
    s_mul_i32 s64, s63, 384
    s_mul_i32 s67, s63, 245760
    s_and_b32 s30, s24, 3
    s_cmp_ge_u32 s24, 4
    s_cbranch_scc1 vo_82
    s_mul_i32 s29, s30, 96
    v_lshrrev_b32 v3, 4, v1
    v_lshlrev_b32 v3, 3, v3
    v_bfe_u32 v4, v1, 2, 2
    v_add_u32 v3, v3, v4
    v_mul_u32_u24 v3, 416, v3
    v_and_b32 v4, 3, v1
    v_lshl_add_u32 v3, v4, 3, v3
    v_add_u32 v13, s29, v3
    s_nop 3
    s_branch ve_83
vo_82:
    s_mul_i32 s29, s30, 320
    s_add_u32 s29, s29, 39936
    v_lshrrev_b32 v3, 2, v1
    v_mul_u32_u24 v3, 1312, v3
    v_and_b32 v4, 3, v1
    v_lshl_add_u32 v3, v4, 3, v3
    v_add_u32 v13, s29, v3
    s_nop 4
ve_83:
    s_mov_b32 s26, s24
    s_add_u32 s28, s64, 0
stg_84:
    s_min_u32 s27, s26, 38
    s_lshl_b32 s27, s27, 6
    v_add_u32 v10, s27, v1
    s_lshl_b32 s27, s27, 4
    v_mul_u32_u24 v11, 40330, v10
    v_lshrrev_b32 v11, 20, v11
    v_mul_u32_u24 v12, 26, v11
    v_sub_u32 v12, v10, v12
    v_min_u32 v12, 23, v12
    v_mul_u32_u24 v11, 12288, v11
    s_add_u32 m0, s27, 0
    v_lshl_add_u32 v11, v12, 4, v11
    s_add_u32 s26, s26, 8
    buffer_load_dwordx4 v11, s[8:11], s28 offen lds
    s_cmp_lt_u32 s26, 40
    s_nop 0
    s_cbranch_scc1 stg_84
    s_mov_b32 s26, s24
    s_add_u32 s28, s67, 0
stg_85:
    s_min_u32 s27, s26, 40
    s_lshl_b32 s27, s27, 6
    v_add_u32 v10, s27, v1
    s_lshl_b32 s27, s27, 4
    v_mul_u32_u24 v11, 12788, v10
    v_lshrrev_b32 v11, 20, v11
    v_mul_u32_u24 v12, 82, v11
    v_sub_u32 v12, v10, v12
    v_min_u32 v12, 79, v12
    v_mul_u32_u24 v11, 1280, v11
    s_add_u32 m0, s27, 39936
    v_lshl_add_u32 v11, v12, 4, v11
    s_add_u32 s26, s26, 8
    buffer_load_dwordx4 v11, s[12:15], s28 offen lds
    s_cmp_lt_u32 s26, 48
    s_nop 0
    s_cbranch_scc1 stg_85
    s_mov_b32 s26, s24
    s_add_u32 s28, s64, 1179648
stg_86:
    s_min_u32 s27, s26, 38
    s_lshl_b32 s27, s27, 6
    v_add_u32 v10, s27, v1
    s_lshl_b32 s27, s27, 4
    v_mul_u32_u24 v11, 40330, v10
    v_lshrrev_b32 v11, 20, v11
    v_mul_u32_u24 v12, 26, v11
    v_sub_u32 v12, v10, v12
    v_min_u32 v12, 23, v12
    v_mul_u32_u24 v11, 12288, v11
    s_add_u32 m0, s27, 81920
    v_lshl_add_u32 v11, v12, 4, v11
    s_add_u32 s26, s26, 8
    buffer_load_dwordx4 v11, s[8:11], s28 offen lds
    s_cmp_lt_u32 s26, 40
    s_nop 0
    s_cbranch_scc1 stg_86
    s_mov_b32 s26, s24
    s_add_u32 s28, s67, 40960
stg_87:
    s_min_u32 s27, s26, 40
    s_lshl_b32 s27, s27, 6
    v_add_u32 v10, s27, v1
    s_lshl_b32 s27, s27, 4
    v_mul_u32_u24 v11, 12788, v10
    v_lshrrev_b32 v11, 20, v11
    v_mul_u32_u24 v12, 82, v11
    v_sub_u32 v12, v10, v12
    v_min_u32 v12, 79, v12
    v_mul_u32_u24 v11, 1280, v11
    s_add_u32 m0, s27, 121856
    v_lshl_add_u32 v11, v12, 4, v11
    s_add_u32 s26, s26, 8
    buffer_load_dwordx4 v11, s[12:15], s28 offen lds
    s_cmp_lt_u32 s26, 48
    s_nop 0
    s_cbranch_scc1 stg_87
    s_waitcnt vmcnt(11)
    s_barrier
    s_cmp_ge_u32 s24, 4
    s_cbranch_scc1 vo_88
    v_add_u32 v14, 0, v13
    ds_read_b64_tr_b16 a[0:1], v14 offset:0
    ds_read_b64_tr_b16 a[2:3], v14 offset:1664
    ds_read_b64_tr_b16 a[8:9], v14 offset:32
    ds_read_b64_tr_b16 a[10:11], v14 offset:1696
    ds_read_b64_tr_b16 a[16:17], v14 offset:64
    ds_read_b64_tr_b16 a[18:19], v14 offset:1728
    ds_read_b64_tr_b16 a[4:5], v14 offset:13312
    ds_read_b64_tr_b16 a[6:7], v14 offset:14976
    ds_read_b64_tr_b16 a[12:13], v14 offset:13344
    ds_read_b64_tr_b16 a[14:15], v14 offset:15008
    ds_read_b64_tr_b16 a[20:21], v14 offset:13376
    ds_read_b64_tr_b16 a[22:23], v14 offset:15040
    ds_read_b64_tr_b16 a[24:25], v14 offset:26624
    ds_read_b64_tr_b16 a[26:27], v14 offset:28288
    ds_read_b64_tr_b16 a[32:33], v14 offset:26656
    ds_read_b64_tr_b16 a[34:35], v14 offset:28320
    ds_read_b64_tr_b16 a[40:41], v14 offset:26688
    ds_read_b64_tr_b16 a[42:43], v14 offset:28352
    s_branch ve_89
vo_88:
    v_add_u32 v14, 0, v13
    ds_read_b64_tr_b16 a[0:1], v14 offset:0
    ds_read_b64_tr_b16 a[2:3], v14 offset:20992
    ds_read_b64_tr_b16 a[8:9], v14 offset:32
    ds_read_b64_tr_b16 a[10:11], v14 offset:21024
    ds_read_b64_tr_b16 a[16:17], v14 offset:64
    ds_read_b64_tr_b16 a[18:19], v14 offset:21056
    ds_read_b64_tr_b16 a[24:25], v14 offset:96
    ds_read_b64_tr_b16 a[26:27], v14 offset:21088
    ds_read_b64_tr_b16 a[32:33], v14 offset:128
    ds_read_b64_tr_b16 a[34:35], v14 offset:21120
    ds_read_b64_tr_b16 a[40:41], v14 offset:160
    ds_read_b64_tr_b16 a[42:43], v14 offset:21152
    ds_read_b64_tr_b16 a[48:49], v14 offset:192
    ds_read_b64_tr_b16 a[50:51], v14 offset:21184
    ds_read_b64_tr_b16 a[56:57], v14 offset:224
    ds_read_b64_tr_b16 a[58:59], v14 offset:21216
    ds_read_b64_tr_b16 v[16:17], v14 offset:256
    ds_read_b64_tr_b16 v[18:19], v14 offset:21248
    ds_read_b64_tr_b16 v[24:25], v14 offset:288
    ds_read_b64_tr_b16 v[26:27], v14 offset:21280
ve_89:
    s_waitcnt lgkmcnt(0)
    s_barrier
    s_mov_b32 s26, s24
    s_add_u32 s28, s64, 2359296
stg_90:
    s_min_u32 s27, s26, 38
    s_lshl_b32 s27, s27, 6
    v_add_u32 v10, s27, v1
    s_lshl_b32 s27, s27, 4
    v_mul_u32_u24 v11, 40330, v10
    v_lshrrev_b32 v11, 20, v11
    v_mul_u32_u24 v12, 26, v11
    v_sub_u32 v12, v10, v12
    v_min_u32 v12, 23, v12
    v_mul_u32_u24 v11, 12288, v11
    s_add_u32 m0, s27, 0
    v_lshl_add_u32 v11, v12, 4, v11
    s_add_u32 s26, s26, 8
    buffer_load_dwordx4 v11, s[8:11], s28 offen lds
    s_cmp_lt_u32 s26, 40
    s_nop 0
    s_cbranch_scc1 stg_90
    s_mov_b32 s26, s24
    s_add_u32 s28, s67, 81920
stg_91:
    s_min_u32 s27, s26, 40
    s_lshl_b32 s27, s27, 6
    v_add_u32 v10, s27, v1
    s_lshl_b32 s27, s27, 4
    v_mul_u32_u24 v11, 12788, v10
    v_lshrrev_b32 v11, 20, v11
    v_mul_u32_u24 v12, 82, v11
    v_sub_u32 v12, v10, v12
    v_min_u32 v12, 79, v12
    v_mul_u32_u24 v11, 1280, v11
    s_add_u32 m0, s27, 39936
    v_lshl_add_u32 v11, v12, 4, v11
    s_add_u32 s26, s26, 8
    buffer_load_dwordx4 v11, s[12:15], s28 offen lds
    s_cmp_lt_u32 s26, 48
    s_nop 0
    s_cbranch_scc1 stg_91
    s_waitcnt vmcnt(11)
    s_barrier
    s_cmp_ge_u32 s24, 4
    s_cbranch_scc1 vo_92
    v_add_u32 v14, 81920, v13
    ds_read_b64_tr_b16 a[28:29], v14 offset:0
    ds_read_b64_tr_b16 a[30:31], v14 offset:1664
    ds_read_b64_tr_b16 a[36:37], v14 offset:32
    ds_read_b64_tr_b16 a[38:39], v14 offset:1696
    ds_read_b64_tr_b16 a[44:45], v14 offset:64
    ds_read_b64_tr_b16 a[46:47], v14 offset:1728
    ds_read_b64_tr_b16 a[48:49], v14 offset:13312
    ds_read_b64_tr_b16 a[50:51], v14 offset:14976
    ds_read_b64_tr_b16 a[56:57], v14 offset:13344
    ds_read_b64_tr_b16 a[58:59], v14 offset:15008
    ds_read_b64_tr_b16 a[64:65], v14 offset:13376
    ds_read_b64_tr_b16 a[66:67], v14 offset:15040
    ds_read_b64_tr_b16 a[52:53], v14 offset:26624
    ds_read_b64_tr_b16 a[54:55], v14 offset:28288
    ds_read_b64_tr_b16 a[60:61], v14 offset:26656
    ds_read_b64_tr_b16 a[62:63], v14 offset:28320
    ds_read_b64_tr_b16 a[68:69], v14 offset:26688
    ds_read_b64_tr_b16 a[70:71], v14 offset:28352
    s_branch ve_93
vo_92:
    v_add_u32 v14, 81920, v13
    ds_read_b64_tr_b16 a[4:5], v14 offset:0
    ds_read_b64_tr_b16 a[6:7], v14 offset:20992
    ds_read_b64_tr_b16 a[12:13], v14 offset:32
    ds_read_b64_tr_b16 a[14:15], v14 offset:21024
    ds_read_b64_tr_b16 a[20:21], v14 offset:64
    ds_read_b64_tr_b16 a[22:23], v14 offset:21056
    ds_read_b64_tr_b16 a[28:29], v14 offset:96
    ds_read_b64_tr_b16 a[30:31], v14 offset:21088
    ds_read_b64_tr_b16 a[36:37], v14 offset:128
    ds_read_b64_tr_b16 a[38:39], v14 offset:21120
    ds_read_b64_tr_b16 a[44:45], v14 offset:160
    ds_read_b64_tr_b16 a[46:47], v14 offset:21152
    ds_read_b64_tr_b16 a[52:53], v14 offset:192
    ds_read_b64_tr_b16 a[54:55], v14 offset:21184
    ds_read_b64_tr_b16 a[60:61], v14 offset:224
    ds_read_b64_tr_b16 a[62:63], v14 offset:21216
    ds_read_b64_tr_b16 v[20:21], v14 offset:256
    ds_read_b64_tr_b16 v[22:23], v14 offset:21248
    ds_read_b64_tr_b16 v[28:29], v14 offset:288
    ds_read_b64_tr_b16 v[30:31], v14 offset:21280
ve_93:
    s_waitcnt lgkmcnt(0)
    s_barrier
    s_mov_b32 s26, s24
    s_add_u32 s28, s64, 3538944
stg_94:
    s_min_u32 s27, s26, 38
    s_lshl_b32 s27, s27, 6
    v_add_u32 v10, s27, v1
    s_lshl_b32 s27, s27, 4
    v_mul_u32_u24 v11, 40330, v10
    v_lshrrev_b32 v11, 20, v11
    v_mul_u32_u24 v12, 26, v11
    v_sub_u32 v12, v10, v12
    v_min_u32 v12, 23, v12
    v_mul_u32_u24 v11, 12288, v11
    s_add_u32 m0, s27, 81920
    v_lshl_add_u32 v11, v12, 4, v11
    s_add_u32 s26, s26, 8
    buffer_load_dwordx4 v11, s[8:11], s28 offen lds
    s_cmp_lt_u32 s26, 40
    s_nop 0
    s_cbranch_scc1 stg_94
    s_mov_b32 s26, s24
    s_add_u32 s28, s67, 122880
stg_95:
    s_min_u32 s27, s26, 40
    s_lshl_b32 s27, s27, 6
    v_add_u32 v10, s27, v1
    s_lshl_b32 s27, s27, 4
    v_mul_u32_u24 v11, 12788, v10
    v_lshrrev_b32 v11, 20, v11
    v_mul_u32_u24 v12, 82, v11
    v_sub_u32 v12, v10, v12
    v_min_u32 v12, 79, v12
    v_mul_u32_u24 v11, 1280, v11
    s_add_u32 m0, s27, 121856
    v_lshl_add_u32 v11, v12, 4, v11
    s_add_u32 s26, s26, 8
    buffer_load_dwordx4 v11, s[12:15], s28 offen lds
    s_cmp_lt_u32 s26, 48
    s_nop 0
    s_cbranch_scc1 stg_95
    s_waitcnt vmcnt(11)
    s_barrier
    s_cmp_ge_u32 s24, 4
    s_cbranch_scc1 vo_96
    v_add_u32 v14, 0, v13
    ds_read_b64_tr_b16 a[72:73], v14 offset:0
    ds_read_b64_tr_b16 a[74:75], v14 offset:1664
    ds_read_b64_tr_b16 a[80:81], v14 offset:32
    ds_read_b64_tr_b16 a[82:83], v14 offset:1696
    ds_read_b64_tr_b16 a[88:89], v14 offset:64
    ds_read_b64_tr_b16 a[90:91], v14 offset:1728
    ds_read_b64_tr_b16 a[76:77], v14 offset:13312
    ds_read_b64_tr_b16 a[78:79], v14 offset:14976
    ds_read_b64_tr_b16 a[84:85], v14 offset:13344
    ds_read_b64_tr_b16 a[86:87], v14 offset:15008
    ds_read_b64_tr_b16 a[92:93], v14 offset:13376
    ds_read_b64_tr_b16 a[94:95], v14 offset:15040
    ds_read_b64_tr_b16 a[96:97], v14 offset:26624
    ds_read_b64_tr_b16 a[98:99], v14 offset:28288
    ds_read_b64_tr_b16 a[104:105], v14 offset:26656
    ds_read_b64_tr_b16 a[106:107], v14 offset:28320
    ds_read_b64_tr_b16 a[112:113], v14 offset:26688
    ds_read_b64_tr_b16 a[114:115], v14 offset:28352
    s_branch ve_97
vo_96:
    v_add_u32 v14, 0, v13
    ds_read_b64_tr_b16 a[64:65], v14 offset:0
    ds_read_b64_tr_b16 a[66:67], v14 offset:20992
    ds_read_b64_tr_b16 a[72:73], v14 offset:32
    ds_read_b64_tr_b16 a[74:75], v14 offset:21024
    ds_read_b64_tr_b16 a[80:81], v14 offset:64
    ds_read_b64_tr_b16 a[82:83], v14 offset:21056
    ds_read_b64_tr_b16 v[64:65], v14 offset:96
    ds_read_b64_tr_b16 v[66:67], v14 offset:21088
    ds_read_b64_tr_b16 a[88:89], v14 offset:128
    ds_read_b64_tr_b16 a[90:91], v14 offset:21120
    ds_read_b64_tr_b16 a[96:97], v14 offset:160
    ds_read_b64_tr_b16 a[98:99], v14 offset:21152
    ds_read_b64_tr_b16 a[104:105], v14 offset:192
    ds_read_b64_tr_b16 a[106:107], v14 offset:21184
    ds_read_b64_tr_b16 a[112:113], v14 offset:224
    ds_read_b64_tr_b16 a[114:115], v14 offset:21216
    ds_read_b64_tr_b16 v[32:33], v14 offset:256
    ds_read_b64_tr_b16 v[34:35], v14 offset:21248
    ds_read_b64_tr_b16 v[40:41], v14 offset:288
    ds_read_b64_tr_b16 v[42:43], v14 offset:21280
ve_97:
    s_waitcnt lgkmcnt(0)
    s_barrier
    s_mov_b32 s26, s24
    s_add_u32 s28, s64, 4718592
stg_98:
    s_min_u32 s27, s26, 38
    s_lshl_b32 s27, s27, 6
    v_add_u32 v10, s27, v1
    s_lshl_b32 s27, s27, 4
    v_mul_u32_u24 v11, 40330, v10
    v_lshrrev_b32 v11, 20, v11
    v_mul_u32_u24 v12, 26, v11
    v_sub_u32 v12, v10, v12
    v_min_u32 v12, 23, v12
    v_mul_u32_u24 v11, 12288, v11
    s_add_u32 m0, s27, 0
    v_lshl_add_u32 v11, v12, 4, v11
    s_add_u32 s26, s26, 8
    buffer_load_dwordx4 v11, s[8:11], s28 offen lds
    s_cmp_lt_u32 s26, 40
    s_nop 0
    s_cbranch_scc1 stg_98
    s_mov_b32 s26, s24
    s_add_u32 s28, s67, 163840
stg_99:
    s_min_u32 s27, s26, 40
    s_lshl_b32 s27, s27, 6
    v_add_u32 v10, s27, v1
    s_lshl_b32 s27, s27, 4
    v_mul_u32_u24 v11, 12788, v10
    v_lshrrev_b32 v11, 20, v11
    v_mul_u32_u24 v12, 82, v11
    v_sub_u32 v12, v10, v12
    v_min_u32 v12, 79, v12
    v_mul_u32_u24 v11, 1280, v11
    s_add_u32 m0, s27, 39936
    v_lshl_add_u32 v11, v12, 4, v11
    s_add_u32 s26, s26, 8
    buffer_load_dwordx4 v11, s[12:15], s28 offen lds
    s_cmp_lt_u32 s26, 48
    s_nop 0
    s_cbranch_scc1 stg_99
    s_waitcnt vmcnt(11)
    s_barrier
    s_cmp_ge_u32 s24, 4
    s_cbranch_scc1 vo_100
    v_add_u32 v14, 81920, v13
    ds_read_b64_tr_b16 a[100:101], v14 offset:0
    ds_read_b64_tr_b16 a[102:103], v14 offset:1664
    ds_read_b64_tr_b16 a[108:109], v14 offset:32
    ds_read_b64_tr_b16 a[110:111], v14 offset:1696
    ds_read_b64_tr_b16 a[116:117], v14 offset:64
    ds_read_b64_tr_b16 a[118:119], v14 offset:1728
    ds_read_b64_tr_b16 a[120:121], v14 offset:13312
    ds_read_b64_tr_b16 a[122:123], v14 offset:14976
    ds_read_b64_tr_b16 a[128:129], v14 offset:13344
    ds_read_b64_tr_b16 a[130:131], v14 offset:15008
    ds_read_b64_tr_b16 a[136:137], v14 offset:13376
    ds_read_b64_tr_b16 a[138:139], v14 offset:15040
    ds_read_b64_tr_b16 a[124:125], v14 offset:26624
    ds_read_b64_tr_b16 a[126:127], v14 offset:28288
    ds_read_b64_tr_b16 a[132:133], v14 offset:26656
    ds_read_b64_tr_b16 a[134:135], v14 offset:28320
    ds_read_b64_tr_b16 a[140:141], v14 offset:26688
    ds_read_b64_tr_b16 a[142:143], v14 offset:28352
    s_branch ve_101
vo_100:
    v_add_u32 v14, 81920, v13
    ds_read_b64_tr_b16 a[68:69], v14 offset:0
    ds_read_b64_tr_b16 a[70:71], v14 offset:20992
    ds_read_b64_tr_b16 a[76:77], v14 offset:32
    ds_read_b64_tr_b16 a[78:79], v14 offset:21024
    ds_read_b64_tr_b16 a[84:85], v14 offset:64
    ds_read_b64_tr_b16 a[86:87], v14 offset:21056
    ds_read_b64_tr_b16 v[68:69], v14 offset:96
    ds_read_b64_tr_b16 v[70:71], v14 offset:21088
    ds_read_b64_tr_b16 a[92:93], v14 offset:128
    ds_read_b64_tr_b16 a[94:95], v14 offset:21120
    ds_read_b64_tr_b16 a[100:101], v14 offset:160
    ds_read_b64_tr_b16 a[102:103], v14 offset:21152
    ds_read_b64_tr_b16 a[108:109], v14 offset:192
    ds_read_b64_tr_b16 a[110:111], v14 offset:21184
    ds_read_b64_tr_b16 a[116:117], v14 offset:224
    ds_read_b64_tr_b16 a[118:119], v14 offset:21216
    ds_read_b64_tr_b16 v[36:37], v14 offset:256
    ds_read_b64_tr_b16 v[38:39], v14 offset:21248
    ds_read_b64_tr_b16 v[44:45], v14 offset:288
    ds_read_b64_tr_b16 v[46:47], v14 offset:21280
ve_101:
    s_waitcnt lgkmcnt(0)
    s_barrier
    s_mov_b32 s26, s24
    s_add_u32 s28, s64, 5898240
stg_102:
    s_min_u32 s27, s26, 38
    s_lshl_b32 s27, s27, 6
    v_add_u32 v10, s27, v1
    s_lshl_b32 s27, s27, 4
    v_mul_u32_u24 v11, 40330, v10
    v_lshrrev_b32 v11, 20, v11
    v_mul_u32_u24 v12, 26, v11
    v_sub_u32 v12, v10, v12
    v_min_u32 v12, 23, v12
    v_mul_u32_u24 v11, 12288, v11
    s_add_u32 m0, s27, 81920
    v_lshl_add_u32 v11, v12, 4, v11
    s_add_u32 s26, s26, 8
    buffer_load_dwordx4 v11, s[8:11], s28 offen lds
    s_cmp_lt_u32 s26, 40
    s_nop 0
    s_cbranch_scc1 stg_102
    s_mov_b32 s26, s24
    s_add_u32 s28, s67, 204800
stg_103:
    s_min_u32 s27, s26, 40
    s_lshl_b32 s27, s27, 6
    v_add_u32 v10, s27, v1
    s_lshl_b32 s27, s27, 4
    v_mul_u32_u24 v11, 12788, v10
    v_lshrrev_b32 v11, 20, v11
    v_mul_u32_u24 v12, 82, v11
    v_sub_u32 v12, v10, v12
    v_min_u32 v12, 79, v12
    v_mul_u32_u24 v11, 1280, v11
    s_add_u32 m0, s27, 121856
    v_lshl_add_u32 v11, v12, 4, v11
    s_add_u32 s26, s26, 8
    buffer_load_dwordx4 v11, s[12:15], s28 offen lds
    s_cmp_lt_u32 s26, 48
    s_nop 0
    s_cbranch_scc1 stg_103
    s_waitcnt vmcnt(11)
    s_barrier
    s_cmp_ge_u32 s24, 4
    s_cbranch_scc1 vo_104
    v_add_u32 v14, 0, v13
    ds_read_b64_tr_b16 a[144:145], v14 offset:0
    ds_read_b64_tr_b16 a[146:147], v14 offset:1664
    ds_read_b64_tr_b16 a[152:153], v14 offset:32
    ds_read_b64_tr_b16 a[154:155], v14 offset:1696
    ds_read_b64_tr_b16 v[72:73], v14 offset:64
    ds_read_b64_tr_b16 v[74:75], v14 offset:1728
    ds_read_b64_tr_b16 a[148:149], v14 offset:13312
    ds_read_b64_tr_b16 a[150:151], v14 offset:14976
    ds_read_b64_tr_b16 a[156:157], v14 offset:13344
    ds_read_b64_tr_b16 a[158:159], v14 offset:15008
    ds_read_b64_tr_b16 v[76:77], v14 offset:13376
    ds_read_b64_tr_b16 v[78:79], v14 offset:15040
    ds_read_b64_tr_b16 v[80:81], v14 offset:26624
    ds_read_b64_tr_b16 v[82:83], v14 offset:28288
    ds_read_b64_tr_b16 v[88:89], v14 offset:26656
    ds_read_b64_tr_b16 v[90:91], v14 offset:28320
    ds_read_b64_tr_b16 v[16:17], v14 offset:26688
    ds_read_b64_tr_b16 v[18:19], v14 offset:28352
    s_branch ve_105
vo_104:
    v_add_u32 v14, 0, v13
    ds_read_b64_tr_b16 a[120:121], v14 offset:0
    ds_read_b64_tr_b16 a[122:123], v14 offset:20992
    ds_read_b64_tr_b16 a[128:129], v14 offset:32
    ds_read_b64_tr_b16 a[130:131], v14 offset:21024
    ds_read_b64_tr_b16 a[136:137], v14 offset:64
    ds_read_b64_tr_b16 a[138:139], v14 offset:21056
    ds_read_b64_tr_b16 a[144:145], v14 offset:96
    ds_read_b64_tr_b16 a[146:147], v14 offset:21088
    ds_read_b64_tr_b16 a[152:153], v14 offset:128
    ds_read_b64_tr_b16 a[154:155], v14 offset:21120
    ds_read_b64_tr_b16 v[72:73], v14 offset:160
    ds_read_b64_tr_b16 v[74:75], v14 offset:21152
    ds_read_b64_tr_b16 v[80:81], v14 offset:192
    ds_read_b64_tr_b16 v[82:83], v14 offset:21184
    ds_read_b64_tr_b16 v[88:89], v14 offset:224
    ds_read_b64_tr_b16 v[90:91], v14 offset:21216
    ds_read_b64_tr_b16 v[48:49], v14 offset:256
    ds_read_b64_tr_b16 v[50:51], v14 offset:21248
    ds_read_b64_tr_b16 v[56:57], v14 offset:288
    ds_read_b64_tr_b16 v[58:59], v14 offset:21280
ve_105:
    s_waitcnt lgkmcnt(0)
    s_barrier
    s_mov_b32 s26, s24
    s_add_u32 s28, s64, 7077888
stg_106:
    s_min_u32 s27, s26, 25
    s_lshl_b32 s27, s27, 6
    v_add_u32 v10, s27, v1
    s_lshl_b32 s27, s27, 4
    v_mul_u32_u24 v11, 40330, v10
    v_lshrrev_b32 v11, 20, v11
    v_mul_u32_u24 v12, 26, v11
    v_sub_u32 v12, v10, v12
    v_min_u32 v12, 23, v12
    v_mul_u32_u24 v11, 12288, v11
    s_add_u32 m0, s27, 0
    v_lshl_add_u32 v11, v12, 4, v11
    s_add_u32 s26, s26, 8
    buffer_load_dwordx4 v11, s[8:11], s28 offen lds
    s_cmp_lt_u32 s26, 32
    s_nop 0
    s_cbranch_scc1 stg_106
    s_cmp_lg_u32 s24, 0
    s_cbranch_scc1 wst_107
    v_and_b32 v5, 3, v1
    v_lshlrev_b32 v5, 6, v5
    s_mov_b32 s100, 0
    s_nop 3
poll_108:
    buffer_load_dword v6, v5, s[16:19], 0 offen sc1
    s_waitcnt vmcnt(0)
    v_cmp_gt_u32 vcc, 32, v6
    s_nop 3
    s_cbranch_vccz polld_109
    s_cmp_lg_u32 s25, 0
    s_cbranch_scc1 polld_109
    s_add_u32 s100, s100, 1
    s_cmp_lt_u32 s100, 400000
    s_sleep 8
    s_cbranch_scc1 poll_108
    s_mov_b32 s25, 1
    s_lshl_b32 s100, s3, 16
    s_lshl_b32 s101, s62, 8
    s_or_b32 s100, s100, s101
    s_or_b32 s100, s100, 1
    v_mov_b32 v3, s100
    v_mov_b32 v4, 36
    buffer_store_dword v3, v4, s[16:19], 0 offen sc1
    s_nop 3
polld_109:
wst_107:
    s_barrier
    v_mov_b32 v5, 8
    s_mov_b32 s100, 0
    s_nop 3
poll_110:
    buffer_load_dword v6, v5, s[16:19], 0 offen sc1
    s_waitcnt vmcnt(0)
    v_cmp_gt_u32 vcc, 64, v6
    s_nop 3
    s_cbranch_vccz polld_111
    s_cmp_lg_u32 s25, 0
    s_cbranch_scc1 polld_111
    s_add_u32 s100, s100, 1
    s_cmp_lt_u32 s100, 400000
    s_sleep 8
    s_cbranch_scc1 poll_110
    s_mov_b32 s25, 1
    s_lshl_b32 s100, s3, 16
    s_lshl_b32 s101, s62, 8
    s_or_b32 s100, s100, s101
    s_or_b32 s100, s100, 2
    v_mov_b32 v3, s100
    v_mov_b32 v4, 40
    buffer_store_dword v3, v4, s[16:19], 0 offen sc1
    s_nop 3
polld_111:
    v_readfirstlane_b32 s26, v6
    s_and_b32 s88, s26, 1
    s_xor_b32 s89, s88, 1
    s_lshl_b32 s89, s89, 13
    s_xor_b32 s91, s89, 8192
    s_mov_b32 s90, 0
    s_waitcnt vmcnt(4)
    s_barrier
    s_cmp_ge_u32 s24, 4
    s_cbranch_scc1 vo_112
    v_add_u32 v14, 81920, v13
    ds_read_b64_tr_b16 v[84:85], v14 offset:0
    ds_read_b64_tr_b16 v[86:87], v14 offset:1664
    ds_read_b64_tr_b16 v[92:93], v14 offset:32
    ds_read_b64_tr_b16 v[94:95], v14 offset:1696
    ds_read_b64_tr_b16 v[20:21], v14 offset:64
    ds_read_b64_tr_b16 v[22:23], v14 offset:1728
    ds_read_b64_tr_b16 v[24:25], v14 offset:13312
    ds_read_b64_tr_b16 v[26:27], v14 offset:14976
    ds_read_b64_tr_b16 v[32:33], v14 offset:13344
    ds_read_b64_tr_b16 v[34:35], v14 offset:15008
    ds_read_b64_tr_b16 v[40:41], v14 offset:13376
    ds_read_b64_tr_b16 v[42:43], v14 offset:15040
    ds_read_b64_tr_b16 v[28:29], v14 offset:26624
    ds_read_b64_tr_b16 v[30:31], v14 offset:28288
    ds_read_b64_tr_b16 v[36:37], v14 offset:26656
    ds_read_b64_tr_b16 v[38:39], v14 offset:28320
    ds_read_b64_tr_b16 v[44:45], v14 offset:26688
    ds_read_b64_tr_b16 v[46:47], v14 offset:28352
    s_branch ve_113
vo_112:
    v_add_u32 v14, 81920, v13
    ds_read_b64_tr_b16 a[124:125], v14 offset:0
    ds_read_b64_tr_b16 a[126:127], v14 offset:20992
    ds_read_b64_tr_b16 a[132:133], v14 offset:32
    ds_read_b64_tr_b16 a[134:135], v14 offset:21024
    ds_read_b64_tr_b16 a[140:141], v14 offset:64
    ds_read_b64_tr_b16 a[142:143], v14 offset:21056
    ds_read_b64_tr_b16 a[148:149], v14 offset:96
    ds_read_b64_tr_b16 a[150:151], v14 offset:21088
    ds_read_b64_tr_b16 a[156:157], v14 offset:128
    ds_read_b64_tr_b16 a[158:159], v14 offset:21120
    ds_read_b64_tr_b16 v[76:77], v14 offset:160
    ds_read_b64_tr_b16 v[78:79], v14 offset:21152
    ds_read_b64_tr_b16 v[84:85], v14 offset:192
    ds_read_b64_tr_b16 v[86:87], v14 offset:21184
    ds_read_b64_tr_b16 v[92:93], v14 offset:224
    ds_read_b64_tr_b16 v[94:95], v14 offset:21216
    ds_read_b64_tr_b16 v[52:53], v14 offset:256
    ds_read_b64_tr_b16 v[54:55], v14 offset:21248
    ds_read_b64_tr_b16 v[60:61], v14 offset:288
    ds_read_b64_tr_b16 v[62:63], v14 offset:21280
ve_113:
    s_waitcnt lgkmcnt(0)
    s_barrier
    s_waitcnt vmcnt(0)
    s_barrier
    s_cmp_ge_u32 s24, 4
    s_cbranch_scc1 vo_114
    v_add_u32 v14, 0, v13
    ds_read_b64_tr_b16 v[48:49], v14 offset:0
    ds_read_b64_tr_b16 v[50:51], v14 offset:1664
    ds_read_b64_tr_b16 v[56:57], v14 offset:32
    ds_read_b64_tr_b16 v[58:59], v14 offset:1696
    ds_read_b64_tr_b16 v[64:65], v14 offset:64
    ds_read_b64_tr_b16 v[66:67], v14 offset:1728
    ds_read_b64_tr_b16 v[52:53], v14 offset:13312
    ds_read_b64_tr_b16 v[54:55], v14 offset:14976
    ds_read_b64_tr_b16 v[60:61], v14 offset:13344
    ds_read_b64_tr_b16 v[62:63], v14 offset:15008
    ds_read_b64_tr_b16 v[68:69], v14 offset:13376
    ds_read_b64_tr_b16 v[70:71], v14 offset:15040
    s_branch ve_115
vo_114:
ve_115:
    s_waitcnt lgkmcnt(0)
    s_barrier
    s_mul_i32 s26, s24, 14336
    v_add_u32 v3, s26, v2
    ds_write_b128 v3, v[16:19] offset:0
    ds_write_b128 v3, v[20:23] offset:1024
    ds_write_b128 v3, v[24:27] offset:2048
    ds_write_b128 v3, v[28:31] offset:3072
    ds_write_b128 v3, v[32:35] offset:4096
    ds_write_b128 v3, v[36:39] offset:5120
    ds_write_b128 v3, v[40:43] offset:6144
    ds_write_b128 v3, v[44:47] offset:7168
    ds_write_b128 v3, v[48:51] offset:8192
    ds_write_b128 v3, v[52:55] offset:9216
    ds_write_b128 v3, v[56:59] offset:10240
    ds_write_b128 v3, v[60:63] offset:11264
    ds_write_b128 v3, v[64:67] offset:12288
    ds_write_b128 v3, v[68:71] offset:13312
    s_waitcnt lgkmcnt(0)
    v_mov_b32 v68, v3
    v_and_b32 v3, 48, v1
    v_bfe_u32 v4, v1, 1, 2
    v_lshl_add_u32 v3, v4, 2, v3
    v_bfe_u32 v4, v1, 3, 1
    v_lshl_add_u32 v3, v4, 1, v3
    v_and_b32 v4, 1, v1
    v_add_u32 v3, v3, v4
    v_lshlrev_b32 v10, 4, v3
    v_add_u32 v10, 114688, v10
    v_bfe_u32 v5, v1, 1, 1
    v_mov_b32 v3, 0x4444
    v_mov_b32 v4, 0xeeee
    v_cmp_eq_u32 vcc, 1, v5
    s_nop 1
    v_cndmask_b32 v11, v3, v4, vcc
    v_add_u32 v9, 114688, v2
    v_bfe_u32 v3, v1, 3, 1
    v_lshlrev_b32 v3, 8, v3
    v_lshrrev_b32 v4, 4, v1
    v_lshl_add_u32 v3, v4, 6, v3
    v_bfe_u32 v4, v1, 1, 1
    v_lshl_add_u32 v3, v4, 5, v3
    v_bfe_u32 v4, v1, 2, 1
    v_lshl_add_u32 v3, v4, 3, v3
    v_and_b32 v4, 1, v1
    v_lshl_add_u32 v3, v4, 1, v3
    v_add_u32 v69, 124928, v3
    v_add_u32 v70, 124928, v2
    v_lshrrev_b32 v3, 4, v1
    v_lshlrev_b32 v3, 14, v3
    v_and_b32 v4, 15, v1
    v_lshl_add_u32 v71, v4, 4, v3
    s_and_b32 s26, s24, 3
    s_mul_i32 s26, s26, 3
    s_add_u32 s27, s26, 0
    s_lshr_b32 s28, s27, 1
    s_lshl_b32 s78, s28, 9
    s_lshl_b32 s81, s28, 10
    s_and_b32 s28, s27, 1
    s_lshl_b32 s29, s28, 2
    s_add_u32 s78, s78, s29
    s_lshl_b32 s29, s28, 3
    s_add_u32 s81, s81, s29
    s_add_u32 s27, s26, 1
    s_lshr_b32 s28, s27, 1
    s_lshl_b32 s79, s28, 9
    s_lshl_b32 s82, s28, 10
    s_and_b32 s28, s27, 1
    s_lshl_b32 s29, s28, 2
    s_add_u32 s79, s79, s29
    s_lshl_b32 s29, s28, 3
    s_add_u32 s82, s82, s29
    s_add_u32 s27, s26, 2
    s_lshr_b32 s28, s27, 1
    s_lshl_b32 s80, s28, 9
    s_lshl_b32 s83, s28, 10
    s_and_b32 s28, s27, 1
    s_lshl_b32 s29, s28, 2
    s_add_u32 s80, s80, s29
    s_lshl_b32 s29, s28, 3
    s_add_u32 s83, s83, s29
    s_and_b32 s26, s24, 3
    s_mul_i32 s26, s26, 3
    s_add_u32 s27, s26, 0
    s_min_u32 s27, s27, 9
    s_lshl_b32 s74, s27, 10
    s_lshr_b32 s27, s27, 3
    s_lshl_b32 s27, s27, 13
    s_add_u32 s71, s74, s27
    s_add_u32 s27, s26, 1
    s_min_u32 s27, s27, 9
    s_lshl_b32 s75, s27, 10
    s_lshr_b32 s27, s27, 3
    s_lshl_b32 s27, s27, 13
    s_add_u32 s72, s75, s27
    s_add_u32 s27, s26, 2
    s_min_u32 s27, s27, 9
    s_lshl_b32 s76, s27, 10
    s_lshr_b32 s27, s27, 3
    s_lshl_b32 s27, s27, 13
    s_add_u32 s73, s76, s27
    v_lshlrev_b32 v3, 2, v1
    v_add_u32 v3, 128000, v3
    v_mov_b32 v4, 0
    ds_write_b32 v3, v4
    s_waitcnt lgkmcnt(0)
    s_barrier
    s_cmp_lg_u32 s24, 4
    s_cbranch_scc1 yw_116
    s_add_u32 s26, s68, 64
    v_mov_b32 v3, 1
    v_mov_b32 v4, s89
    s_mov_b64 exec, 1
    buffer_store_dword v3, v4, s[4:7], s26 offen sc1
    s_mov_b64 exec, -1
    s_nop 1
yw_116:
    s_mov_b32 s84, 0
    s_mov_b32 s81, 0
    s_mov_b32 s82, 0
    s_mov_b32 s83, 0
    s_mov_b32 s85, 0
    s_cmp_ge_u32 s24, 4
    s_cbranch_scc1 YM_o
    s_lshl_b32 s26, s63, 7
    s_add_u32 s26, s26, 69632
    v_mov_b32 v71, s26
    s_add_u32 s30, s84, 1
    s_cmp_ge_u32 s83, s30
    s_nop 1
    s_cbranch_scc1 pc_117
    s_mov_b32 s100, 0
poll_118:
    buffer_load_dword v6, v71, s[4:7], 0 offen sc1
    s_waitcnt vmcnt(0)
    v_cmp_gt_u32 vcc, s30, v6
    s_nop 3
    s_cbranch_vccz polld_119
    s_cmp_lg_u32 s25, 0
    s_cbranch_scc1 polld_119
    s_add_u32 s100, s100, 1
    s_cmp_lt_u32 s100, 400000
    s_sleep 6
    s_cbranch_scc1 poll_118
    s_mov_b32 s25, 1
    s_lshl_b32 s100, s3, 16
    s_lshl_b32 s101, s62, 8
    s_or_b32 s100, s100, s101
    s_or_b32 s100, s100, 35
    v_mov_b32 v3, s100
    v_mov_b32 v4, 44
    buffer_store_dword v3, v4, s[16:19], 0 offen sc1
    s_nop 3
polld_119:
    v_readfirstlane_b32 s83, v6
    s_nop 4
pc_117:
    s_lshl_b32 s27, s84, 5
    s_add_u32 s27, s27, s63
    s_mul_i32 s27, s27, 12288
    s_mul_i32 s26, s24, 3072
    s_add_u32 s27, s27, s26
    s_add_u32 s27, s27, 0xc800000
    s_add_u32 s26, s26, s85
    s_add_u32 m0, s26, 129024
    s_nop 0
    buffer_load_dwordx4 v2, s[4:7], s27 offen offset:0 sc1 lds
    buffer_load_dwordx4 v2, s[4:7], s27 offen offset:1024 sc1 lds
    buffer_load_dwordx4 v2, s[4:7], s27 offen offset:2048 sc1 lds
YM_v_loop:
    s_cmp_eq_u32 s84, 0
    s_cbranch_scc1 YM_v_bar
    s_sub_u32 s26, s84, 2
    s_cmp_lt_u32 s26, 1
    s_cbranch_scc1 YM_v_bar
    s_sub_u32 s62, s84, 2
    s_max_i32 s62, s62, 0
    s_lshl_b32 s69, s62, 18
    s_add_u32 s69, s69, 0xe000000
    s_add_u32 s70, s62, 0
    s_lshr_b32 s70, s70, 3
    s_xor_b32 s70, s70, s88
    s_and_b32 s70, s70, 1
    s_lshl_b32 s70, s70, 13
    s_add_u32 s70, s70, s69
    v_mov_b32 v12, 0
    v_mov_b32 v13, 0
    v_mov_b32 v14, 0
    v_mov_b32 v15, 0
    v_mov_b32 v16, 0
    v_mov_b32 v17, 0
    v_mov_b32 v18, 0
    v_mov_b32 v19, 0
    v_mov_b32 v20, 0
    v_mov_b32 v21, 0
    v_mov_b32 v22, 0
    v_mov_b32 v23, 0
    ds_read_b128 v[24:27], v68 offset:8192
    ds_read_b128 v[28:31], v68 offset:9216
    ds_read_b128 v[32:35], v68 offset:10240
    ds_read_b128 v[36:39], v68 offset:11264
    ds_read_b128 v[40:43], v68 offset:12288
    ds_read_b128 v[44:47], v68 offset:13312
    s_mul_i32 s26, s62, 171
    s_lshr_b32 s26, s26, 9
    s_mul_i32 s86, s26, 131072
    s_xor_b32 s26, s26, s88
    s_and_b32 s26, s26, 1
    s_lshl_b32 s26, s26, 13
    s_add_u32 s86, s86, s26
    s_mul_i32 s26, s62, 655360
    s_add_u32 s86, s86, s26
    s_add_u32 s86, s86, 0x4800000
    s_and_b32 s26, s24, 3
    s_mul_i32 s26, s26, 163840
    s_add_u32 s86, s86, s26
    s_lshl_b32 s26, s63, 8
    s_add_u32 s86, s86, s26
    s_add_u32 s26, s70, s71
    v_add_u32 v6, s74, v10
    s_add_u32 s27, s70, s72
    v_add_u32 v7, s75, v10
    s_add_u32 s28, s70, s73
    v_add_u32 v8, s76, v10
    s_add_u32 s81, s81, 4
    s_waitcnt vmcnt(0)
    s_nop 2
sc_120:
    s_memrealtime s[92:93]
    s_memtime s[94:95]
    s_waitcnt lgkmcnt(0)
    s_sub_u32 s92, s82, s92
    s_sub_u32 s93, s92, 1
    s_cmp_ge_u32 s93, 2000
    s_cbranch_scc1 sc2_122
    s_cmp_lt_u32 s92, 40
    s_cbranch_scc1 sc1_121
    s_sleep 6
    s_branch sc_120
sc1_121:
    s_mul_i32 s92, s92, 22
    s_add_u32 s93, s94, s92
sc3_123:
    s_memtime s[94:95]
    s_waitcnt lgkmcnt(0)
    s_sub_u32 s92, s93, s94
    s_cmp_gt_i32 s92, 20
    s_cbranch_scc1 sc3_123
sc2_122:
    s_add_u32 s26, s26, 0
    s_add_u32 s27, s27, 0
    s_add_u32 s28, s28, 0
    s_mov_b32 s100, 0
mg_124:
    buffer_load_dwordx4 v[48:51], v2, s[4:7], s26 offen sc1
    buffer_load_dwordx4 v[52:55], v2, s[4:7], s27 offen sc1
    buffer_load_dwordx4 v[56:59], v2, s[4:7], s28 offen sc1
    s_waitcnt vmcnt(0)
    v_max3_u32 v4, v48, v49, v50
    v_max3_u32 v4, v4, v51, v52
    v_max_u32 v4, v4, v53
    v_max3_u32 v5, v54, v55, v56
    v_max3_u32 v5, v5, v57, v58
    v_max_u32 v5, v5, v59
    v_max_u32 v4, v4, v5
    v_cmp_eq_u32 vcc, -1, v4
    s_nop 3
    s_cbranch_vccz mgd_125
    s_cmp_lt_u32 s100, 2
    s_cselect_b32 s29, 65536, 0
    s_cmp_eq_u32 s100, 0
    s_cselect_b32 s29, 131072, s29
    s_add_u32 s26, s26, s29
    s_add_u32 s27, s27, s29
    s_add_u32 s28, s28, s29
    s_cmp_lg_u32 s25, 0
    s_cbranch_scc1 mgd_125
    s_add_u32 s100, s100, 1
    s_cmp_lt_u32 s100, 400000
    s_cbranch_scc1 mg_124
    s_mov_b32 s25, 1
    s_lshl_b32 s100, s3, 16
    s_lshl_b32 s101, s62, 8
    s_or_b32 s100, s100, s101
    s_or_b32 s100, s100, 34
    v_mov_b32 v3, s100
    v_mov_b32 v4, 40
    buffer_store_dword v3, v4, s[16:19], 0 offen sc1
    s_nop 3
mgd_125:
    ds_write_b128 v6, v[48:51]
    ds_write_b128 v7, v[52:55]
    ds_write_b128 v8, v[56:59]
    v_mov_b32 v3, 128000
    v_mov_b32 v4, 1
    s_mov_b64 exec, 1
    ds_add_u32 v3, v4
    s_mov_b64 exec, -1
    s_mov_b32 s100, 0
    s_nop 0
yq_126:
    s_waitcnt lgkmcnt(0)
    ds_read_b32 v5, v3
    ds_read_b128 v[48:51], v9 offset:9216
    ds_read_b128 v[52:55], v9 offset:0
    ds_read_b128 v[56:59], v9 offset:1024
    ds_read_b128 v[60:63], v9 offset:2048
    ds_read_b128 v[64:67], v9 offset:3072
    s_waitcnt lgkmcnt(5)
    v_cmp_gt_u32 vcc, s81, v5
    s_nop 3
    s_cbranch_vccz yqd_127
    s_cmp_lg_u32 s25, 0
    s_cbranch_scc1 yqd_127
    s_add_u32 s100, s100, 1
    s_cmp_lt_u32 s100, 400000
    s_cbranch_scc1 yq_126
    s_mov_b32 s25, 1
    s_lshl_b32 s100, s3, 16
    s_lshl_b32 s101, s62, 8
    s_or_b32 s100, s100, s101
    s_or_b32 s100, s100, 36
    v_mov_b32 v3, s100
    v_mov_b32 v4, 48
    buffer_store_dword v3, v4, s[16:19], 0 offen sc1
    s_nop 3
yqd_127:
    s_waitcnt lgkmcnt(4)
    v_smfmac_f32_16x16x64_bf16 v[12:15], v[48:51], v[24:31], v11
    ds_read_b128 v[24:27], v68 offset:2048
    ds_read_b128 v[28:31], v68 offset:3072
    v_smfmac_f32_16x16x64_bf16 v[16:19], v[48:51], v[32:39], v11
    ds_read_b128 v[32:35], v68 offset:4096
    ds_read_b128 v[36:39], v68 offset:5120
    v_smfmac_f32_16x16x64_bf16 v[20:23], v[48:51], v[40:47], v11
    ds_read_b128 v[48:51], v9 offset:8192
    ds_read_b128 v[40:43], v68 offset:6144
    ds_read_b128 v[44:47], v68 offset:7168
    s_waitcnt lgkmcnt(10)
    v_smfmac_f32_16x16x64_bf16 v[12:15], v[52:55], a[0:7], v11
    v_smfmac_f32_16x16x64_bf16 v[16:19], v[52:55], a[8:15], v11
    v_smfmac_f32_16x16x64_bf16 v[20:23], v[52:55], a[16:23], v11
    ds_read_b128 v[52:55], v9 offset:4096
    s_waitcnt lgkmcnt(10)
    v_smfmac_f32_16x16x64_bf16 v[12:15], v[56:59], a[24:31], v11
    v_smfmac_f32_16x16x64_bf16 v[16:19], v[56:59], a[32:39], v11
    v_smfmac_f32_16x16x64_bf16 v[20:23], v[56:59], a[40:47], v11
    ds_read_b128 v[56:59], v9 offset:5120
    s_waitcnt lgkmcnt(10)
    v_smfmac_f32_16x16x64_bf16 v[12:15], v[60:63], a[48:55], v11
    v_smfmac_f32_16x16x64_bf16 v[16:19], v[60:63], a[56:63], v11
    v_smfmac_f32_16x16x64_bf16 v[20:23], v[60:63], a[64:71], v11
    ds_read_b128 v[60:63], v9 offset:6144
    s_waitcnt lgkmcnt(10)
    v_smfmac_f32_16x16x64_bf16 v[12:15], v[64:67], a[72:79], v11
    v_smfmac_f32_16x16x64_bf16 v[16:19], v[64:67], a[80:87], v11
    v_smfmac_f32_16x16x64_bf16 v[20:23], v[64:67], a[88:95], v11
    ds_read_b128 v[64:67], v9 offset:7168
    s_waitcnt lgkmcnt(6)
    v_smfmac_f32_16x16x64_bf16 v[12:15], v[48:51], v[24:31], v11
    ds_read_b128 v[24:27], v68 offset:0
    ds_read_b128 v[28:31], v68 offset:1024
    v_smfmac_f32_16x16x64_bf16 v[16:19], v[48:51], v[32:39], v11
    s_waitcnt lgkmcnt(6)
    v_smfmac_f32_16x16x64_bf16 v[20:23], v[48:51], v[40:47], v11
    s_waitcnt lgkmcnt(5)
    v_smfmac_f32_16x16x64_bf16 v[12:15], v[52:55], a[96:103], v11
    v_smfmac_f32_16x16x64_bf16 v[16:19], v[52:55], a[104:111], v11
    v_smfmac_f32_16x16x64_bf16 v[20:23], v[52:55], a[112:119], v11
    s_waitcnt lgkmcnt(4)
    v_smfmac_f32_16x16x64_bf16 v[12:15], v[56:59], a[120:127], v11
    v_smfmac_f32_16x16x64_bf16 v[16:19], v[56:59], a[128:135], v11
    v_smfmac_f32_16x16x64_bf16 v[20:23], v[56:59], a[136:143], v11
    s_waitcnt lgkmcnt(3)
    v_smfmac_f32_16x16x64_bf16 v[12:15], v[60:63], a[144:151], v11
    v_smfmac_f32_16x16x64_bf16 v[16:19], v[60:63], a[152:159], v11
    v_smfmac_f32_16x16x64_bf16 v[20:23], v[60:63], v[72:79], v11
    s_waitcnt lgkmcnt(2)
    v_smfmac_f32_16x16x64_bf16 v[12:15], v[64:67], v[80:87], v11
    v_smfmac_f32_16x16x64_bf16 v[16:19], v[64:67], v[88:95], v11
    s_waitcnt lgkmcnt(0)
    v_smfmac_f32_16x16x64_bf16 v[20:23], v[64:67], v[24:31], v11
    s_nop 4
    v_add_f32 v12, v12, v14
    v_add_f32 v13, v13, v15
    v_cvt_pk_bf16_f32 v12, v12, v13
    v_add_u32 v3, s78, v69
    ds_write_b16 v3, v12
    ds_write_b16_d16_hi v3, v12 offset:16
    v_add_f32 v16, v16, v18
    v_add_f32 v17, v17, v19
    v_cvt_pk_bf16_f32 v16, v16, v17
    v_add_u32 v3, s79, v69
    ds_write_b16 v3, v16
    ds_write_b16_d16_hi v3, v16 offset:16
    v_add_f32 v20, v20, v22
    v_add_f32 v21, v21, v23
    v_cvt_pk_bf16_f32 v20, v20, v21
    v_add_u32 v3, s80, v69
    ds_write_b16 v3, v20
    ds_write_b16_d16_hi v3, v20 offset:16
    v_add_u32 v8, 57344, v68
    ds_read_b128 v[24:27], v8 offset:0
    ds_read_b128 v[28:31], v8 offset:1024
    ds_read_b128 v[32:35], v8 offset:2048
    ds_read_b128 v[36:39], v8 offset:3072
    ds_read_b128 v[40:43], v8 offset:4096
    ds_read_b128 v[44:47], v8 offset:5120
    ds_read_b128 v[48:51], v8 offset:6144
    ds_read_b128 v[52:55], v8 offset:7168
    ds_read_b128 v[56:59], v8 offset:8192
    ds_read_b128 v[60:63], v8 offset:9216
    v_mov_b32 v4, 0
    v_mov_b32 v5, 0
    v_mov_b32 v6, 0
    v_mov_b32 v7, 0
    v_mov_b32 v64, 0
    v_mov_b32 v65, 0
    v_mov_b32 v66, 0
    v_mov_b32 v67, 0
    s_waitcnt vmcnt(0) lgkmcnt(10)
    s_barrier
    ds_read_b128 v[12:15], v70 offset:0
    ds_read_b128 v[16:19], v70 offset:1024
    ds_read_b128 v[20:23], v70 offset:2048
    v_lshrrev_b32 v3, 4, v1
    s_waitcnt lgkmcnt(2)
    v_smfmac_f32_16x16x64_bf16 v[4:7], v[12:15], v[24:31], v11
    ds_read_b128 v[24:27], v8 offset:10240
    ds_read_b128 v[28:31], v8 offset:11264
    v_smfmac_f32_16x16x64_bf16 v[64:67], v[12:15], v[32:39], v11
    s_waitcnt lgkmcnt(3)
    v_smfmac_f32_16x16x64_bf16 v[4:7], v[16:19], v[40:47], v11
    v_smfmac_f32_16x16x64_bf16 v[64:67], v[16:19], v[48:55], v11
    s_waitcnt lgkmcnt(2)
    v_smfmac_f32_16x16x64_bf16 v[4:7], v[20:23], v[56:63], v11
    s_waitcnt lgkmcnt(0)
    v_smfmac_f32_16x16x64_bf16 v[64:67], v[20:23], v[24:31], v11
    v_and_b32 v33, 15, v1
    v_lshlrev_b32 v33, 4, v33
    v_lshl_add_u32 v32, v3, 14, v33
    s_nop 2
    v_add_f32 v4, v4, v6
    v_add_f32 v5, v5, v7
    v_cvt_pk_bf16_f32 v36, v4, v5
    v_add_f32 v64, v64, v66
    v_add_f32 v65, v65, v67
    v_cvt_pk_bf16_f32 v37, v64, v65
    v_min_u32 v36, -2, v36
    v_min_u32 v37, -2, v37
    s_add_u32 s86, s86, 131072
    v_permlane32_swap_b32 v36, v38
    v_permlane32_swap_b32 v37, v39
    s_nop 1
    v_permlane16_swap_b32 v36, v37
    v_permlane16_swap_b32 v38, v39
    s_mov_b32 exec_hi, 0
    buffer_store_dwordx4 v[36:39], v32, s[4:7], s86 offen sc1
    s_mov_b32 exec_hi, -1
    s_nop 0
    s_branch YM_v_nx
YM_v_bar:
    s_waitcnt vmcnt(0) lgkmcnt(0)
    s_barrier
YM_v_nx:
    s_add_u32 s84, s84, 1
    s_xor_b32 s85, s85, 12288
    s_cmp_ge_u32 s84, 66
    s_cbranch_scc1 YM_v_end
    s_cmp_lt_u32 s84, 3
    s_cbranch_scc1 ysl_128
    s_add_u32 s82, s70, 18432
    v_and_b32 v5, 1, v1
    v_lshlrev_b32 v5, 2, v5
    s_mov_b32 s100, 0
    s_nop 3
tw_129:
    buffer_load_dword v6, v5, s[4:7], s82 offen sc1
    s_waitcnt vmcnt(0)
    v_cmp_eq_u32 vcc, -1, v6
    s_nop 3
    s_cbranch_vccz twd_130
    s_cmp_lg_u32 s25, 0
    s_cbranch_scc1 twd_130
    s_add_u32 s100, s100, 1
    s_cmp_lt_u32 s100, 400000
    s_sleep 2
    s_cbranch_scc1 tw_129
    s_mov_b32 s25, 1
    s_lshl_b32 s100, s3, 16
    s_lshl_b32 s101, s62, 8
    s_or_b32 s100, s100, s101
    s_or_b32 s100, s100, 33
    v_mov_b32 v3, s100
    v_mov_b32 v4, 36
    buffer_store_dword v3, v4, s[16:19], 0 offen sc1
    s_nop 3
twd_130:
    v_readfirstlane_b32 s82, v6
    s_add_u32 s82, s82, 0
    s_sleep 5
ysl_128:
    s_cmp_ge_u32 s84, 64
    s_cbranch_scc1 yf_131
    s_add_u32 s30, s84, 1
    s_cmp_ge_u32 s83, s30
    s_cbranch_scc1 pc_132
    s_mov_b32 s100, 0
poll_133:
    buffer_load_dword v6, v71, s[4:7], 0 offen sc1
    s_waitcnt vmcnt(0)
    v_cmp_gt_u32 vcc, s30, v6
    s_nop 3
    s_cbranch_vccz polld_134
    s_cmp_lg_u32 s25, 0
    s_cbranch_scc1 polld_134
    s_add_u32 s100, s100, 1
    s_cmp_lt_u32 s100, 400000
    s_sleep 6
    s_cbranch_scc1 poll_133
    s_mov_b32 s25, 1
    s_lshl_b32 s100, s3, 16
    s_lshl_b32 s101, s62, 8
    s_or_b32 s100, s100, s101
    s_or_b32 s100, s100, 35
    v_mov_b32 v3, s100
    v_mov_b32 v4, 44
    buffer_store_dword v3, v4, s[16:19], 0 offen sc1
    s_nop 3
polld_134:
    v_readfirstlane_b32 s83, v6
    s_nop 4
pc_132:
    s_lshl_b32 s27, s84, 5
    s_add_u32 s27, s27, s63
    s_mul_i32 s27, s27, 12288
    s_mul_i32 s26, s24, 3072
    s_add_u32 s27, s27, s26
    s_add_u32 s27, s27, 0xc800000
    s_add_u32 s26, s26, s85
    s_add_u32 m0, s26, 129024
    s_nop 0
    buffer_load_dwordx4 v2, s[4:7], s27 offen offset:0 sc1 lds
    buffer_load_dwordx4 v2, s[4:7], s27 offen offset:1024 sc1 lds
    buffer_load_dwordx4 v2, s[4:7], s27 offen offset:2048 sc1 lds
yf_131:
    s_branch YM_v_loop
YM_v_end:
    s_waitcnt vmcnt(0)
    s_barrier
    s_endpgm
YM_o:
    v_lshrrev_b32 v3, 4, v1
    v_lshlrev_b32 v3, 13, v3
    v_and_b32 v4, 15, v1
    v_lshl_add_u32 v10, v4, 4, v3
    s_and_b32 s26, s24, 3
    s_lshl_b32 s26, s26, 11
    s_add_u32 s26, s26, 153600
    v_add_u32 v69, s26, v2
    s_mov_b32 s83, 0
    s_nop 3
YM_o_loop:
    s_cmp_eq_u32 s84, 0
    s_cbranch_scc1 YM_o_skip
    s_sub_u32 s26, s84, 2
    s_cmp_lt_u32 s26, 1
    s_cbranch_scc1 YM_o_skip
    s_sub_u32 s62, s84, 2
    s_max_i32 s62, s62, 0
    ds_read_b128 v[24:27], v68 offset:12288
    ds_read_b128 v[28:31], v68 offset:13312
    v_mov_b32 v32, 0
    v_mov_b32 v33, 0
    v_mov_b32 v34, 0
    v_mov_b32 v35, 0
    v_mov_b32 v36, 0
    v_mov_b32 v37, 0
    v_mov_b32 v38, 0
    v_mov_b32 v39, 0
    v_mov_b32 v40, 0
    v_mov_b32 v41, 0
    v_mov_b32 v42, 0
    v_mov_b32 v43, 0
    v_mov_b32 v44, 0
    v_mov_b32 v45, 0
    v_mov_b32 v46, 0
    v_mov_b32 v47, 0
    v_mov_b32 v48, 0
    v_mov_b32 v49, 0
    v_mov_b32 v50, 0
    v_mov_b32 v51, 0
    v_mov_b32 v52, 0
    v_mov_b32 v53, 0
    v_mov_b32 v54, 0
    v_mov_b32 v55, 0
    v_mov_b32 v56, 0
    v_mov_b32 v57, 0
    v_mov_b32 v58, 0
    v_mov_b32 v59, 0
    v_mov_b32 v60, 0
    v_mov_b32 v61, 0
    v_mov_b32 v62, 0
    v_mov_b32 v63, 0
    s_mul_i32 s26, s62, 171
    s_lshr_b32 s26, s26, 9
    s_mul_i32 s30, s26, 131072
    s_xor_b32 s26, s26, s88
    s_and_b32 s26, s26, 1
    s_lshl_b32 s26, s26, 13
    s_add_u32 s30, s30, s26
    s_mul_i32 s26, s62, 655360
    s_add_u32 s30, s30, s26
    s_add_u32 s30, s30, 0x4800000
    s_and_b32 s26, s24, 3
    s_mul_i32 s26, s26, 163840
    s_add_u32 s30, s30, s26
    s_lshl_b32 s26, s63, 8
    s_add_u32 s30, s30, s26
    s_waitcnt lgkmcnt(0)
    s_cmp_eq_u32 s83, 0
    s_cbranch_scc1 fd_135
    s_add_u32 s27, s62, 1
    s_lshl_b32 s27, s27, 2
    v_mov_b32 v8, 128000
    s_mov_b32 s100, 0
    s_nop 3
ow_136:
    ds_read_b32 v9, v8
    s_waitcnt lgkmcnt(0)
    v_cmp_gt_u32 vcc, s27, v9
    s_nop 3
    s_cbranch_vccz owd_137
    s_cmp_lg_u32 s25, 0
    s_cbranch_scc1 owd_137
    s_add_u32 s100, s100, 1
    s_cmp_lt_u32 s100, 400000
    s_sleep 1
    s_cbranch_scc1 ow_136
owd_137:
    s_add_u32 s26, s83, 262144
    buffer_store_dwordx4 v[12:15], v2, s[4:7], s26 offen sc1
    s_add_u32 s26, s83, 196608
    buffer_store_dwordx4 v[16:19], v2, s[4:7], s26 offen sc1
    s_add_u32 s26, s83, 229376
    buffer_store_dwordx4 v[20:23], v2, s[4:7], s26 offen sc1
    s_add_u32 s26, s83, 294912
    buffer_store_dwordx4 v[4:7], v2, s[4:7], s26 offen sc1
    s_nop 2
    ds_read_b128 v[12:15], v69
    s_add_u32 s26, s83, 163840
    s_waitcnt lgkmcnt(0)
    buffer_store_dwordx4 v[12:15], v2, s[4:7], s26 offen sc1
    s_mov_b32 s83, 0
    s_nop 0
fd_135:
    s_and_b32 s26, s24, 3
    s_lshl_b32 s26, s26, 2
    s_add_u32 s26, s26, 128064
    v_mov_b32 v8, s26
    s_add_u32 s26, s62, 1
    v_mov_b32 v9, s26
    s_barrier
    ds_read_b128 v[12:15], v70 offset:0
    ds_read_b128 v[16:19], v70 offset:1024
    ds_read_b128 v[20:23], v70 offset:2048
    s_waitcnt lgkmcnt(2)
    v_smfmac_f32_16x16x64_bf16 v[32:35], v[12:15], a[0:7], v11
    s_waitcnt lgkmcnt(1)
    v_smfmac_f32_16x16x64_bf16 v[32:35], v[16:19], a[64:71], v11
    s_waitcnt lgkmcnt(0)
    v_smfmac_f32_16x16x64_bf16 v[32:35], v[20:23], a[120:127], v11
    v_smfmac_f32_16x16x64_bf16 v[36:39], v[12:15], a[8:15], v11
    v_smfmac_f32_16x16x64_bf16 v[36:39], v[16:19], a[72:79], v11
    v_smfmac_f32_16x16x64_bf16 v[36:39], v[20:23], a[128:135], v11
    s_nop 4
    v_add_f32 v32, v32, v34
    v_add_f32 v33, v33, v35
    v_smfmac_f32_16x16x64_bf16 v[40:43], v[12:15], a[16:23], v11
    v_cvt_pk_bf16_f32 v4, v32, v33
    v_smfmac_f32_16x16x64_bf16 v[40:43], v[16:19], a[80:87], v11
    v_min_u32 v4, -2, v4
    v_smfmac_f32_16x16x64_bf16 v[40:43], v[20:23], a[136:143], v11
    v_add_f32 v36, v36, v38
    v_add_f32 v37, v37, v39
    v_smfmac_f32_16x16x64_bf16 v[44:47], v[12:15], a[24:31], v11
    v_cvt_pk_bf16_f32 v5, v36, v37
    v_smfmac_f32_16x16x64_bf16 v[44:47], v[16:19], v[24:31], v11
    v_min_u32 v5, -2, v5
    v_smfmac_f32_16x16x64_bf16 v[44:47], v[20:23], a[144:151], v11
    s_nop 0
    v_add_f32 v40, v40, v42
    v_add_f32 v41, v41, v43
    v_smfmac_f32_16x16x64_bf16 v[48:51], v[12:15], a[32:39], v11
    v_cvt_pk_bf16_f32 v6, v40, v41
    v_smfmac_f32_16x16x64_bf16 v[48:51], v[16:19], a[88:95], v11
    v_min_u32 v6, -2, v6
    v_smfmac_f32_16x16x64_bf16 v[48:51], v[20:23], a[152:159], v11
    v_add_f32 v44, v44, v46
    v_add_f32 v45, v45, v47
    v_smfmac_f32_16x16x64_bf16 v[52:55], v[12:15], a[40:47], v11
    v_cvt_pk_bf16_f32 v7, v44, v45
    v_smfmac_f32_16x16x64_bf16 v[52:55], v[16:19], a[96:103], v11
    v_min_u32 v7, -2, v7
    v_smfmac_f32_16x16x64_bf16 v[52:55], v[20:23], v[72:79], v11
    s_add_u32 s26, s30, 0
    v_permlane32_swap_b32 v4, v6
    v_permlane32_swap_b32 v5, v7
    s_nop 0
    s_nop 0
    v_permlane16_swap_b32 v4, v5
    v_permlane16_swap_b32 v6, v7
    buffer_store_dwordx4 v[4:7], v71, s[4:7], s26 offen sc1
    v_add_f32 v48, v48, v50
    v_add_f32 v49, v49, v51
    v_smfmac_f32_16x16x64_bf16 v[56:59], v[12:15], a[48:55], v11
    v_cvt_pk_bf16_f32 v64, v48, v49
    v_smfmac_f32_16x16x64_bf16 v[56:59], v[16:19], a[104:111], v11
    v_min_u32 v64, -2, v64
    v_smfmac_f32_16x16x64_bf16 v[56:59], v[20:23], v[80:87], v11
    v_add_f32 v52, v52, v54
    v_add_f32 v53, v53, v55
    v_smfmac_f32_16x16x64_bf16 v[60:63], v[12:15], a[56:63], v11
    v_cvt_pk_bf16_f32 v65, v52, v53
    v_smfmac_f32_16x16x64_bf16 v[60:63], v[16:19], a[112:119], v11
    v_min_u32 v65, -2, v65
    v_smfmac_f32_16x16x64_bf16 v[60:63], v[20:23], v[88:95], v11
    s_nop 0
    v_add_f32 v56, v56, v58
    v_add_f32 v57, v57, v59
    v_cvt_pk_bf16_f32 v66, v56, v57
    v_min_u32 v66, -2, v66
    s_nop 2
    v_add_f32 v60, v60, v62
    v_add_f32 v61, v61, v63
    v_cvt_pk_bf16_f32 v67, v60, v61
    v_min_u32 v67, -2, v67
    s_add_u32 s26, s30, 65536
    v_permlane32_swap_b32 v64, v66
    v_permlane32_swap_b32 v65, v67
    s_nop 0
    s_nop 0
    v_permlane16_swap_b32 v64, v65
    v_permlane16_swap_b32 v66, v67
    buffer_store_dwordx4 v[64:67], v71, s[4:7], s26 offen sc1
    s_waitcnt vmcnt(2)
    v_mov_b32 v3, s84
    v_mov_b32 v4, s89
    s_mov_b64 exec, 1
    buffer_store_dword v3, v4, s[4:7], s68 offen sc1
    s_mov_b64 exec, -1
    s_nop 0
    s_branch YM_o_bulk
YM_o_skip:
    s_cmp_eq_u32 s83, 0
    s_cbranch_scc1 fd_138
    s_add_u32 s26, s83, 262144
    buffer_store_dwordx4 v[12:15], v2, s[4:7], s26 offen sc1
    s_add_u32 s26, s83, 196608
    buffer_store_dwordx4 v[16:19], v2, s[4:7], s26 offen sc1
    s_add_u32 s26, s83, 229376
    buffer_store_dwordx4 v[20:23], v2, s[4:7], s26 offen sc1
    s_add_u32 s26, s83, 294912
    buffer_store_dwordx4 v[4:7], v2, s[4:7], s26 offen sc1
    s_nop 2
    ds_read_b128 v[12:15], v69
    s_add_u32 s26, s83, 163840
    s_waitcnt lgkmcnt(0)
    buffer_store_dwordx4 v[12:15], v2, s[4:7], s26 offen sc1
    s_mov_b32 s83, 0
    s_nop 0
fd_138:
    s_waitcnt vmcnt(0)
    v_mov_b32 v3, s84
    v_mov_b32 v4, s89
    s_mov_b64 exec, 1
    buffer_store_dword v3, v4, s[4:7], s68 offen sc1
    s_mov_b64 exec, -1
    s_barrier
    s_nop 0
YM_o_bulk:
    s_cmp_ge_u32 s84, 64
    s_cbranch_scc1 YM_o_next
    s_mul_i32 s30, s84, 40
    s_and_b32 s26, s24, 3
    s_mul_i32 s26, s26, 10
    s_add_u32 s30, s30, s26
    s_lshl_b32 s30, s30, 5
    s_add_u32 s30, s30, s63
    s_lshl_b32 s30, s30, 10
    s_add_u32 s30, s30, 0x7400000
    s_add_u32 s26, s85, 129024
    v_add_u32 v9, s26, v2
    ds_read_b128 v[52:55], v9 offset:0
    ds_read_b128 v[56:59], v9 offset:6144
    ds_read_b128 v[60:63], v9 offset:1024
    ds_read_b128 v[64:67], v68 offset:12288
    ds_read_b128 v[4:7], v68 offset:13312
    s_waitcnt lgkmcnt(4)
    v_mfma_f32_16x16x32_bf16 v[12:15], v[52:55], a[0:3], 0
    v_mfma_f32_16x16x32_bf16 v[20:23], v[52:55], a[8:11], 0
    v_mfma_f32_16x16x32_bf16 v[28:31], v[52:55], a[16:19], 0
    v_mfma_f32_16x16x32_bf16 v[36:39], v[52:55], a[24:27], 0
    v_mfma_f32_16x16x32_bf16 v[44:47], v[52:55], a[32:35], 0
    ds_read_b128 v[52:55], v9 offset:7168
    s_waitcnt lgkmcnt(4)
    v_mfma_f32_16x16x32_bf16 v[16:19], v[56:59], a[0:3], 0
    v_mfma_f32_16x16x32_bf16 v[24:27], v[56:59], a[8:11], 0
    v_mfma_f32_16x16x32_bf16 v[32:35], v[56:59], a[16:19], 0
    v_mfma_f32_16x16x32_bf16 v[40:43], v[56:59], a[24:27], 0
    v_mfma_f32_16x16x32_bf16 v[48:51], v[56:59], a[32:35], 0
    ds_read_b128 v[56:59], v9 offset:2048
    s_waitcnt lgkmcnt(4)
    v_mfma_f32_16x16x32_bf16 v[12:15], v[60:63], a[4:7], v[12:15]
    v_mfma_f32_16x16x32_bf16 v[20:23], v[60:63], a[12:15], v[20:23]
    v_mfma_f32_16x16x32_bf16 v[28:31], v[60:63], a[20:23], v[28:31]
    v_mfma_f32_16x16x32_bf16 v[36:39], v[60:63], a[28:31], v[36:39]
    v_mfma_f32_16x16x32_bf16 v[44:47], v[60:63], a[36:39], v[44:47]
    ds_read_b128 v[60:63], v9 offset:8192
    s_waitcnt lgkmcnt(2)
    v_mfma_f32_16x16x32_bf16 v[16:19], v[52:55], a[4:7], v[16:19]
    v_mfma_f32_16x16x32_bf16 v[24:27], v[52:55], a[12:15], v[24:27]
    v_mfma_f32_16x16x32_bf16 v[32:35], v[52:55], a[20:23], v[32:35]
    v_mfma_f32_16x16x32_bf16 v[40:43], v[52:55], a[28:31], v[40:43]
    v_mfma_f32_16x16x32_bf16 v[48:51], v[52:55], a[36:39], v[48:51]
    ds_read_b128 v[52:55], v9 offset:3072
    s_waitcnt lgkmcnt(2)
    v_mfma_f32_16x16x32_bf16 v[12:15], v[56:59], a[64:67], v[12:15]
    v_mfma_f32_16x16x32_bf16 v[20:23], v[56:59], a[72:75], v[20:23]
    v_mfma_f32_16x16x32_bf16 v[28:31], v[56:59], a[80:83], v[28:31]
    v_mfma_f32_16x16x32_bf16 v[36:39], v[56:59], v[64:67], v[36:39]
    v_mfma_f32_16x16x32_bf16 v[44:47], v[56:59], a[88:91], v[44:47]
    ds_read_b128 v[56:59], v9 offset:9216
    s_waitcnt lgkmcnt(2)
    v_mfma_f32_16x16x32_bf16 v[16:19], v[60:63], a[64:67], v[16:19]
    v_mfma_f32_16x16x32_bf16 v[24:27], v[60:63], a[72:75], v[24:27]
    v_mfma_f32_16x16x32_bf16 v[32:35], v[60:63], a[80:83], v[32:35]
    v_mfma_f32_16x16x32_bf16 v[40:43], v[60:63], v[64:67], v[40:43]
    ds_read_b128 v[64:67], v68 offset:0
    v_mfma_f32_16x16x32_bf16 v[48:51], v[60:63], a[88:91], v[48:51]
    ds_read_b128 v[60:63], v9 offset:4096
    s_waitcnt lgkmcnt(3)
    v_mfma_f32_16x16x32_bf16 v[12:15], v[52:55], a[68:71], v[12:15]
    v_mfma_f32_16x16x32_bf16 v[20:23], v[52:55], a[76:79], v[20:23]
    v_mfma_f32_16x16x32_bf16 v[28:31], v[52:55], a[84:87], v[28:31]
    v_mfma_f32_16x16x32_bf16 v[36:39], v[52:55], v[4:7], v[36:39]
    v_mfma_f32_16x16x32_bf16 v[44:47], v[52:55], a[92:95], v[44:47]
    ds_read_b128 v[52:55], v9 offset:10240
    s_waitcnt lgkmcnt(3)
    v_mfma_f32_16x16x32_bf16 v[16:19], v[56:59], a[68:71], v[16:19]
    v_mfma_f32_16x16x32_bf16 v[24:27], v[56:59], a[76:79], v[24:27]
    v_mfma_f32_16x16x32_bf16 v[32:35], v[56:59], a[84:87], v[32:35]
    v_mfma_f32_16x16x32_bf16 v[40:43], v[56:59], v[4:7], v[40:43]
    ds_read_b128 v[4:7], v68 offset:2048
    v_mfma_f32_16x16x32_bf16 v[48:51], v[56:59], a[92:95], v[48:51]
    ds_read_b128 v[56:59], v9 offset:5120
    s_waitcnt lgkmcnt(3)
    v_mfma_f32_16x16x32_bf16 v[12:15], v[60:63], a[120:123], v[12:15]
    v_mfma_f32_16x16x32_bf16 v[20:23], v[60:63], a[128:131], v[20:23]
    v_mfma_f32_16x16x32_bf16 v[28:31], v[60:63], a[136:139], v[28:31]
    v_mfma_f32_16x16x32_bf16 v[36:39], v[60:63], a[144:147], v[36:39]
    v_mfma_f32_16x16x32_bf16 v[44:47], v[60:63], a[152:155], v[44:47]
    ds_read_b128 v[60:63], v9 offset:11264
    s_waitcnt lgkmcnt(3)
    v_mfma_f32_16x16x32_bf16 v[16:19], v[52:55], a[120:123], v[16:19]
    v_mfma_f32_16x16x32_bf16 v[24:27], v[52:55], a[128:131], v[24:27]
    v_mfma_f32_16x16x32_bf16 v[32:35], v[52:55], a[136:139], v[32:35]
    v_mfma_f32_16x16x32_bf16 v[40:43], v[52:55], a[144:147], v[40:43]
    v_mfma_f32_16x16x32_bf16 v[48:51], v[52:55], a[152:155], v[48:51]
    ds_read_b128 v[52:55], v9 offset:0
    s_waitcnt lgkmcnt(2)
    v_mfma_f32_16x16x32_bf16 v[12:15], v[56:59], a[124:127], v[12:15]
    s_waitcnt lgkmcnt(1)
    v_mfma_f32_16x16x32_bf16 v[16:19], v[60:63], a[124:127], v[16:19]
    v_mfma_f32_16x16x32_bf16 v[20:23], v[56:59], a[132:135], v[20:23]
    v_mfma_f32_16x16x32_bf16 v[24:27], v[60:63], a[132:135], v[24:27]
    v_mfma_f32_16x16x32_bf16 v[28:31], v[56:59], a[140:143], v[28:31]
    s_nop 2
    v_cvt_pk_bf16_f32 v12, v12, v13
    v_cvt_pk_bf16_f32 v13, v14, v15
    v_mfma_f32_16x16x32_bf16 v[32:35], v[60:63], a[140:143], v[32:35]
    v_cvt_pk_bf16_f32 v14, v16, v17
    v_cvt_pk_bf16_f32 v15, v18, v19
    s_add_u32 s26, s30, 0
    buffer_store_dwordx4 v[12:15], v2, s[4:7], s26 offen sc1
    s_nop 1
    v_mfma_f32_16x16x32_bf16 v[36:39], v[56:59], a[148:151], v[36:39]
    v_cvt_pk_bf16_f32 v20, v20, v21
    v_cvt_pk_bf16_f32 v21, v22, v23
    v_mfma_f32_16x16x32_bf16 v[40:43], v[60:63], a[148:151], v[40:43]
    v_cvt_pk_bf16_f32 v22, v24, v25
    v_cvt_pk_bf16_f32 v23, v26, v27
    s_add_u32 s26, s30, 32768
    buffer_store_dwordx4 v[20:23], v2, s[4:7], s26 offen sc1
    s_nop 1
    v_mfma_f32_16x16x32_bf16 v[44:47], v[56:59], a[156:159], v[44:47]
    v_cvt_pk_bf16_f32 v28, v28, v29
    v_cvt_pk_bf16_f32 v29, v30, v31
    ds_read_b128 v[56:59], v9 offset:6144
    v_mfma_f32_16x16x32_bf16 v[48:51], v[60:63], a[156:159], v[48:51]
    v_cvt_pk_bf16_f32 v30, v32, v33
    v_cvt_pk_bf16_f32 v31, v34, v35
    s_add_u32 s26, s30, 65536
    buffer_store_dwordx4 v[28:31], v2, s[4:7], s26 offen sc1
    s_nop 1
    v_cvt_pk_bf16_f32 v36, v36, v37
    v_cvt_pk_bf16_f32 v37, v38, v39
    ds_read_b128 v[60:63], v9 offset:1024
    s_waitcnt lgkmcnt(2)
    v_mfma_f32_16x16x32_bf16 v[12:15], v[52:55], a[40:43], 0
    v_cvt_pk_bf16_f32 v38, v40, v41
    v_cvt_pk_bf16_f32 v39, v42, v43
    s_add_u32 s26, s30, 98304
    buffer_store_dwordx4 v[36:39], v2, s[4:7], s26 offen sc1
    s_nop 1
    v_cvt_pk_bf16_f32 v44, v44, v45
    v_cvt_pk_bf16_f32 v45, v46, v47
    v_mfma_f32_16x16x32_bf16 v[20:23], v[52:55], a[48:51], 0
    v_cvt_pk_bf16_f32 v46, v48, v49
    v_cvt_pk_bf16_f32 v47, v50, v51
    s_add_u32 s26, s30, 131072
    buffer_store_dwordx4 v[44:47], v2, s[4:7], s26 offen sc1
    s_nop 1
    v_mfma_f32_16x16x32_bf16 v[28:31], v[52:55], a[56:59], 0
    v_mfma_f32_16x16x32_bf16 v[36:39], v[52:55], v[64:67], 0
    v_mfma_f32_16x16x32_bf16 v[44:47], v[52:55], v[4:7], 0
    ds_read_b128 v[52:55], v9 offset:7168
    s_waitcnt lgkmcnt(2)
    v_mfma_f32_16x16x32_bf16 v[16:19], v[56:59], a[40:43], 0
    v_mfma_f32_16x16x32_bf16 v[24:27], v[56:59], a[48:51], 0
    v_mfma_f32_16x16x32_bf16 v[32:35], v[56:59], a[56:59], 0
    v_mfma_f32_16x16x32_bf16 v[40:43], v[56:59], v[64:67], 0
    ds_read_b128 v[64:67], v68 offset:1024
    v_mfma_f32_16x16x32_bf16 v[48:51], v[56:59], v[4:7], 0
    ds_read_b128 v[4:7], v68 offset:3072
    ds_read_b128 v[56:59], v9 offset:2048
    s_waitcnt lgkmcnt(4)
    v_mfma_f32_16x16x32_bf16 v[12:15], v[60:63], a[44:47], v[12:15]
    v_mfma_f32_16x16x32_bf16 v[20:23], v[60:63], a[52:55], v[20:23]
    v_mfma_f32_16x16x32_bf16 v[28:31], v[60:63], a[60:63], v[28:31]
    s_waitcnt lgkmcnt(2)
    v_mfma_f32_16x16x32_bf16 v[36:39], v[60:63], v[64:67], v[36:39]
    s_waitcnt lgkmcnt(1)
    v_mfma_f32_16x16x32_bf16 v[44:47], v[60:63], v[4:7], v[44:47]
    ds_read_b128 v[60:63], v9 offset:8192
    v_mfma_f32_16x16x32_bf16 v[16:19], v[52:55], a[44:47], v[16:19]
    v_mfma_f32_16x16x32_bf16 v[24:27], v[52:55], a[52:55], v[24:27]
    v_mfma_f32_16x16x32_bf16 v[32:35], v[52:55], a[60:63], v[32:35]
    v_mfma_f32_16x16x32_bf16 v[40:43], v[52:55], v[64:67], v[40:43]
    ds_read_b128 v[64:67], v68 offset:4096
    v_mfma_f32_16x16x32_bf16 v[48:51], v[52:55], v[4:7], v[48:51]
    ds_read_b128 v[4:7], v68 offset:6144
    ds_read_b128 v[52:55], v9 offset:3072
    s_waitcnt lgkmcnt(4)
    v_mfma_f32_16x16x32_bf16 v[12:15], v[56:59], a[96:99], v[12:15]
    v_mfma_f32_16x16x32_bf16 v[20:23], v[56:59], a[104:107], v[20:23]
    v_mfma_f32_16x16x32_bf16 v[28:31], v[56:59], a[112:115], v[28:31]
    s_waitcnt lgkmcnt(2)
    v_mfma_f32_16x16x32_bf16 v[36:39], v[56:59], v[64:67], v[36:39]
    s_waitcnt lgkmcnt(1)
    v_mfma_f32_16x16x32_bf16 v[44:47], v[56:59], v[4:7], v[44:47]
    ds_read_b128 v[56:59], v9 offset:9216
    v_mfma_f32_16x16x32_bf16 v[16:19], v[60:63], a[96:99], v[16:19]
    v_mfma_f32_16x16x32_bf16 v[24:27], v[60:63], a[104:107], v[24:27]
    v_mfma_f32_16x16x32_bf16 v[32:35], v[60:63], a[112:115], v[32:35]
    v_mfma_f32_16x16x32_bf16 v[40:43], v[60:63], v[64:67], v[40:43]
    ds_read_b128 v[64:67], v68 offset:5120
    v_mfma_f32_16x16x32_bf16 v[48:51], v[60:63], v[4:7], v[48:51]
    ds_read_b128 v[4:7], v68 offset:7168
    ds_read_b128 v[60:63], v9 offset:4096
    s_waitcnt lgkmcnt(4)
    v_mfma_f32_16x16x32_bf16 v[12:15], v[52:55], a[100:103], v[12:15]
    v_mfma_f32_16x16x32_bf16 v[20:23], v[52:55], a[108:111], v[20:23]
    v_mfma_f32_16x16x32_bf16 v[28:31], v[52:55], a[116:119], v[28:31]
    s_waitcnt lgkmcnt(2)
    v_mfma_f32_16x16x32_bf16 v[36:39], v[52:55], v[64:67], v[36:39]
    s_waitcnt lgkmcnt(1)
    v_mfma_f32_16x16x32_bf16 v[44:47], v[52:55], v[4:7], v[44:47]
    ds_read_b128 v[52:55], v9 offset:10240
    v_mfma_f32_16x16x32_bf16 v[16:19], v[56:59], a[100:103], v[16:19]
    v_mfma_f32_16x16x32_bf16 v[24:27], v[56:59], a[108:111], v[24:27]
    v_mfma_f32_16x16x32_bf16 v[32:35], v[56:59], a[116:119], v[32:35]
    v_mfma_f32_16x16x32_bf16 v[40:43], v[56:59], v[64:67], v[40:43]
    ds_read_b128 v[64:67], v68 offset:8192
    v_mfma_f32_16x16x32_bf16 v[48:51], v[56:59], v[4:7], v[48:51]
    ds_read_b128 v[4:7], v68 offset:10240
    ds_read_b128 v[56:59], v9 offset:5120
    s_waitcnt lgkmcnt(4)
    v_mfma_f32_16x16x32_bf16 v[12:15], v[60:63], v[72:75], v[12:15]
    v_mfma_f32_16x16x32_bf16 v[20:23], v[60:63], v[80:83], v[20:23]
    v_mfma_f32_16x16x32_bf16 v[28:31], v[60:63], v[88:91], v[28:31]
    s_waitcnt lgkmcnt(2)
    v_mfma_f32_16x16x32_bf16 v[36:39], v[60:63], v[64:67], v[36:39]
    s_waitcnt lgkmcnt(1)
    v_mfma_f32_16x16x32_bf16 v[44:47], v[60:63], v[4:7], v[44:47]
    ds_read_b128 v[60:63], v9 offset:11264
    v_mfma_f32_16x16x32_bf16 v[16:19], v[52:55], v[72:75], v[16:19]
    v_mfma_f32_16x16x32_bf16 v[24:27], v[52:55], v[80:83], v[24:27]
    v_mfma_f32_16x16x32_bf16 v[32:35], v[52:55], v[88:91], v[32:35]
    v_mfma_f32_16x16x32_bf16 v[40:43], v[52:55], v[64:67], v[40:43]
    ds_read_b128 v[64:67], v68 offset:9216
    v_mfma_f32_16x16x32_bf16 v[48:51], v[52:55], v[4:7], v[48:51]
    ds_read_b128 v[4:7], v68 offset:11264
    s_waitcnt lgkmcnt(3)
    v_mfma_f32_16x16x32_bf16 v[12:15], v[56:59], v[76:79], v[12:15]
    s_waitcnt lgkmcnt(2)
    v_mfma_f32_16x16x32_bf16 v[16:19], v[60:63], v[76:79], v[16:19]
    v_mfma_f32_16x16x32_bf16 v[20:23], v[56:59], v[84:87], v[20:23]
    v_mfma_f32_16x16x32_bf16 v[24:27], v[60:63], v[84:87], v[24:27]
    v_mfma_f32_16x16x32_bf16 v[28:31], v[56:59], v[92:95], v[28:31]
    s_nop 2
    v_cvt_pk_bf16_f32 v12, v12, v13
    v_cvt_pk_bf16_f32 v13, v14, v15
    v_mfma_f32_16x16x32_bf16 v[32:35], v[60:63], v[92:95], v[32:35]
    v_cvt_pk_bf16_f32 v14, v16, v17
    v_cvt_pk_bf16_f32 v15, v18, v19
    ds_write_b128 v69, v[12:15]
    s_waitcnt lgkmcnt(1)
    v_mfma_f32_16x16x32_bf16 v[36:39], v[56:59], v[64:67], v[36:39]
    v_cvt_pk_bf16_f32 v16, v20, v21
    v_cvt_pk_bf16_f32 v17, v22, v23
    v_mfma_f32_16x16x32_bf16 v[40:43], v[60:63], v[64:67], v[40:43]
    v_cvt_pk_bf16_f32 v18, v24, v25
    v_cvt_pk_bf16_f32 v19, v26, v27
    s_waitcnt lgkmcnt(0)
    v_mfma_f32_16x16x32_bf16 v[44:47], v[56:59], v[4:7], v[44:47]
    v_cvt_pk_bf16_f32 v20, v28, v29
    v_cvt_pk_bf16_f32 v21, v30, v31
    v_mfma_f32_16x16x32_bf16 v[48:51], v[60:63], v[4:7], v[48:51]
    v_cvt_pk_bf16_f32 v22, v32, v33
    v_cvt_pk_bf16_f32 v23, v34, v35
    v_cvt_pk_bf16_f32 v12, v36, v37
    v_cvt_pk_bf16_f32 v13, v38, v39
    v_cvt_pk_bf16_f32 v14, v40, v41
    v_cvt_pk_bf16_f32 v15, v42, v43
    v_cvt_pk_bf16_f32 v4, v44, v45
    v_cvt_pk_bf16_f32 v5, v46, v47
    v_cvt_pk_bf16_f32 v6, v48, v49
    v_cvt_pk_bf16_f32 v7, v50, v51
    s_mov_b32 s83, s30
    s_nop 3
YM_o_next:
    s_add_u32 s84, s84, 1
    s_xor_b32 s85, s85, 12288
    s_cmp_lt_u32 s84, 66
    s_cbranch_scc1 YM_o_loop
    s_waitcnt vmcnt(0)
    s_barrier
    v_mov_b32 v3, s84
    v_mov_b32 v4, s89
    s_mov_b64 exec, 1
    buffer_store_dword v3, v4, s[4:7], s68 offen sc1
    s_mov_b64 exec, -1
    s_endpgm
    s_nop 0
R_K:
    s_lshl_b32 s68, s63, 7
    s_add_u32 s68, s68, 65536
    s_mov_b32 s8, s38
    s_and_b32 s9, s39, 0xffff
    s_mov_b32 s10, 0x780000
    s_mov_b32 s11, 0x20000
    s_sub_u32 s26, s24, 4
    s_lshr_b32 s27, s26, 1
    s_add_u32 s27, s27, 4
    s_and_b32 s26, s26, 1
    s_cmp_lt_u32 s24, 4
    s_cselect_b32 s64, s24, s27
    s_cselect_b32 s65, 0, s26
    s_cselect_b32 s66, 2, 1
    s_mul_i32 s67, s63, 384
    s_lshl_b32 s29, s64, 6
    v_lshrrev_b32 v3, 4, v1
    v_lshlrev_b32 v3, 3, v3
    v_bfe_u32 v4, v1, 2, 2
    v_add_u32 v3, v3, v4
    v_mul_u32_u24 v3, 416, v3
    v_and_b32 v4, 3, v1
    v_lshl_add_u32 v3, v4, 3, v3
    v_add_u32 v13, s29, v3
    s_mov_b32 s26, s24
    s_add_u32 s28, s67, 0
    s_nop 2
stg_139:
    s_min_u32 s27, s26, 64
    s_lshl_b32 s27, s27, 6
    v_add_u32 v10, s27, v1
    s_lshl_b32 s27, s27, 4
    v_mul_u32_u24 v11, 40330, v10
    v_lshrrev_b32 v11, 20, v11
    v_mul_u32_u24 v12, 26, v11
    v_sub_u32 v12, v10, v12
    v_min_u32 v12, 23, v12
    v_mul_u32_u24 v11, 12288, v11
    s_add_u32 m0, s27, 0
    v_lshl_add_u32 v11, v12, 4, v11
    s_add_u32 s26, s26, 8
    buffer_load_dwordx4 v11, s[8:11], s28 offen lds
    s_cmp_lt_u32 s26, 72
    s_nop 0
    s_cbranch_scc1 stg_139
    s_mov_b32 s26, s24
    s_add_u32 s28, s67, 1966080
stg_140:
    s_min_u32 s27, s26, 64
    s_lshl_b32 s27, s27, 6
    v_add_u32 v10, s27, v1
    s_lshl_b32 s27, s27, 4
    v_mul_u32_u24 v11, 40330, v10
    v_lshrrev_b32 v11, 20, v11
    v_mul_u32_u24 v12, 26, v11
    v_sub_u32 v12, v10, v12
    v_min_u32 v12, 23, v12
    v_mul_u32_u24 v11, 12288, v11
    s_add_u32 m0, s27, 81920
    v_lshl_add_u32 v11, v12, 4, v11
    s_add_u32 s26, s26, 8
    buffer_load_dwordx4 v11, s[8:11], s28 offen lds
    s_cmp_lt_u32 s26, 72
    s_nop 0
    s_cbranch_scc1 stg_140
    s_waitcnt vmcnt(9)
    s_barrier
    v_add_u32 v14, 0, v13
    ds_read_b64_tr_b16 a[0:1], v14 offset:0
    ds_read_b64_tr_b16 a[2:3], v14 offset:1664
    ds_read_b64_tr_b16 a[80:81], v14 offset:32
    ds_read_b64_tr_b16 a[82:83], v14 offset:1696
    ds_read_b64_tr_b16 a[4:5], v14 offset:13312
    ds_read_b64_tr_b16 a[6:7], v14 offset:14976
    ds_read_b64_tr_b16 a[84:85], v14 offset:13344
    ds_read_b64_tr_b16 a[86:87], v14 offset:15008
    ds_read_b64_tr_b16 a[8:9], v14 offset:26624
    ds_read_b64_tr_b16 a[10:11], v14 offset:28288
    ds_read_b64_tr_b16 a[88:89], v14 offset:26656
    ds_read_b64_tr_b16 a[90:91], v14 offset:28320
    ds_read_b64_tr_b16 a[12:13], v14 offset:39936
    ds_read_b64_tr_b16 a[14:15], v14 offset:41600
    ds_read_b64_tr_b16 a[92:93], v14 offset:39968
    ds_read_b64_tr_b16 a[94:95], v14 offset:41632
    ds_read_b64_tr_b16 a[16:17], v14 offset:53248
    ds_read_b64_tr_b16 a[18:19], v14 offset:54912
    ds_read_b64_tr_b16 a[96:97], v14 offset:53280
    ds_read_b64_tr_b16 a[98:99], v14 offset:54944
    s_waitcnt lgkmcnt(0)
    s_barrier
    s_mov_b32 s26, s24
    s_add_u32 s28, s67, 3932160
stg_141:
    s_min_u32 s27, s26, 64
    s_lshl_b32 s27, s27, 6
    v_add_u32 v10, s27, v1
    s_lshl_b32 s27, s27, 4
    v_mul_u32_u24 v11, 40330, v10
    v_lshrrev_b32 v11, 20, v11
    v_mul_u32_u24 v12, 26, v11
    v_sub_u32 v12, v10, v12
    v_min_u32 v12, 23, v12
    v_mul_u32_u24 v11, 12288, v11
    s_add_u32 m0, s27, 0
    v_lshl_add_u32 v11, v12, 4, v11
    s_add_u32 s26, s26, 8
    buffer_load_dwordx4 v11, s[8:11], s28 offen lds
    s_cmp_lt_u32 s26, 72
    s_nop 0
    s_cbranch_scc1 stg_141
    s_waitcnt vmcnt(9)
    s_barrier
    v_add_u32 v14, 81920, v13
    ds_read_b64_tr_b16 a[20:21], v14 offset:0
    ds_read_b64_tr_b16 a[22:23], v14 offset:1664
    ds_read_b64_tr_b16 a[100:101], v14 offset:32
    ds_read_b64_tr_b16 a[102:103], v14 offset:1696
    ds_read_b64_tr_b16 a[24:25], v14 offset:13312
    ds_read_b64_tr_b16 a[26:27], v14 offset:14976
    ds_read_b64_tr_b16 a[104:105], v14 offset:13344
    ds_read_b64_tr_b16 a[106:107], v14 offset:15008
    ds_read_b64_tr_b16 a[28:29], v14 offset:26624
    ds_read_b64_tr_b16 a[30:31], v14 offset:28288
    ds_read_b64_tr_b16 a[108:109], v14 offset:26656
    ds_read_b64_tr_b16 a[110:111], v14 offset:28320
    ds_read_b64_tr_b16 a[32:33], v14 offset:39936
    ds_read_b64_tr_b16 a[34:35], v14 offset:41600
    ds_read_b64_tr_b16 a[112:113], v14 offset:39968
    ds_read_b64_tr_b16 a[114:115], v14 offset:41632
    ds_read_b64_tr_b16 a[36:37], v14 offset:53248
    ds_read_b64_tr_b16 a[38:39], v14 offset:54912
    ds_read_b64_tr_b16 a[116:117], v14 offset:53280
    ds_read_b64_tr_b16 a[118:119], v14 offset:54944
    s_waitcnt lgkmcnt(0)
    s_barrier
    s_mov_b32 s26, s24
    s_add_u32 s28, s67, 5898240
stg_142:
    s_min_u32 s27, s26, 64
    s_lshl_b32 s27, s27, 6
    v_add_u32 v10, s27, v1
    s_lshl_b32 s27, s27, 4
    v_mul_u32_u24 v11, 40330, v10
    v_lshrrev_b32 v11, 20, v11
    v_mul_u32_u24 v12, 26, v11
    v_sub_u32 v12, v10, v12
    v_min_u32 v12, 23, v12
    v_mul_u32_u24 v11, 12288, v11
    s_add_u32 m0, s27, 81920
    v_lshl_add_u32 v11, v12, 4, v11
    s_add_u32 s26, s26, 8
    buffer_load_dwordx4 v11, s[8:11], s28 offen lds
    s_cmp_lt_u32 s26, 72
    s_nop 0
    s_cbranch_scc1 stg_142
    s_waitcnt vmcnt(9)
    s_barrier
    v_add_u32 v14, 0, v13
    ds_read_b64_tr_b16 a[40:41], v14 offset:0
    ds_read_b64_tr_b16 a[42:43], v14 offset:1664
    ds_read_b64_tr_b16 a[120:121], v14 offset:32
    ds_read_b64_tr_b16 a[122:123], v14 offset:1696
    ds_read_b64_tr_b16 a[44:45], v14 offset:13312
    ds_read_b64_tr_b16 a[46:47], v14 offset:14976
    ds_read_b64_tr_b16 a[124:125], v14 offset:13344
    ds_read_b64_tr_b16 a[126:127], v14 offset:15008
    ds_read_b64_tr_b16 a[48:49], v14 offset:26624
    ds_read_b64_tr_b16 a[50:51], v14 offset:28288
    ds_read_b64_tr_b16 a[128:129], v14 offset:26656
    ds_read_b64_tr_b16 a[130:131], v14 offset:28320
    ds_read_b64_tr_b16 a[52:53], v14 offset:39936
    ds_read_b64_tr_b16 a[54:55], v14 offset:41600
    ds_read_b64_tr_b16 a[132:133], v14 offset:39968
    ds_read_b64_tr_b16 a[134:135], v14 offset:41632
    ds_read_b64_tr_b16 a[56:57], v14 offset:53248
    ds_read_b64_tr_b16 a[58:59], v14 offset:54912
    ds_read_b64_tr_b16 a[136:137], v14 offset:53280
    ds_read_b64_tr_b16 a[138:139], v14 offset:54944
    s_waitcnt lgkmcnt(0)
    s_barrier
    s_waitcnt vmcnt(0)
    s_barrier
    v_add_u32 v14, 81920, v13
    ds_read_b64_tr_b16 a[60:61], v14 offset:0
    ds_read_b64_tr_b16 a[62:63], v14 offset:1664
    ds_read_b64_tr_b16 a[140:141], v14 offset:32
    ds_read_b64_tr_b16 a[142:143], v14 offset:1696
    ds_read_b64_tr_b16 a[64:65], v14 offset:13312
    ds_read_b64_tr_b16 a[66:67], v14 offset:14976
    ds_read_b64_tr_b16 a[144:145], v14 offset:13344
    ds_read_b64_tr_b16 a[146:147], v14 offset:15008
    ds_read_b64_tr_b16 a[68:69], v14 offset:26624
    ds_read_b64_tr_b16 a[70:71], v14 offset:28288
    ds_read_b64_tr_b16 a[148:149], v14 offset:26656
    ds_read_b64_tr_b16 a[150:151], v14 offset:28320
    ds_read_b64_tr_b16 a[72:73], v14 offset:39936
    ds_read_b64_tr_b16 a[74:75], v14 offset:41600
    ds_read_b64_tr_b16 a[152:153], v14 offset:39968
    ds_read_b64_tr_b16 a[154:155], v14 offset:41632
    ds_read_b64_tr_b16 a[76:77], v14 offset:53248
    ds_read_b64_tr_b16 a[78:79], v14 offset:54912
    ds_read_b64_tr_b16 a[156:157], v14 offset:53280
    ds_read_b64_tr_b16 a[158:159], v14 offset:54944
    s_waitcnt lgkmcnt(0)
    s_barrier
    s_cmp_lg_u32 s24, 0
    s_cbranch_scc1 wst_143
    v_and_b32 v5, 3, v1
    v_lshlrev_b32 v5, 6, v5
    s_mov_b32 s100, 0
    s_nop 3
poll_144:
    buffer_load_dword v6, v5, s[16:19], 0 offen sc1
    s_waitcnt vmcnt(0)
    v_cmp_gt_u32 vcc, 32, v6
    s_nop 3
    s_cbranch_vccz polld_145
    s_cmp_lg_u32 s25, 0
    s_cbranch_scc1 polld_145
    s_add_u32 s100, s100, 1
    s_cmp_lt_u32 s100, 400000
    s_sleep 8
    s_cbranch_scc1 poll_144
    s_mov_b32 s25, 1
    s_lshl_b32 s100, s3, 16
    s_lshl_b32 s101, s62, 8
    s_or_b32 s100, s100, s101
    s_or_b32 s100, s100, 1
    v_mov_b32 v3, s100
    v_mov_b32 v4, 36
    buffer_store_dword v3, v4, s[16:19], 0 offen sc1
    s_nop 3
polld_145:
wst_143:
    s_barrier
    s_mov_b32 s69, 0x600000
    s_mov_b32 s70, 0
    s_mul_i32 s26, s24, 5120
    s_add_u32 s27, s26, s69
    s_add_u32 s26, s26, s70
    s_add_u32 m0, s26, 0
    s_nop 0
    buffer_load_dwordx4 v2, s[4:7], s27 offen offset:0 sc1 lds
    buffer_load_dwordx4 v2, s[4:7], s27 offen offset:1024 sc1 lds
    buffer_load_dwordx4 v2, s[4:7], s27 offen offset:2048 sc1 lds
    buffer_load_dwordx4 v2, s[4:7], s27 offen offset:3072 sc1 lds
    s_add_u32 m0, s26, 4096
    s_add_u32 s27, s27, 4096
    buffer_load_dwordx4 v2, s[4:7], s27 offen offset:0 sc1 lds
    s_waitcnt vmcnt(0)
K_K_loop:
    s_cmp_lt_u32 s24, 4
    s_cbranch_scc1 kw_146
    s_waitcnt vmcnt(1)
    s_branch kw2_147
kw_146:
    s_waitcnt vmcnt(2)
kw2_147:
    s_barrier
    s_cmp_ge_u32 s62, 64
    s_cbranch_scc1 K_K_done
    s_cmp_lg_u32 s24, 7
    s_cbranch_scc1 ks_148
    s_cmp_lt_u32 s62, 5
    s_cbranch_scc1 ks_148
    s_sub_u32 s26, s62, 1
    v_mov_b32 v3, s26
    v_mov_b32 v4, 0
    s_mov_b64 exec, 1
    buffer_store_dword v3, v4, s[4:7], s68 offen sc1
    s_mov_b64 exec, -1
    s_nop 1
ks_148:
    s_add_u32 s69, s69, 40960
    s_xor_b32 s29, s70, 40960
    s_mul_i32 s26, s24, 5120
    s_add_u32 s27, s26, s69
    s_add_u32 s26, s26, s29
    s_add_u32 m0, s26, 0
    s_nop 0
    buffer_load_dwordx4 v2, s[4:7], s27 offen offset:0 sc1 lds
    buffer_load_dwordx4 v2, s[4:7], s27 offen offset:1024 sc1 lds
    buffer_load_dwordx4 v2, s[4:7], s27 offen offset:2048 sc1 lds
    buffer_load_dwordx4 v2, s[4:7], s27 offen offset:3072 sc1 lds
    s_add_u32 m0, s26, 4096
    s_add_u32 s27, s27, 4096
    buffer_load_dwordx4 v2, s[4:7], s27 offen offset:0 sc1 lds
    s_mov_b32 s71, 0
K_K_unit:
    s_add_u32 s26, s65, s71
    s_mul_i32 s27, s26, 20480
    s_add_u32 s27, s27, s70
    v_add_u32 v10, s27, v2
    s_lshl_b32 s27, s62, 5
    s_add_u32 s27, s27, s63
    s_mul_i32 s27, s27, 12
    s_mul_i32 s26, s26, 6
    s_add_u32 s27, s27, s26
    s_add_u32 s27, s27, s64
    s_lshl_b32 s27, s27, 10
    s_add_u32 s72, s27, 0x3000000
    ds_read_b128 v[24:27], v10 offset:0
    ds_read_b128 v[28:31], v10 offset:1024
    ds_read_b128 v[32:35], v10 offset:2048
    ds_read_b128 v[36:39], v10 offset:3072
    s_waitcnt lgkmcnt(3)
    v_mfma_f32_16x16x32_bf16 v[12:15], a[0:3], v[24:27], 0
    v_mfma_f32_16x16x32_bf16 v[16:19], a[80:83], v[24:27], 0
    ds_read_b128 v[24:27], v10 offset:4096
    s_waitcnt lgkmcnt(3)
    v_mfma_f32_16x16x32_bf16 v[12:15], a[4:7], v[28:31], v[12:15]
    v_mfma_f32_16x16x32_bf16 v[16:19], a[84:87], v[28:31], v[16:19]
    ds_read_b128 v[28:31], v10 offset:5120
    s_waitcnt lgkmcnt(3)
    v_mfma_f32_16x16x32_bf16 v[12:15], a[8:11], v[32:35], v[12:15]
    v_mfma_f32_16x16x32_bf16 v[16:19], a[88:91], v[32:35], v[16:19]
    ds_read_b128 v[32:35], v10 offset:6144
    s_waitcnt lgkmcnt(3)
    v_mfma_f32_16x16x32_bf16 v[12:15], a[12:15], v[36:39], v[12:15]
    v_mfma_f32_16x16x32_bf16 v[16:19], a[92:95], v[36:39], v[16:19]
    ds_read_b128 v[36:39], v10 offset:7168
    s_waitcnt lgkmcnt(3)
    v_mfma_f32_16x16x32_bf16 v[12:15], a[16:19], v[24:27], v[12:15]
    v_mfma_f32_16x16x32_bf16 v[16:19], a[96:99], v[24:27], v[16:19]
    ds_read_b128 v[24:27], v10 offset:8192
    s_waitcnt lgkmcnt(3)
    v_mfma_f32_16x16x32_bf16 v[12:15], a[20:23], v[28:31], v[12:15]
    v_mfma_f32_16x16x32_bf16 v[16:19], a[100:103], v[28:31], v[16:19]
    ds_read_b128 v[28:31], v10 offset:9216
    s_waitcnt lgkmcnt(3)
    v_mfma_f32_16x16x32_bf16 v[12:15], a[24:27], v[32:35], v[12:15]
    v_mfma_f32_16x16x32_bf16 v[16:19], a[104:107], v[32:35], v[16:19]
    ds_read_b128 v[32:35], v10 offset:10240
    s_waitcnt lgkmcnt(3)
    v_mfma_f32_16x16x32_bf16 v[12:15], a[28:31], v[36:39], v[12:15]
    v_mfma_f32_16x16x32_bf16 v[16:19], a[108:111], v[36:39], v[16:19]
    ds_read_b128 v[36:39], v10 offset:11264
    s_waitcnt lgkmcnt(3)
    v_mfma_f32_16x16x32_bf16 v[12:15], a[32:35], v[24:27], v[12:15]
    v_mfma_f32_16x16x32_bf16 v[16:19], a[112:115], v[24:27], v[16:19]
    ds_read_b128 v[24:27], v10 offset:12288
    s_waitcnt lgkmcnt(3)
    v_mfma_f32_16x16x32_bf16 v[12:15], a[36:39], v[28:31], v[12:15]
    v_mfma_f32_16x16x32_bf16 v[16:19], a[116:119], v[28:31], v[16:19]
    ds_read_b128 v[28:31], v10 offset:13312
    s_waitcnt lgkmcnt(3)
    v_mfma_f32_16x16x32_bf16 v[12:15], a[40:43], v[32:35], v[12:15]
    v_mfma_f32_16x16x32_bf16 v[16:19], a[120:123], v[32:35], v[16:19]
    ds_read_b128 v[32:35], v10 offset:14336
    s_waitcnt lgkmcnt(3)
    v_mfma_f32_16x16x32_bf16 v[12:15], a[44:47], v[36:39], v[12:15]
    v_mfma_f32_16x16x32_bf16 v[16:19], a[124:127], v[36:39], v[16:19]
    ds_read_b128 v[36:39], v10 offset:15360
    s_waitcnt lgkmcnt(3)
    v_mfma_f32_16x16x32_bf16 v[12:15], a[48:51], v[24:27], v[12:15]
    v_mfma_f32_16x16x32_bf16 v[16:19], a[128:131], v[24:27], v[16:19]
    ds_read_b128 v[24:27], v10 offset:16384
    s_waitcnt lgkmcnt(3)
    v_mfma_f32_16x16x32_bf16 v[12:15], a[52:55], v[28:31], v[12:15]
    v_mfma_f32_16x16x32_bf16 v[16:19], a[132:135], v[28:31], v[16:19]
    ds_read_b128 v[28:31], v10 offset:17408
    s_waitcnt lgkmcnt(3)
    v_mfma_f32_16x16x32_bf16 v[12:15], a[56:59], v[32:35], v[12:15]
    v_mfma_f32_16x16x32_bf16 v[16:19], a[136:139], v[32:35], v[16:19]
    ds_read_b128 v[32:35], v10 offset:18432
    s_waitcnt lgkmcnt(3)
    v_mfma_f32_16x16x32_bf16 v[12:15], a[60:63], v[36:39], v[12:15]
    v_mfma_f32_16x16x32_bf16 v[16:19], a[140:143], v[36:39], v[16:19]
    ds_read_b128 v[36:39], v10 offset:19456
    s_waitcnt lgkmcnt(3)
    v_mfma_f32_16x16x32_bf16 v[12:15], a[64:67], v[24:27], v[12:15]
    v_mfma_f32_16x16x32_bf16 v[16:19], a[144:147], v[24:27], v[16:19]
    s_waitcnt lgkmcnt(2)
    v_mfma_f32_16x16x32_bf16 v[12:15], a[68:71], v[28:31], v[12:15]
    v_mfma_f32_16x16x32_bf16 v[16:19], a[148:151], v[28:31], v[16:19]
    s_waitcnt lgkmcnt(1)
    v_mfma_f32_16x16x32_bf16 v[12:15], a[72:75], v[32:35], v[12:15]
    v_mfma_f32_16x16x32_bf16 v[16:19], a[152:155], v[32:35], v[16:19]
    s_waitcnt lgkmcnt(0)
    v_mfma_f32_16x16x32_bf16 v[12:15], a[76:79], v[36:39], v[12:15]
    v_mfma_f32_16x16x32_bf16 v[16:19], a[156:159], v[36:39], v[16:19]
    s_nop 6
    v_cvt_pk_bf16_f32 v20, v12, v13
    v_cvt_pk_bf16_f32 v21, v14, v15
    v_cvt_pk_bf16_f32 v22, v16, v17
    v_cvt_pk_bf16_f32 v23, v18, v19
    buffer_store_dwordx4 v[20:23], v2, s[4:7], s72 offen sc1
    s_add_u32 s71, s71, 1
    s_cmp_lt_u32 s71, s66
    s_nop 0
    s_cbranch_scc1 K_K_unit
    s_add_u32 s62, s62, 1
    s_xor_b32 s70, s70, 40960
    s_cmp_gt_u32 s62, 3
    s_cbranch_scc1 K_K_loop
    s_waitcnt vmcnt(0)
    s_barrier
    s_cmp_lg_u32 s24, 6
    s_cbranch_scc1 K_K_loop
    v_mov_b32 v3, s62
    v_mov_b32 v4, 0
    s_mov_b64 exec, 1
    buffer_store_dword v3, v4, s[4:7], s68 offen sc1
    s_mov_b64 exec, -1
    s_waitcnt vmcnt(0)
    s_branch K_K_loop
K_K_done:
    s_waitcnt vmcnt(0)
    s_barrier
    s_cmp_lg_u32 s24, 7
    s_cbranch_scc1 kd_149
    v_mov_b32 v3, 64
    v_mov_b32 v4, 0
    s_mov_b64 exec, 1
    buffer_store_dword v3, v4, s[4:7], s68 offen sc1
    s_mov_b64 exec, -1
    s_nop 1
kd_149:
    s_mov_b32 s87, 1
    s_branch R_M
R_VP:
    s_lshl_b32 s68, s63, 7
    s_add_u32 s68, s68, 69632
    s_mov_b32 s8, s40
    s_and_b32 s9, s41, 0xffff
    s_mov_b32 s10, 0x780000
    s_mov_b32 s11, 0x20000
    s_sub_u32 s26, s24, 4
    s_lshr_b32 s27, s26, 1
    s_add_u32 s27, s27, 4
    s_and_b32 s26, s26, 1
    s_cmp_lt_u32 s24, 4
    s_cselect_b32 s64, s24, s27
    s_cselect_b32 s65, 0, s26
    s_cselect_b32 s66, 2, 1
    s_mul_i32 s67, s63, 384
    s_lshl_b32 s29, s64, 6
    v_lshrrev_b32 v3, 4, v1
    v_lshlrev_b32 v3, 3, v3
    v_bfe_u32 v4, v1, 2, 2
    v_add_u32 v3, v3, v4
    v_mul_u32_u24 v3, 416, v3
    v_and_b32 v4, 3, v1
    v_lshl_add_u32 v3, v4, 3, v3
    v_add_u32 v13, s29, v3
    s_mov_b32 s26, s24
    s_add_u32 s28, s67, 0
    s_nop 2
stg_150:
    s_min_u32 s27, s26, 64
    s_lshl_b32 s27, s27, 6
    v_add_u32 v10, s27, v1
    s_lshl_b32 s27, s27, 4
    v_mul_u32_u24 v11, 40330, v10
    v_lshrrev_b32 v11, 20, v11
    v_mul_u32_u24 v12, 26, v11
    v_sub_u32 v12, v10, v12
    v_min_u32 v12, 23, v12
    v_mul_u32_u24 v11, 12288, v11
    s_add_u32 m0, s27, 0
    v_lshl_add_u32 v11, v12, 4, v11
    s_add_u32 s26, s26, 8
    buffer_load_dwordx4 v11, s[8:11], s28 offen lds
    s_cmp_lt_u32 s26, 72
    s_nop 0
    s_cbranch_scc1 stg_150
    s_mov_b32 s26, s24
    s_add_u32 s28, s67, 1966080
stg_151:
    s_min_u32 s27, s26, 64
    s_lshl_b32 s27, s27, 6
    v_add_u32 v10, s27, v1
    s_lshl_b32 s27, s27, 4
    v_mul_u32_u24 v11, 40330, v10
    v_lshrrev_b32 v11, 20, v11
    v_mul_u32_u24 v12, 26, v11
    v_sub_u32 v12, v10, v12
    v_min_u32 v12, 23, v12
    v_mul_u32_u24 v11, 12288, v11
    s_add_u32 m0, s27, 81920
    v_lshl_add_u32 v11, v12, 4, v11
    s_add_u32 s26, s26, 8
    buffer_load_dwordx4 v11, s[8:11], s28 offen lds
    s_cmp_lt_u32 s26, 72
    s_nop 0
    s_cbranch_scc1 stg_151
    s_waitcnt vmcnt(9)
    s_barrier
    v_add_u32 v14, 0, v13
    ds_read_b64_tr_b16 a[0:1], v14 offset:0
    ds_read_b64_tr_b16 a[2:3], v14 offset:1664
    ds_read_b64_tr_b16 a[80:81], v14 offset:32
    ds_read_b64_tr_b16 a[82:83], v14 offset:1696
    ds_read_b64_tr_b16 a[4:5], v14 offset:13312
    ds_read_b64_tr_b16 a[6:7], v14 offset:14976
    ds_read_b64_tr_b16 a[84:85], v14 offset:13344
    ds_read_b64_tr_b16 a[86:87], v14 offset:15008
    ds_read_b64_tr_b16 a[8:9], v14 offset:26624
    ds_read_b64_tr_b16 a[10:11], v14 offset:28288
    ds_read_b64_tr_b16 a[88:89], v14 offset:26656
    ds_read_b64_tr_b16 a[90:91], v14 offset:28320
    ds_read_b64_tr_b16 a[12:13], v14 offset:39936
    ds_read_b64_tr_b16 a[14:15], v14 offset:41600
    ds_read_b64_tr_b16 a[92:93], v14 offset:39968
    ds_read_b64_tr_b16 a[94:95], v14 offset:41632
    ds_read_b64_tr_b16 a[16:17], v14 offset:53248
    ds_read_b64_tr_b16 a[18:19], v14 offset:54912
    ds_read_b64_tr_b16 a[96:97], v14 offset:53280
    ds_read_b64_tr_b16 a[98:99], v14 offset:54944
    s_waitcnt lgkmcnt(0)
    s_barrier
    s_mov_b32 s26, s24
    s_add_u32 s28, s67, 3932160
stg_152:
    s_min_u32 s27, s26, 64
    s_lshl_b32 s27, s27, 6
    v_add_u32 v10, s27, v1
    s_lshl_b32 s27, s27, 4
    v_mul_u32_u24 v11, 40330, v10
    v_lshrrev_b32 v11, 20, v11
    v_mul_u32_u24 v12, 26, v11
    v_sub_u32 v12, v10, v12
    v_min_u32 v12, 23, v12
    v_mul_u32_u24 v11, 12288, v11
    s_add_u32 m0, s27, 0
    v_lshl_add_u32 v11, v12, 4, v11
    s_add_u32 s26, s26, 8
    buffer_load_dwordx4 v11, s[8:11], s28 offen lds
    s_cmp_lt_u32 s26, 72
    s_nop 0
    s_cbranch_scc1 stg_152
    s_waitcnt vmcnt(9)
    s_barrier
    v_add_u32 v14, 81920, v13
    ds_read_b64_tr_b16 a[20:21], v14 offset:0
    ds_read_b64_tr_b16 a[22:23], v14 offset:1664
    ds_read_b64_tr_b16 a[100:101], v14 offset:32
    ds_read_b64_tr_b16 a[102:103], v14 offset:1696
    ds_read_b64_tr_b16 a[24:25], v14 offset:13312
    ds_read_b64_tr_b16 a[26:27], v14 offset:14976
    ds_read_b64_tr_b16 a[104:105], v14 offset:13344
    ds_read_b64_tr_b16 a[106:107], v14 offset:15008
    ds_read_b64_tr_b16 a[28:29], v14 offset:26624
    ds_read_b64_tr_b16 a[30:31], v14 offset:28288
    ds_read_b64_tr_b16 a[108:109], v14 offset:26656
    ds_read_b64_tr_b16 a[110:111], v14 offset:28320
    ds_read_b64_tr_b16 a[32:33], v14 offset:39936
    ds_read_b64_tr_b16 a[34:35], v14 offset:41600
    ds_read_b64_tr_b16 a[112:113], v14 offset:39968
    ds_read_b64_tr_b16 a[114:115], v14 offset:41632
    ds_read_b64_tr_b16 a[36:37], v14 offset:53248
    ds_read_b64_tr_b16 a[38:39], v14 offset:54912
    ds_read_b64_tr_b16 a[116:117], v14 offset:53280
    ds_read_b64_tr_b16 a[118:119], v14 offset:54944
    s_waitcnt lgkmcnt(0)
    s_barrier
    s_mov_b32 s26, s24
    s_add_u32 s28, s67, 5898240
stg_153:
    s_min_u32 s27, s26, 64
    s_lshl_b32 s27, s27, 6
    v_add_u32 v10, s27, v1
    s_lshl_b32 s27, s27, 4
    v_mul_u32_u24 v11, 40330, v10
    v_lshrrev_b32 v11, 20, v11
    v_mul_u32_u24 v12, 26, v11
    v_sub_u32 v12, v10, v12
    v_min_u32 v12, 23, v12
    v_mul_u32_u24 v11, 12288, v11
    s_add_u32 m0, s27, 81920
    v_lshl_add_u32 v11, v12, 4, v11
    s_add_u32 s26, s26, 8
    buffer_load_dwordx4 v11, s[8:11], s28 offen lds
    s_cmp_lt_u32 s26, 72
    s_nop 0
    s_cbranch_scc1 stg_153
    s_waitcnt vmcnt(9)
    s_barrier
    v_add_u32 v14, 0, v13
    ds_read_b64_tr_b16 a[40:41], v14 offset:0
    ds_read_b64_tr_b16 a[42:43], v14 offset:1664
    ds_read_b64_tr_b16 a[120:121], v14 offset:32
    ds_read_b64_tr_b16 a[122:123], v14 offset:1696
    ds_read_b64_tr_b16 a[44:45], v14 offset:13312
    ds_read_b64_tr_b16 a[46:47], v14 offset:14976
    ds_read_b64_tr_b16 a[124:125], v14 offset:13344
    ds_read_b64_tr_b16 a[126:127], v14 offset:15008
    ds_read_b64_tr_b16 a[48:49], v14 offset:26624
    ds_read_b64_tr_b16 a[50:51], v14 offset:28288
    ds_read_b64_tr_b16 a[128:129], v14 offset:26656
    ds_read_b64_tr_b16 a[130:131], v14 offset:28320
    ds_read_b64_tr_b16 a[52:53], v14 offset:39936
    ds_read_b64_tr_b16 a[54:55], v14 offset:41600
    ds_read_b64_tr_b16 a[132:133], v14 offset:39968
    ds_read_b64_tr_b16 a[134:135], v14 offset:41632
    ds_read_b64_tr_b16 a[56:57], v14 offset:53248
    ds_read_b64_tr_b16 a[58:59], v14 offset:54912
    ds_read_b64_tr_b16 a[136:137], v14 offset:53280
    ds_read_b64_tr_b16 a[138:139], v14 offset:54944
    s_waitcnt lgkmcnt(0)
    s_barrier
    s_waitcnt vmcnt(0)
    s_barrier
    v_add_u32 v14, 81920, v13
    ds_read_b64_tr_b16 a[60:61], v14 offset:0
    ds_read_b64_tr_b16 a[62:63], v14 offset:1664
    ds_read_b64_tr_b16 a[140:141], v14 offset:32
    ds_read_b64_tr_b16 a[142:143], v14 offset:1696
    ds_read_b64_tr_b16 a[64:65], v14 offset:13312
    ds_read_b64_tr_b16 a[66:67], v14 offset:14976
    ds_read_b64_tr_b16 a[144:145], v14 offset:13344
    ds_read_b64_tr_b16 a[146:147], v14 offset:15008
    ds_read_b64_tr_b16 a[68:69], v14 offset:26624
    ds_read_b64_tr_b16 a[70:71], v14 offset:28288
    ds_read_b64_tr_b16 a[148:149], v14 offset:26656
    ds_read_b64_tr_b16 a[150:151], v14 offset:28320
    ds_read_b64_tr_b16 a[72:73], v14 offset:39936
    ds_read_b64_tr_b16 a[74:75], v14 offset:41600
    ds_read_b64_tr_b16 a[152:153], v14 offset:39968
    ds_read_b64_tr_b16 a[154:155], v14 offset:41632
    ds_read_b64_tr_b16 a[76:77], v14 offset:53248
    ds_read_b64_tr_b16 a[78:79], v14 offset:54912
    ds_read_b64_tr_b16 a[156:157], v14 offset:53280
    ds_read_b64_tr_b16 a[158:159], v14 offset:54944
    s_waitcnt lgkmcnt(0)
    s_barrier
    s_cmp_lg_u32 s24, 0
    s_cbranch_scc1 wst_154
    v_and_b32 v5, 3, v1
    v_lshlrev_b32 v5, 6, v5
    s_mov_b32 s100, 0
    s_nop 3
poll_155:
    buffer_load_dword v6, v5, s[16:19], 0 offen sc1
    s_waitcnt vmcnt(0)
    v_cmp_gt_u32 vcc, 32, v6
    s_nop 3
    s_cbranch_vccz polld_156
    s_cmp_lg_u32 s25, 0
    s_cbranch_scc1 polld_156
    s_add_u32 s100, s100, 1
    s_cmp_lt_u32 s100, 400000
    s_sleep 8
    s_cbranch_scc1 poll_155
    s_mov_b32 s25, 1
    s_lshl_b32 s100, s3, 16
    s_lshl_b32 s101, s62, 8
    s_or_b32 s100, s100, s101
    s_or_b32 s100, s100, 1
    v_mov_b32 v3, s100
    v_mov_b32 v4, 36
    buffer_store_dword v3, v4, s[16:19], 0 offen sc1
    s_nop 3
polld_156:
wst_154:
    s_barrier
    s_mov_b32 s69, 0x600000
    s_mov_b32 s70, 0
    s_mul_i32 s26, s24, 5120
    s_add_u32 s27, s26, s69
    s_add_u32 s26, s26, s70
    s_add_u32 m0, s26, 0
    s_nop 0
    buffer_load_dwordx4 v2, s[4:7], s27 offen offset:0 sc1 lds
    buffer_load_dwordx4 v2, s[4:7], s27 offen offset:1024 sc1 lds
    buffer_load_dwordx4 v2, s[4:7], s27 offen offset:2048 sc1 lds
    buffer_load_dwordx4 v2, s[4:7], s27 offen offset:3072 sc1 lds
    s_add_u32 m0, s26, 4096
    s_add_u32 s27, s27, 4096
    buffer_load_dwordx4 v2, s[4:7], s27 offen offset:0 sc1 lds
    s_waitcnt vmcnt(0)
VP_K_loop:
    s_cmp_lt_u32 s24, 4
    s_cbranch_scc1 kw_157
    s_waitcnt vmcnt(1)
    s_branch kw2_158
kw_157:
    s_waitcnt vmcnt(2)
kw2_158:
    s_barrier
    s_cmp_ge_u32 s62, 64
    s_cbranch_scc1 VP_K_done
    s_cmp_lg_u32 s24, 7
    s_cbranch_scc1 ks_159
    s_cmp_lt_u32 s62, 5
    s_cbranch_scc1 ks_159
    s_sub_u32 s26, s62, 1
    v_mov_b32 v3, s26
    v_mov_b32 v4, 0
    s_mov_b64 exec, 1
    buffer_store_dword v3, v4, s[4:7], s68 offen sc1
    s_mov_b64 exec, -1
    s_nop 1
ks_159:
    s_add_u32 s69, s69, 40960
    s_xor_b32 s29, s70, 40960
    s_mul_i32 s26, s24, 5120
    s_add_u32 s27, s26, s69
    s_add_u32 s26, s26, s29
    s_add_u32 m0, s26, 0
    s_nop 0
    buffer_load_dwordx4 v2, s[4:7], s27 offen offset:0 sc1 lds
    buffer_load_dwordx4 v2, s[4:7], s27 offen offset:1024 sc1 lds
    buffer_load_dwordx4 v2, s[4:7], s27 offen offset:2048 sc1 lds
    buffer_load_dwordx4 v2, s[4:7], s27 offen offset:3072 sc1 lds
    s_add_u32 m0, s26, 4096
    s_add_u32 s27, s27, 4096
    buffer_load_dwordx4 v2, s[4:7], s27 offen offset:0 sc1 lds
    s_mov_b32 s71, 0
VP_K_unit:
    s_add_u32 s26, s65, s71
    s_mul_i32 s27, s26, 20480
    s_add_u32 s27, s27, s70
    v_add_u32 v10, s27, v2
    s_lshl_b32 s27, s62, 5
    s_add_u32 s27, s27, s63
    s_mul_i32 s27, s27, 12
    s_mul_i32 s26, s26, 6
    s_add_u32 s27, s27, s26
    s_add_u32 s27, s27, s64
    s_lshl_b32 s27, s27, 10
    s_add_u32 s72, s27, 0xc800000
    ds_read_b128 v[24:27], v10 offset:0
    ds_read_b128 v[28:31], v10 offset:1024
    ds_read_b128 v[32:35], v10 offset:2048
    ds_read_b128 v[36:39], v10 offset:3072
    s_waitcnt lgkmcnt(3)
    v_mfma_f32_16x16x32_bf16 v[12:15], a[0:3], v[24:27], 0
    v_mfma_f32_16x16x32_bf16 v[16:19], a[80:83], v[24:27], 0
    ds_read_b128 v[24:27], v10 offset:4096
    s_waitcnt lgkmcnt(3)
    v_mfma_f32_16x16x32_bf16 v[12:15], a[4:7], v[28:31], v[12:15]
    v_mfma_f32_16x16x32_bf16 v[16:19], a[84:87], v[28:31], v[16:19]
    ds_read_b128 v[28:31], v10 offset:5120
    s_waitcnt lgkmcnt(3)
    v_mfma_f32_16x16x32_bf16 v[12:15], a[8:11], v[32:35], v[12:15]
    v_mfma_f32_16x16x32_bf16 v[16:19], a[88:91], v[32:35], v[16:19]
    ds_read_b128 v[32:35], v10 offset:6144
    s_waitcnt lgkmcnt(3)
    v_mfma_f32_16x16x32_bf16 v[12:15], a[12:15], v[36:39], v[12:15]
    v_mfma_f32_16x16x32_bf16 v[16:19], a[92:95], v[36:39], v[16:19]
    ds_read_b128 v[36:39], v10 offset:7168
    s_waitcnt lgkmcnt(3)
    v_mfma_f32_16x16x32_bf16 v[12:15], a[16:19], v[24:27], v[12:15]
    v_mfma_f32_16x16x32_bf16 v[16:19], a[96:99], v[24:27], v[16:19]
    ds_read_b128 v[24:27], v10 offset:8192
    s_waitcnt lgkmcnt(3)
    v_mfma_f32_16x16x32_bf16 v[12:15], a[20:23], v[28:31], v[12:15]
    v_mfma_f32_16x16x32_bf16 v[16:19], a[100:103], v[28:31], v[16:19]
    ds_read_b128 v[28:31], v10 offset:9216
    s_waitcnt lgkmcnt(3)
    v_mfma_f32_16x16x32_bf16 v[12:15], a[24:27], v[32:35], v[12:15]
    v_mfma_f32_16x16x32_bf16 v[16:19], a[104:107], v[32:35], v[16:19]
    ds_read_b128 v[32:35], v10 offset:10240
    s_waitcnt lgkmcnt(3)
    v_mfma_f32_16x16x32_bf16 v[12:15], a[28:31], v[36:39], v[12:15]
    v_mfma_f32_16x16x32_bf16 v[16:19], a[108:111], v[36:39], v[16:19]
    ds_read_b128 v[36:39], v10 offset:11264
    s_waitcnt lgkmcnt(3)
    v_mfma_f32_16x16x32_bf16 v[12:15], a[32:35], v[24:27], v[12:15]
    v_mfma_f32_16x16x32_bf16 v[16:19], a[112:115], v[24:27], v[16:19]
    ds_read_b128 v[24:27], v10 offset:12288
    s_waitcnt lgkmcnt(3)
    v_mfma_f32_16x16x32_bf16 v[12:15], a[36:39], v[28:31], v[12:15]
    v_mfma_f32_16x16x32_bf16 v[16:19], a[116:119], v[28:31], v[16:19]
    ds_read_b128 v[28:31], v10 offset:13312
    s_waitcnt lgkmcnt(3)
    v_mfma_f32_16x16x32_bf16 v[12:15], a[40:43], v[32:35], v[12:15]
    v_mfma_f32_16x16x32_bf16 v[16:19], a[120:123], v[32:35], v[16:19]
    ds_read_b128 v[32:35], v10 offset:14336
    s_waitcnt lgkmcnt(3)
    v_mfma_f32_16x16x32_bf16 v[12:15], a[44:47], v[36:39], v[12:15]
    v_mfma_f32_16x16x32_bf16 v[16:19], a[124:127], v[36:39], v[16:19]
    ds_read_b128 v[36:39], v10 offset:15360
    s_waitcnt lgkmcnt(3)
    v_mfma_f32_16x16x32_bf16 v[12:15], a[48:51], v[24:27], v[12:15]
    v_mfma_f32_16x16x32_bf16 v[16:19], a[128:131], v[24:27], v[16:19]
    ds_read_b128 v[24:27], v10 offset:16384
    s_waitcnt lgkmcnt(3)
    v_mfma_f32_16x16x32_bf16 v[12:15], a[52:55], v[28:31], v[12:15]
    v_mfma_f32_16x16x32_bf16 v[16:19], a[132:135], v[28:31], v[16:19]
    ds_read_b128 v[28:31], v10 offset:17408
    s_waitcnt lgkmcnt(3)
    v_mfma_f32_16x16x32_bf16 v[12:15], a[56:59], v[32:35], v[12:15]
    v_mfma_f32_16x16x32_bf16 v[16:19], a[136:139], v[32:35], v[16:19]
    ds_read_b128 v[32:35], v10 offset:18432
    s_waitcnt lgkmcnt(3)
    v_mfma_f32_16x16x32_bf16 v[12:15], a[60:63], v[36:39], v[12:15]
    v_mfma_f32_16x16x32_bf16 v[16:19], a[140:143], v[36:39], v[16:19]
    ds_read_b128 v[36:39], v10 offset:19456
    s_waitcnt lgkmcnt(3)
    v_mfma_f32_16x16x32_bf16 v[12:15], a[64:67], v[24:27], v[12:15]
    v_mfma_f32_16x16x32_bf16 v[16:19], a[144:147], v[24:27], v[16:19]
    s_waitcnt lgkmcnt(2)
    v_mfma_f32_16x16x32_bf16 v[12:15], a[68:71], v[28:31], v[12:15]
    v_mfma_f32_16x16x32_bf16 v[16:19], a[148:151], v[28:31], v[16:19]
    s_waitcnt lgkmcnt(1)
    v_mfma_f32_16x16x32_bf16 v[12:15], a[72:75], v[32:35], v[12:15]
    v_mfma_f32_16x16x32_bf16 v[16:19], a[152:155], v[32:35], v[16:19]
    s_waitcnt lgkmcnt(0)
    v_mfma_f32_16x16x32_bf16 v[12:15], a[76:79], v[36:39], v[12:15]
    v_mfma_f32_16x16x32_bf16 v[16:19], a[156:159], v[36:39], v[16:19]
    s_nop 6
    v_cvt_pk_bf16_f32 v20, v12, v13
    v_cvt_pk_bf16_f32 v21, v14, v15
    v_cvt_pk_bf16_f32 v22, v16, v17
    v_cvt_pk_bf16_f32 v23, v18, v19
    buffer_store_dwordx4 v[20:23], v2, s[4:7], s72 offen sc1
    s_add_u32 s71, s71, 1
    s_cmp_lt_u32 s71, s66
    s_nop 0
    s_cbranch_scc1 VP_K_unit
    s_add_u32 s62, s62, 1
    s_xor_b32 s70, s70, 40960
    s_cmp_gt_u32 s62, 3
    s_cbranch_scc1 VP_K_loop
    s_waitcnt vmcnt(0)
    s_barrier
    s_cmp_lg_u32 s24, 6
    s_cbranch_scc1 VP_K_loop
    v_mov_b32 v3, s62
    v_mov_b32 v4, 0
    s_mov_b64 exec, 1
    buffer_store_dword v3, v4, s[4:7], s68 offen sc1
    s_mov_b64 exec, -1
    s_waitcnt vmcnt(0)
    s_branch VP_K_loop
VP_K_done:
    s_waitcnt vmcnt(0)
    s_barrier
    s_cmp_lg_u32 s24, 7
    s_cbranch_scc1 kd_160
    v_mov_b32 v3, 64
    v_mov_b32 v4, 0
    s_mov_b64 exec, 1
    buffer_store_dword v3, v4, s[4:7], s68 offen sc1
    s_mov_b64 exec, -1
    s_nop 1
kd_160:
    s_endpgm
R_Q:
    s_lshl_b32 s68, s63, 7
    s_and_b32 s26, s24, 1
    s_lshl_b32 s26, s26, 2
    s_add_u32 s68, s68, s26
    s_add_u32 s68, s68, 16384
    s_mov_b32 s8, s36
    s_and_b32 s9, s37, 0xffff
    s_mov_b32 s10, 0x780000
    s_mov_b32 s11, 0x20000
    s_sub_u32 s26, s24, 4
    s_lshr_b32 s27, s26, 1
    s_add_u32 s27, s27, 4
    s_and_b32 s26, s26, 1
    s_cmp_lt_u32 s24, 4
    s_cselect_b32 s64, s24, s27
    s_cselect_b32 s65, 0, s26
    s_cselect_b32 s66, 2, 1
    s_mul_i32 s67, s63, 384
    s_lshl_b32 s29, s64, 6
    v_lshrrev_b32 v3, 4, v1
    v_lshlrev_b32 v3, 3, v3
    v_bfe_u32 v4, v1, 2, 2
    v_add_u32 v3, v3, v4
    v_mul_u32_u24 v3, 416, v3
    v_and_b32 v4, 3, v1
    v_lshl_add_u32 v3, v4, 3, v3
    v_add_u32 v13, s29, v3
    s_mov_b32 s26, s24
    s_add_u32 s28, s67, 0
    s_nop 2
stg_161:
    s_min_u32 s27, s26, 64
    s_lshl_b32 s27, s27, 6
    v_add_u32 v10, s27, v1
    s_lshl_b32 s27, s27, 4
    v_mul_u32_u24 v11, 40330, v10
    v_lshrrev_b32 v11, 20, v11
    v_mul_u32_u24 v12, 26, v11
    v_sub_u32 v12, v10, v12
    v_min_u32 v12, 23, v12
    v_mul_u32_u24 v11, 12288, v11
    s_add_u32 m0, s27, 0
    v_lshl_add_u32 v11, v12, 4, v11
    s_add_u32 s26, s26, 8
    buffer_load_dwordx4 v11, s[8:11], s28 offen lds
    s_cmp_lt_u32 s26, 72
    s_nop 0
    s_cbranch_scc1 stg_161
    s_mov_b32 s26, s24
    s_add_u32 s28, s67, 1966080
stg_162:
    s_min_u32 s27, s26, 64
    s_lshl_b32 s27, s27, 6
    v_add_u32 v10, s27, v1
    s_lshl_b32 s27, s27, 4
    v_mul_u32_u24 v11, 40330, v10
    v_lshrrev_b32 v11, 20, v11
    v_mul_u32_u24 v12, 26, v11
    v_sub_u32 v12, v10, v12
    v_min_u32 v12, 23, v12
    v_mul_u32_u24 v11, 12288, v11
    s_add_u32 m0, s27, 81920
    v_lshl_add_u32 v11, v12, 4, v11
    s_add_u32 s26, s26, 8
    buffer_load_dwordx4 v11, s[8:11], s28 offen lds
    s_cmp_lt_u32 s26, 72
    s_nop 0
    s_cbranch_scc1 stg_162
    s_waitcnt vmcnt(9)
    s_barrier
    v_add_u32 v14, 0, v13
    ds_read_b64_tr_b16 a[0:1], v14 offset:0
    ds_read_b64_tr_b16 a[2:3], v14 offset:1664
    ds_read_b64_tr_b16 a[80:81], v14 offset:32
    ds_read_b64_tr_b16 a[82:83], v14 offset:1696
    ds_read_b64_tr_b16 a[4:5], v14 offset:13312
    ds_read_b64_tr_b16 a[6:7], v14 offset:14976
    ds_read_b64_tr_b16 a[84:85], v14 offset:13344
    ds_read_b64_tr_b16 a[86:87], v14 offset:15008
    ds_read_b64_tr_b16 a[8:9], v14 offset:26624
    ds_read_b64_tr_b16 a[10:11], v14 offset:28288
    ds_read_b64_tr_b16 a[88:89], v14 offset:26656
    ds_read_b64_tr_b16 a[90:91], v14 offset:28320
    ds_read_b64_tr_b16 a[12:13], v14 offset:39936
    ds_read_b64_tr_b16 a[14:15], v14 offset:41600
    ds_read_b64_tr_b16 a[92:93], v14 offset:39968
    ds_read_b64_tr_b16 a[94:95], v14 offset:41632
    ds_read_b64_tr_b16 a[16:17], v14 offset:53248
    ds_read_b64_tr_b16 a[18:19], v14 offset:54912
    ds_read_b64_tr_b16 a[96:97], v14 offset:53280
    ds_read_b64_tr_b16 a[98:99], v14 offset:54944
    s_waitcnt lgkmcnt(0)
    s_barrier
    s_mov_b32 s26, s24
    s_add_u32 s28, s67, 3932160
stg_163:
    s_min_u32 s27, s26, 64
    s_lshl_b32 s27, s27, 6
    v_add_u32 v10, s27, v1
    s_lshl_b32 s27, s27, 4
    v_mul_u32_u24 v11, 40330, v10
    v_lshrrev_b32 v11, 20, v11
    v_mul_u32_u24 v12, 26, v11
    v_sub_u32 v12, v10, v12
    v_min_u32 v12, 23, v12
    v_mul_u32_u24 v11, 12288, v11
    s_add_u32 m0, s27, 0
    v_lshl_add_u32 v11, v12, 4, v11
    s_add_u32 s26, s26, 8
    buffer_load_dwordx4 v11, s[8:11], s28 offen lds
    s_cmp_lt_u32 s26, 72
    s_nop 0
    s_cbranch_scc1 stg_163
    s_waitcnt vmcnt(9)
    s_barrier
    v_add_u32 v14, 81920, v13
    ds_read_b64_tr_b16 a[20:21], v14 offset:0
    ds_read_b64_tr_b16 a[22:23], v14 offset:1664
    ds_read_b64_tr_b16 a[100:101], v14 offset:32
    ds_read_b64_tr_b16 a[102:103], v14 offset:1696
    ds_read_b64_tr_b16 a[24:25], v14 offset:13312
    ds_read_b64_tr_b16 a[26:27], v14 offset:14976
    ds_read_b64_tr_b16 a[104:105], v14 offset:13344
    ds_read_b64_tr_b16 a[106:107], v14 offset:15008
    ds_read_b64_tr_b16 a[28:29], v14 offset:26624
    ds_read_b64_tr_b16 a[30:31], v14 offset:28288
    ds_read_b64_tr_b16 a[108:109], v14 offset:26656
    ds_read_b64_tr_b16 a[110:111], v14 offset:28320
    ds_read_b64_tr_b16 a[32:33], v14 offset:39936
    ds_read_b64_tr_b16 a[34:35], v14 offset:41600
    ds_read_b64_tr_b16 a[112:113], v14 offset:39968
    ds_read_b64_tr_b16 a[114:115], v14 offset:41632
    ds_read_b64_tr_b16 a[36:37], v14 offset:53248
    ds_read_b64_tr_b16 a[38:39], v14 offset:54912
    ds_read_b64_tr_b16 a[116:117], v14 offset:53280
    ds_read_b64_tr_b16 a[118:119], v14 offset:54944
    s_waitcnt lgkmcnt(0)
    s_barrier
    s_mov_b32 s26, s24
    s_add_u32 s28, s67, 5898240
stg_164:
    s_min_u32 s27, s26, 64
    s_lshl_b32 s27, s27, 6
    v_add_u32 v10, s27, v1
    s_lshl_b32 s27, s27, 4
    v_mul_u32_u24 v11, 40330, v10
    v_lshrrev_b32 v11, 20, v11
    v_mul_u32_u24 v12, 26, v11
    v_sub_u32 v12, v10, v12
    v_min_u32 v12, 23, v12
    v_mul_u32_u24 v11, 12288, v11
    s_add_u32 m0, s27, 81920
    v_lshl_add_u32 v11, v12, 4, v11
    s_add_u32 s26, s26, 8
    buffer_load_dwordx4 v11, s[8:11], s28 offen lds
    s_cmp_lt_u32 s26, 72
    s_nop 0
    s_cbranch_scc1 stg_164
    s_waitcnt vmcnt(9)
    s_barrier
    v_add_u32 v14, 0, v13
    ds_read_b64_tr_b16 a[40:41], v14 offset:0
    ds_read_b64_tr_b16 a[42:43], v14 offset:1664
    ds_read_b64_tr_b16 a[120:121], v14 offset:32
    ds_read_b64_tr_b16 a[122:123], v14 offset:1696
    ds_read_b64_tr_b16 a[44:45], v14 offset:13312
    ds_read_b64_tr_b16 a[46:47], v14 offset:14976
    ds_read_b64_tr_b16 a[124:125], v14 offset:13344
    ds_read_b64_tr_b16 a[126:127], v14 offset:15008
    ds_read_b64_tr_b16 a[48:49], v14 offset:26624
    ds_read_b64_tr_b16 a[50:51], v14 offset:28288
    ds_read_b64_tr_b16 a[128:129], v14 offset:26656
    ds_read_b64_tr_b16 a[130:131], v14 offset:28320
    ds_read_b64_tr_b16 a[52:53], v14 offset:39936
    ds_read_b64_tr_b16 a[54:55], v14 offset:41600
    ds_read_b64_tr_b16 a[132:133], v14 offset:39968
    ds_read_b64_tr_b16 a[134:135], v14 offset:41632
    ds_read_b64_tr_b16 a[56:57], v14 offset:53248
    ds_read_b64_tr_b16 a[58:59], v14 offset:54912
    ds_read_b64_tr_b16 a[136:137], v14 offset:53280
    ds_read_b64_tr_b16 a[138:139], v14 offset:54944
    s_waitcnt lgkmcnt(0)
    s_barrier
    s_waitcnt vmcnt(0)
    s_barrier
    v_add_u32 v14, 81920, v13
    ds_read_b64_tr_b16 a[60:61], v14 offset:0
    ds_read_b64_tr_b16 a[62:63], v14 offset:1664
    ds_read_b64_tr_b16 a[140:141], v14 offset:32
    ds_read_b64_tr_b16 a[142:143], v14 offset:1696
    ds_read_b64_tr_b16 a[64:65], v14 offset:13312
    ds_read_b64_tr_b16 a[66:67], v14 offset:14976
    ds_read_b64_tr_b16 a[144:145], v14 offset:13344
    ds_read_b64_tr_b16 a[146:147], v14 offset:15008
    ds_read_b64_tr_b16 a[68:69], v14 offset:26624
    ds_read_b64_tr_b16 a[70:71], v14 offset:28288
    ds_read_b64_tr_b16 a[148:149], v14 offset:26656
    ds_read_b64_tr_b16 a[150:151], v14 offset:28320
    ds_read_b64_tr_b16 a[72:73], v14 offset:39936
    ds_read_b64_tr_b16 a[74:75], v14 offset:41600
    ds_read_b64_tr_b16 a[152:153], v14 offset:39968
    ds_read_b64_tr_b16 a[154:155], v14 offset:41632
    ds_read_b64_tr_b16 a[76:77], v14 offset:53248
    ds_read_b64_tr_b16 a[78:79], v14 offset:54912
    ds_read_b64_tr_b16 a[156:157], v14 offset:53280
    ds_read_b64_tr_b16 a[158:159], v14 offset:54944
    s_waitcnt lgkmcnt(0)
    s_barrier
    v_and_b32 v3, 15, v1
    v_lshrrev_b32 v4, 4, v1
    v_lshlrev_b32 v4, 2, v4
    v_add_u32 v5, 0, v4
    v_cmp_le_u32 vcc, v5, v3
    s_cmp_eq_u32 s24, 6
    s_cselect_b64 s[76:77], vcc, -1
    s_cselect_b64 s[32:33], 0, vcc
    v_add_u32 v5, 1, v4
    v_cmp_le_u32 vcc, v5, v3
    s_cmp_eq_u32 s24, 6
    s_cselect_b64 s[78:79], vcc, -1
    s_cselect_b64 s[34:35], 0, vcc
    v_add_u32 v5, 2, v4
    v_cmp_le_u32 vcc, v5, v3
    s_cmp_eq_u32 s24, 6
    s_cselect_b64 s[80:81], vcc, -1
    s_cselect_b64 s[36:37], 0, vcc
    v_add_u32 v5, 3, v4
    v_cmp_le_u32 vcc, v5, v3
    s_cmp_eq_u32 s24, 6
    s_cselect_b64 s[82:83], vcc, -1
    s_cselect_b64 s[38:39], 0, vcc
    v_cmp_gt_u32 vcc, 32, v1
    s_nop 1
    v_cndmask_b32 v90, 0, 1.0, vcc
    v_and_b32 v5, 7, v1
    v_lshl_add_u32 v5, v4, 1, v5
    v_lshlrev_b32 v91, 4, v5
    v_lshlrev_b32 v5, 4, v3
    v_lshl_add_u32 v92, v4, 1, v5
    s_lshl_b32 s26, s63, 7
    s_add_u32 s27, s26, 65536
    v_mov_b32 v93, s27
    s_add_u32 s27, s26, 0
    v_mov_b32 v94, s27
    s_mov_b32 s74, 0x3dd53b95
    s_mov_b32 s75, 0
    s_cmp_lg_u32 s24, 0
    s_nop 0
    s_cbranch_scc1 wst_165
    v_and_b32 v5, 3, v1
    v_lshlrev_b32 v5, 6, v5
    s_mov_b32 s100, 0
    s_nop 3
poll_166:
    buffer_load_dword v6, v5, s[16:19], 0 offen sc1
    s_waitcnt vmcnt(0)
    v_cmp_gt_u32 vcc, 32, v6
    s_nop 3
    s_cbranch_vccz polld_167
    s_cmp_lg_u32 s25, 0
    s_cbranch_scc1 polld_167
    s_add_u32 s100, s100, 1
    s_cmp_lt_u32 s100, 400000
    s_sleep 8
    s_cbranch_scc1 poll_166
    s_mov_b32 s25, 1
    s_lshl_b32 s100, s3, 16
    s_lshl_b32 s101, s62, 8
    s_or_b32 s100, s100, s101
    s_or_b32 s100, s100, 1
    v_mov_b32 v3, s100
    v_mov_b32 v4, 36
    buffer_store_dword v3, v4, s[16:19], 0 offen sc1
    s_nop 3
polld_167:
wst_165:
    s_barrier
    s_mov_b32 s69, 0x600000
    s_mov_b32 s70, 0
    s_mov_b32 s72, 0
    s_cmp_lt_u32 s24, 6
    s_cbranch_scc1 qp_168
    s_setprio 3
qp_168:
    s_mul_i32 s26, s24, 5120
    s_add_u32 s27, s26, s69
    s_add_u32 s26, s26, s70
    s_add_u32 m0, s26, 0
    s_nop 0
    buffer_load_dwordx4 v2, s[4:7], s27 offen offset:0 sc1 lds
    buffer_load_dwordx4 v2, s[4:7], s27 offen offset:1024 sc1 lds
    buffer_load_dwordx4 v2, s[4:7], s27 offen offset:2048 sc1 lds
    buffer_load_dwordx4 v2, s[4:7], s27 offen offset:3072 sc1 lds
    s_add_u32 m0, s26, 4096
    s_add_u32 s27, s27, 4096
    buffer_load_dwordx4 v2, s[4:7], s27 offen offset:0 sc1 lds
Q_loop:
    s_waitcnt vmcnt(0) lgkmcnt(0)
    s_barrier
    s_cmp_ge_u32 s62, 64
    s_cbranch_scc1 Q_att
    s_and_b32 s26, s24, 6
    s_cmp_lg_u32 s26, 4
    s_cbranch_scc1 qk_169
    s_add_u32 s73, s62, 1
    s_cmp_ge_u32 s75, s73
    s_cbranch_scc1 pc_170
    s_mov_b32 s100, 0
poll_171:
    buffer_load_dword v6, v93, s[4:7], 0 offen sc1
    s_waitcnt vmcnt(0)
    v_cmp_gt_u32 vcc, s73, v6
    s_nop 3
    s_cbranch_vccz polld_172
    s_cmp_lg_u32 s25, 0
    s_cbranch_scc1 polld_172
    s_add_u32 s100, s100, 1
    s_cmp_lt_u32 s100, 400000
    s_sleep 2
    s_cbranch_scc1 poll_171
    s_mov_b32 s25, 1
    s_lshl_b32 s100, s3, 16
    s_lshl_b32 s101, s62, 8
    s_or_b32 s100, s100, s101
    s_or_b32 s100, s100, 2
    v_mov_b32 v3, s100
    v_mov_b32 v4, 40
    buffer_store_dword v3, v4, s[16:19], 0 offen sc1
    s_nop 3
polld_172:
    v_readfirstlane_b32 s75, v6
    s_nop 4
pc_170:
    s_lshl_b32 s27, s62, 5
    s_add_u32 s27, s27, s63
    s_mul_i32 s27, s27, 12288
    s_sub_u32 s26, s24, 4
    s_mul_i32 s26, s26, 6144
    s_add_u32 s27, s27, s26
    s_add_u32 s27, s27, 0x3000000
    s_add_u32 s26, s26, s72
    s_add_u32 m0, s26, 106496
    s_nop 0
    buffer_load_dwordx4 v2, s[4:7], s27 offen offset:0 sc1 lds
    buffer_load_dwordx4 v2, s[4:7], s27 offen offset:1024 sc1 lds
    buffer_load_dwordx4 v2, s[4:7], s27 offen offset:2048 sc1 lds
    s_add_u32 m0, s26, 109568
    s_add_u32 s27, s27, 3072
    buffer_load_dwordx4 v2, s[4:7], s27 offen offset:0 sc1 lds
    buffer_load_dwordx4 v2, s[4:7], s27 offen offset:1024 sc1 lds
    buffer_load_dwordx4 v2, s[4:7], s27 offen offset:2048 sc1 lds
qk_169:
    s_add_u32 s69, s69, 40960
    s_xor_b32 s29, s70, 40960
    s_mul_i32 s26, s24, 5120
    s_add_u32 s27, s26, s69
    s_add_u32 s26, s26, s29
    s_add_u32 m0, s26, 0
    s_nop 0
    buffer_load_dwordx4 v2, s[4:7], s27 offen offset:0 sc1 lds
    buffer_load_dwordx4 v2, s[4:7], s27 offen offset:1024 sc1 lds
    buffer_load_dwordx4 v2, s[4:7], s27 offen offset:2048 sc1 lds
    buffer_load_dwordx4 v2, s[4:7], s27 offen offset:3072 sc1 lds
    s_add_u32 m0, s26, 4096
    s_add_u32 s27, s27, 4096
    buffer_load_dwordx4 v2, s[4:7], s27 offen offset:0 sc1 lds
    s_mov_b32 s71, 0
Q_unit:
    s_add_u32 s26, s65, s71
    s_mul_i32 s27, s26, 20480
    s_add_u32 s27, s27, s70
    v_add_u32 v10, s27, v2
    s_mul_i32 s26, s26, 6
    s_add_u32 s26, s26, s64
    s_lshl_b32 s26, s26, 10
    s_add_u32 s26, s26, 81920
    s_add_u32 s26, s26, s72
    v_add_u32 v11, s26, v2
    ds_read_b128 v[24:27], v10 offset:0
    ds_read_b128 v[28:31], v10 offset:1024
    ds_read_b128 v[32:35], v10 offset:2048
    ds_read_b128 v[36:39], v10 offset:3072
    s_waitcnt lgkmcnt(3)
    v_mfma_f32_16x16x32_bf16 v[12:15], a[0:3], v[24:27], 0
    v_mfma_f32_16x16x32_bf16 v[16:19], a[80:83], v[24:27], 0
    ds_read_b128 v[24:27], v10 offset:4096
    s_waitcnt lgkmcnt(3)
    v_mfma_f32_16x16x32_bf16 v[12:15], a[4:7], v[28:31], v[12:15]
    v_mfma_f32_16x16x32_bf16 v[16:19], a[84:87], v[28:31], v[16:19]
    ds_read_b128 v[28:31], v10 offset:5120
    s_waitcnt lgkmcnt(3)
    v_mfma_f32_16x16x32_bf16 v[12:15], a[8:11], v[32:35], v[12:15]
    v_mfma_f32_16x16x32_bf16 v[16:19], a[88:91], v[32:35], v[16:19]
    ds_read_b128 v[32:35], v10 offset:6144
    s_waitcnt lgkmcnt(3)
    v_mfma_f32_16x16x32_bf16 v[12:15], a[12:15], v[36:39], v[12:15]
    v_mfma_f32_16x16x32_bf16 v[16:19], a[92:95], v[36:39], v[16:19]
    ds_read_b128 v[36:39], v10 offset:7168
    s_waitcnt lgkmcnt(3)
    v_mfma_f32_16x16x32_bf16 v[12:15], a[16:19], v[24:27], v[12:15]
    v_mfma_f32_16x16x32_bf16 v[16:19], a[96:99], v[24:27], v[16:19]
    ds_read_b128 v[24:27], v10 offset:8192
    s_waitcnt lgkmcnt(3)
    v_mfma_f32_16x16x32_bf16 v[12:15], a[20:23], v[28:31], v[12:15]
    v_mfma_f32_16x16x32_bf16 v[16:19], a[100:103], v[28:31], v[16:19]
    ds_read_b128 v[28:31], v10 offset:9216
    s_waitcnt lgkmcnt(3)
    v_mfma_f32_16x16x32_bf16 v[12:15], a[24:27], v[32:35], v[12:15]
    v_mfma_f32_16x16x32_bf16 v[16:19], a[104:107], v[32:35], v[16:19]
    ds_read_b128 v[32:35], v10 offset:10240
    s_waitcnt lgkmcnt(3)
    v_mfma_f32_16x16x32_bf16 v[12:15], a[28:31], v[36:39], v[12:15]
    v_mfma_f32_16x16x32_bf16 v[16:19], a[108:111], v[36:39], v[16:19]
    ds_read_b128 v[36:39], v10 offset:11264
    s_waitcnt lgkmcnt(3)
    v_mfma_f32_16x16x32_bf16 v[12:15], a[32:35], v[24:27], v[12:15]
    v_mfma_f32_16x16x32_bf16 v[16:19], a[112:115], v[24:27], v[16:19]
    ds_read_b128 v[24:27], v10 offset:12288
    s_waitcnt lgkmcnt(3)
    v_mfma_f32_16x16x32_bf16 v[12:15], a[36:39], v[28:31], v[12:15]
    v_mfma_f32_16x16x32_bf16 v[16:19], a[116:119], v[28:31], v[16:19]
    ds_read_b128 v[28:31], v10 offset:13312
    s_waitcnt lgkmcnt(3)
    v_mfma_f32_16x16x32_bf16 v[12:15], a[40:43], v[32:35], v[12:15]
    v_mfma_f32_16x16x32_bf16 v[16:19], a[120:123], v[32:35], v[16:19]
    ds_read_b128 v[32:35], v10 offset:14336
    s_waitcnt lgkmcnt(3)
    v_mfma_f32_16x16x32_bf16 v[12:15], a[44:47], v[36:39], v[12:15]
    v_mfma_f32_16x16x32_bf16 v[16:19], a[124:127], v[36:39], v[16:19]
    ds_read_b128 v[36:39], v10 offset:15360
    s_waitcnt lgkmcnt(3)
    v_mfma_f32_16x16x32_bf16 v[12:15], a[48:51], v[24:27], v[12:15]
    v_mfma_f32_16x16x32_bf16 v[16:19], a[128:131], v[24:27], v[16:19]
    ds_read_b128 v[24:27], v10 offset:16384
    s_waitcnt lgkmcnt(3)
    v_mfma_f32_16x16x32_bf16 v[12:15], a[52:55], v[28:31], v[12:15]
    v_mfma_f32_16x16x32_bf16 v[16:19], a[132:135], v[28:31], v[16:19]
    ds_read_b128 v[28:31], v10 offset:17408
    s_waitcnt lgkmcnt(3)
    v_mfma_f32_16x16x32_bf16 v[12:15], a[56:59], v[32:35], v[12:15]
    v_mfma_f32_16x16x32_bf16 v[16:19], a[136:139], v[32:35], v[16:19]
    ds_read_b128 v[32:35], v10 offset:18432
    s_waitcnt lgkmcnt(3)
    v_mfma_f32_16x16x32_bf16 v[12:15], a[60:63], v[36:39], v[12:15]
    v_mfma_f32_16x16x32_bf16 v[16:19], a[140:143], v[36:39], v[16:19]
    ds_read_b128 v[36:39], v10 offset:19456
    s_waitcnt lgkmcnt(3)
    v_mfma_f32_16x16x32_bf16 v[12:15], a[64:67], v[24:27], v[12:15]
    v_mfma_f32_16x16x32_bf16 v[16:19], a[144:147], v[24:27], v[16:19]
    s_waitcnt lgkmcnt(2)
    v_mfma_f32_16x16x32_bf16 v[12:15], a[68:71], v[28:31], v[12:15]
    v_mfma_f32_16x16x32_bf16 v[16:19], a[148:151], v[28:31], v[16:19]
    s_waitcnt lgkmcnt(1)
    v_mfma_f32_16x16x32_bf16 v[12:15], a[72:75], v[32:35], v[12:15]
    v_mfma_f32_16x16x32_bf16 v[16:19], a[152:155], v[32:35], v[16:19]
    s_waitcnt lgkmcnt(0)
    v_mfma_f32_16x16x32_bf16 v[12:15], a[76:79], v[36:39], v[12:15]
    v_mfma_f32_16x16x32_bf16 v[16:19], a[156:159], v[36:39], v[16:19]
    s_nop 6
    v_cvt_pk_bf16_f32 v20, v12, v13
    v_cvt_pk_bf16_f32 v21, v14, v15
    v_cvt_pk_bf16_f32 v22, v16, v17
    v_cvt_pk_bf16_f32 v23, v18, v19
    ds_write_b128 v11, v[20:23]
    s_add_u32 s71, s71, 1
    s_cmp_lt_u32 s71, s66
    s_nop 0
    s_cbranch_scc1 Q_unit
Q_att:
    s_cmp_lt_u32 s24, 6
    s_cbranch_scc1 Q_next
    s_cmp_eq_u32 s62, 0
    s_cbranch_scc1 Q_next
    s_sub_u32 s67, s62, 1
    s_xor_b32 s27, s72, 12288
    s_and_b32 s26, s24, 1
    s_mul_i32 s26, s26, 6144
    s_add_u32 s26, s26, s27
    s_add_u32 s26, s26, 81920
    s_add_u32 s27, s27, 106496
    s_waitcnt lgkmcnt(0)
    v_add_u32 v10, s26, v2
    v_add_u32 v11, s27, v2
    ds_read_b128 v[12:15], v10 offset:0
    ds_read_b128 v[16:19], v10 offset:1024
    ds_read_b128 v[20:23], v10 offset:2048
    ds_read_b128 v[24:27], v10 offset:3072
    ds_read_b128 v[28:31], v10 offset:4096
    ds_read_b128 v[32:35], v10 offset:5120
    ds_read_b128 v[36:39], v11 offset:0
    ds_read_b128 v[40:43], v11 offset:1024
    ds_read_b128 v[44:47], v11 offset:2048
    ds_read_b128 v[48:51], v11 offset:3072
    ds_read_b128 v[52:55], v11 offset:4096
    ds_read_b128 v[56:59], v11 offset:5120
    s_waitcnt lgkmcnt(5)
    v_mfma_f32_16x16x32_bf16 v[60:63], v[36:39], v[12:15], 0
    s_waitcnt lgkmcnt(4)
    v_mfma_f32_16x16x32_bf16 v[60:63], v[40:43], v[16:19], v[60:63]
    s_waitcnt lgkmcnt(3)
    v_mfma_f32_16x16x32_bf16 v[60:63], v[44:47], v[20:23], v[60:63]
    s_waitcnt lgkmcnt(2)
    v_mfma_f32_16x16x32_bf16 v[60:63], v[48:51], v[24:27], v[60:63]
    s_waitcnt lgkmcnt(1)
    v_mfma_f32_16x16x32_bf16 v[60:63], v[52:55], v[28:31], v[60:63]
    s_waitcnt lgkmcnt(0)
    v_mfma_f32_16x16x32_bf16 v[60:63], v[56:59], v[32:35], v[60:63]
    ds_read_b128 v[36:39], v11 offset:6144
    ds_read_b128 v[40:43], v11 offset:7168
    ds_read_b128 v[44:47], v11 offset:8192
    ds_read_b128 v[48:51], v11 offset:9216
    ds_read_b128 v[52:55], v11 offset:10240
    ds_read_b128 v[56:59], v11 offset:11264
    s_waitcnt lgkmcnt(5)
    v_mfma_f32_16x16x32_bf16 v[64:67], v[36:39], v[12:15], 0
    s_waitcnt lgkmcnt(4)
    v_mfma_f32_16x16x32_bf16 v[64:67], v[40:43], v[16:19], v[64:67]
    s_waitcnt lgkmcnt(3)
    v_mfma_f32_16x16x32_bf16 v[64:67], v[44:47], v[20:23], v[64:67]
    s_waitcnt lgkmcnt(2)
    v_mfma_f32_16x16x32_bf16 v[64:67], v[48:51], v[24:27], v[64:67]
    s_waitcnt lgkmcnt(1)
    v_mfma_f32_16x16x32_bf16 v[64:67], v[52:55], v[28:31], v[64:67]
    s_waitcnt lgkmcnt(0)
    v_mfma_f32_16x16x32_bf16 v[64:67], v[56:59], v[32:35], v[64:67]
    s_mov_b32 s100, 0
    s_nop 6
poll_173:
    buffer_load_dword v6, v94, s[4:7], s91 offen sc1
    s_waitcnt vmcnt(0)
    v_cmp_gt_u32 vcc, s62, v6
    s_nop 3
    s_cbranch_vccz polld_174
    s_cmp_lg_u32 s25, 0
    s_cbranch_scc1 polld_174
    s_cmp_ge_u32 s62, 58
    s_cbranch_scc1 lz_175
    s_sleep 24
lz_175:
    s_add_u32 s100, s100, 1
    s_cmp_lt_u32 s100, 400000
    s_sleep 2
    s_cbranch_scc1 poll_173
    s_mov_b32 s25, 1
    s_lshl_b32 s100, s3, 16
    s_lshl_b32 s101, s62, 8
    s_or_b32 s100, s100, s101
    s_or_b32 s100, s100, 3
    v_mov_b32 v3, s100
    v_mov_b32 v4, 44
    buffer_store_dword v3, v4, s[16:19], 0 offen sc1
    s_nop 3
polld_174:
    s_lshl_b32 s27, s67, 5
    s_add_u32 s27, s27, s63
    s_mul_i32 s28, s27, 3072
    s_add_u32 s26, s28, 0x2000000
    buffer_load_dwordx4 v[36:39], v91, s[4:7], s26 offen offset:0 sc1
    buffer_load_dwordx4 v[40:43], v91, s[4:7], s26 offen offset:512 sc1
    buffer_load_dwordx4 v[44:47], v91, s[4:7], s26 offen offset:1024 sc1
    buffer_load_dwordx4 v[48:51], v91, s[4:7], s26 offen offset:1536 sc1
    buffer_load_dwordx4 v[52:55], v91, s[4:7], s26 offen offset:2048 sc1
    buffer_load_dwordx4 v[56:59], v91, s[4:7], s26 offen offset:2560 sc1
    v_mov_b32 v3, 0xff61b1e6
    v_cndmask_b32 v60, v3, v60, s[76:77]
    v_cndmask_b32 v64, v3, v64, s[32:33]
    v_cndmask_b32 v61, v3, v61, s[78:79]
    v_cndmask_b32 v65, v3, v65, s[34:35]
    v_cndmask_b32 v62, v3, v62, s[80:81]
    v_cndmask_b32 v66, v3, v66, s[36:37]
    v_cndmask_b32 v63, v3, v63, s[82:83]
    v_cndmask_b32 v67, v3, v67, s[38:39]
    s_waitcnt vmcnt(5)
    v_mfma_f32_16x16x32_bf16 v[68:71], v[36:39], v[12:15], 0
    s_waitcnt vmcnt(4)
    v_mfma_f32_16x16x32_bf16 v[68:71], v[40:43], v[16:19], v[68:71]
    s_waitcnt vmcnt(3)
    v_mfma_f32_16x16x32_bf16 v[68:71], v[44:47], v[20:23], v[68:71]
    s_waitcnt vmcnt(2)
    v_mfma_f32_16x16x32_bf16 v[68:71], v[48:51], v[24:27], v[68:71]
    s_waitcnt vmcnt(1)
    v_mfma_f32_16x16x32_bf16 v[68:71], v[52:55], v[28:31], v[68:71]
    s_waitcnt vmcnt(0)
    v_mfma_f32_16x16x32_bf16 v[68:71], v[56:59], v[32:35], v[68:71]
    v_max3_f32 v72, v60, v61, v62
    v_max3_f32 v72, v72, v63, v64
    v_max3_f32 v72, v72, v65, v66
    s_nop 4
    v_max3_f32 v72, v72, v67, v68
    v_max3_f32 v72, v72, v69, v70
    v_max_f32 v72, v72, v71
    v_mov_b32 v73, v72
    s_nop 1
    v_permlane16_swap_b32 v72, v73
    v_max_f32 v72, v72, v73
    v_mov_b32 v73, v72
    s_nop 1
    v_permlane32_swap_b32 v72, v73
    v_max_f32 v72, v72, v73
    v_mul_f32 v72, s74, v72
    v_fma_f32 v60, v60, s74, -v72
    v_fma_f32 v61, v61, s74, -v72
    v_fma_f32 v62, v62, s74, -v72
    v_fma_f32 v63, v63, s74, -v72
    v_fma_f32 v64, v64, s74, -v72
    v_fma_f32 v65, v65, s74, -v72
    v_fma_f32 v66, v66, s74, -v72
    v_fma_f32 v67, v67, s74, -v72
    v_fma_f32 v68, v68, s74, -v72
    v_fma_f32 v69, v69, s74, -v72
    v_fma_f32 v70, v70, s74, -v72
    v_fma_f32 v71, v71, s74, -v72
    v_exp_f32 v60, v60
    v_exp_f32 v61, v61
    v_exp_f32 v62, v62
    v_exp_f32 v63, v63
    v_exp_f32 v64, v64
    v_exp_f32 v65, v65
    v_exp_f32 v66, v66
    v_exp_f32 v67, v67
    v_exp_f32 v68, v68
    v_exp_f32 v69, v69
    v_exp_f32 v70, v70
    v_exp_f32 v71, v71
    v_add_f32 v74, v68, v69
    v_add_f32 v74, v74, v70
    v_add_f32 v74, v74, v71
    v_mul_f32 v74, v74, v90
    v_add_f32 v74, v74, v60
    v_add_f32 v74, v74, v61
    v_add_f32 v74, v74, v62
    v_add_f32 v74, v74, v63
    v_add_f32 v74, v74, v64
    v_add_f32 v74, v74, v65
    v_add_f32 v74, v74, v66
    v_add_f32 v74, v74, v67
    v_mov_b32 v73, v74
    s_nop 1
    v_permlane16_swap_b32 v74, v73
    v_add_f32 v74, v74, v73
    v_mov_b32 v73, v74
    s_nop 1
    v_permlane32_swap_b32 v74, v73
    v_add_f32 v74, v74, v73
    v_rcp_f32 v74, v74
    s_nop 0
    v_mul_f32 v60, v60, v74
    v_mul_f32 v61, v61, v74
    v_mul_f32 v62, v62, v74
    v_mul_f32 v63, v63, v74
    v_mul_f32 v64, v64, v74
    v_mul_f32 v65, v65, v74
    v_mul_f32 v66, v66, v74
    v_mul_f32 v67, v67, v74
    v_mul_f32 v68, v68, v74
    v_mul_f32 v69, v69, v74
    v_mul_f32 v70, v70, v74
    v_mul_f32 v71, v71, v74
    v_cvt_pk_bf16_f32 v76, v60, v61
    v_cvt_pk_bf16_f32 v77, v62, v63
    v_cvt_pk_bf16_f32 v78, v64, v65
    v_cvt_pk_bf16_f32 v79, v66, v67
    v_cvt_pk_bf16_f32 v80, v68, v69
    v_cvt_pk_bf16_f32 v81, v70, v71
    s_and_b32 s29, s24, 1
    s_lshl_b32 s26, s27, 1
    s_add_u32 s26, s26, s29
    s_lshl_b32 s26, s26, 10
    s_add_u32 s26, s26, 0x1a00000
    buffer_store_dwordx4 v[76:79], v2, s[4:7], s26 offen sc1
    s_lshl_b32 s26, s67, 1
    s_add_u32 s26, s26, s29
    s_lshl_b32 s26, s26, 5
    s_add_u32 s26, s26, s63
    s_lshl_b32 s26, s26, 8
    s_add_u32 s26, s26, 0x1e00000
    s_mov_b32 exec_lo, 0xffffffff
    s_mov_b32 exec_hi, 0x0
    buffer_store_dwordx2 v[80:81], v92, s[4:7], s26 offen sc1
    s_mov_b64 exec, -1
    s_waitcnt vmcnt(0)
    v_mov_b32 v3, s62
    v_mov_b32 v4, s89
    s_mov_b64 exec, 1
    buffer_store_dword v3, v4, s[4:7], s68 offen sc1
    s_mov_b64 exec, -1
    s_nop 1
Q_next:
    s_add_u32 s62, s62, 1
    s_xor_b32 s70, s70, 40960
    s_xor_b32 s72, s72, 12288
    s_cmp_le_u32 s62, 64
    s_cbranch_scc1 Q_loop
    s_endpgm
R_PY:
    s_cmp_ge_u32 s63, 10
    s_cselect_b32 s65, 1, 0
    s_mul_i32 s26, s65, 10
    s_sub_u32 s66, s63, s26
    s_lshr_b32 s74, s24, 1
    s_and_b32 s27, s24, 1
    s_lshl_b32 s73, s66, 1
    s_add_u32 s73, s73, s27
    s_lshl_b32 s68, s63, 5
    s_add_u32 s68, s68, s24
    s_lshl_b32 s68, s68, 2
    s_add_u32 s68, s68, 20480
    v_and_b32 v4, 3, v1
    v_lshlrev_b32 v4, 7, v4
    v_bfe_u32 v3, v1, 2, 2
    v_lshl_add_u32 v4, v3, 2, v4
    s_lshl_b32 s26, s24, 9
    s_add_u32 s26, s26, 4096
    v_add_u32 v9, s26, v4
    v_and_b32 v3, 3, v1
    v_lshlrev_b32 v3, 7, v3
    v_and_b32 v4, 4, v1
    v_add_u32 v3, v3, v4
    s_lshl_b32 s26, s24, 9
    s_add_u32 s26, s26, 16384
    v_add_u32 v10, s26, v3
    v_and_b32 v3, 15, v1
    v_lshrrev_b32 v4, 4, v1
    v_mul_u32_u24 v5, 1280, v3
    v_lshl_add_u32 v15, v4, 3, v5
    v_lshlrev_b32 v88, 3, v3
    s_lshl_b32 s26, s24, 13
    v_add_u32 v14, s26, v2
    s_mov_b32 s62, s65
    s_mov_b32 s72, 0
    s_cmp_lg_u32 s24, 0
    s_nop 0
    s_cbranch_scc1 wst_176
    v_and_b32 v5, 3, v1
    v_lshlrev_b32 v5, 6, v5
    s_mov_b32 s100, 0
    s_nop 3
poll_177:
    buffer_load_dword v6, v5, s[16:19], 0 offen sc1
    s_waitcnt vmcnt(0)
    v_cmp_gt_u32 vcc, 32, v6
    s_nop 3
    s_cbranch_vccz polld_178
    s_cmp_lg_u32 s25, 0
    s_cbranch_scc1 polld_178
    s_add_u32 s100, s100, 1
    s_cmp_lt_u32 s100, 400000
    s_sleep 8
    s_cbranch_scc1 poll_177
    s_mov_b32 s25, 1
    s_lshl_b32 s100, s3, 16
    s_lshl_b32 s101, s62, 8
    s_or_b32 s100, s100, s101
    s_or_b32 s100, s100, 1
    v_mov_b32 v3, s100
    v_mov_b32 v4, 36
    buffer_store_dword v3, v4, s[16:19], 0 offen sc1
    s_nop 3
polld_178:
wst_176:
    s_barrier
PY_loop:
    s_add_u32 s71, s62, 1
    s_mul_i32 s26, s62, 40
    s_lshl_b32 s27, s66, 2
    s_add_u32 s26, s26, s27
    s_lshl_b32 s26, s26, 3
    s_add_u32 s26, s26, s24
    s_lshl_b32 s69, s26, 12
    s_add_u32 s69, s69, 0x7400000
    s_mul_i32 s26, s62, 171
    s_lshr_b32 s26, s26, 9
    s_mul_i32 s75, s26, 131072
    s_xor_b32 s26, s26, s88
    s_and_b32 s26, s26, 1
    s_lshl_b32 s26, s26, 13
    s_add_u32 s75, s75, s26
    s_mul_i32 s26, s62, 655360
    s_add_u32 s75, s75, s26
    s_add_u32 s75, s75, 0x4800000
    s_lshl_b32 s26, s66, 16
    s_add_u32 s75, s75, s26
    s_lshl_b32 s26, s24, 10
    s_add_u32 s75, s75, s26
    s_mov_b32 s100, 0
poll_179:
    buffer_load_dword v6, v9, s[4:7], s89 offen sc1
    s_waitcnt vmcnt(0)
    v_cmp_gt_u32 vcc, s71, v6
    s_nop 3
    s_cbranch_vccz polld_180
    s_cmp_lg_u32 s25, 0
    s_cbranch_scc1 polld_180
    s_add_u32 s100, s100, 1
    s_cmp_lt_u32 s100, 400000
    s_sleep 12
    s_cbranch_scc1 poll_179
    s_mov_b32 s25, 1
    s_lshl_b32 s100, s3, 16
    s_lshl_b32 s101, s62, 8
    s_or_b32 s100, s100, s101
    s_or_b32 s100, s100, 19
    v_mov_b32 v3, s100
    v_mov_b32 v4, 44
    buffer_store_dword v3, v4, s[16:19], 0 offen sc1
    s_nop 3
polld_180:
    buffer_load_dwordx4 a[0:3], v2, s[4:7], s69 offen offset:0 sc1
    buffer_load_dwordx4 a[16:19], v2, s[4:7], s69 offen offset:1024 sc1
    buffer_load_dwordx4 a[32:35], v2, s[4:7], s69 offen offset:2048 sc1
    buffer_load_dwordx4 a[48:51], v2, s[4:7], s69 offen offset:3072 sc1
    s_add_u32 s69, s69, 32768
    buffer_load_dwordx4 a[4:7], v2, s[4:7], s69 offen offset:0 sc1
    buffer_load_dwordx4 a[20:23], v2, s[4:7], s69 offen offset:1024 sc1
    buffer_load_dwordx4 a[36:39], v2, s[4:7], s69 offen offset:2048 sc1
    buffer_load_dwordx4 a[52:55], v2, s[4:7], s69 offen offset:3072 sc1
    s_add_u32 s69, s69, 32768
    buffer_load_dwordx4 a[8:11], v2, s[4:7], s69 offen offset:0 sc1
    buffer_load_dwordx4 a[24:27], v2, s[4:7], s69 offen offset:1024 sc1
    buffer_load_dwordx4 a[40:43], v2, s[4:7], s69 offen offset:2048 sc1
    buffer_load_dwordx4 a[56:59], v2, s[4:7], s69 offen offset:3072 sc1
    s_add_u32 s69, s69, 32768
    buffer_load_dwordx4 a[12:15], v2, s[4:7], s69 offen offset:0 sc1
    buffer_load_dwordx4 a[28:31], v2, s[4:7], s69 offen offset:1024 sc1
    buffer_load_dwordx4 a[44:47], v2, s[4:7], s69 offen offset:2048 sc1
    buffer_load_dwordx4 a[60:63], v2, s[4:7], s69 offen offset:3072 sc1
    s_cmp_lt_u32 s62, 63
    s_cbranch_scc1 pe_181
    s_add_u32 s30, s62, 3
    s_mov_b32 s100, 0
poll_182:
    buffer_load_dword v6, v9, s[4:7], s89 offen sc1
    s_waitcnt vmcnt(0)
    v_cmp_gt_u32 vcc, s30, v6
    s_nop 3
    s_cbranch_vccz polld_183
    s_cmp_lg_u32 s25, 0
    s_cbranch_scc1 polld_183
    s_cmp_ge_u32 s62, 58
    s_cbranch_scc1 lz_184
    s_sleep 24
lz_184:
    s_add_u32 s100, s100, 1
    s_cmp_lt_u32 s100, 400000
    s_sleep 3
    s_cbranch_scc1 poll_182
    s_mov_b32 s25, 1
    s_lshl_b32 s100, s3, 16
    s_lshl_b32 s101, s62, 8
    s_or_b32 s100, s100, s101
    s_or_b32 s100, s100, 17
    v_mov_b32 v3, s100
    v_mov_b32 v4, 36
    buffer_store_dword v3, v4, s[16:19], 0 offen sc1
    s_nop 3
polld_183:
    buffer_load_dwordx4 a[64:67], v2, s[4:7], s75 offen sc1
    s_add_u32 s75, s75, 16384
    buffer_load_dwordx4 a[68:71], v2, s[4:7], s75 offen sc1
    s_add_u32 s75, s75, 16384
    buffer_load_dwordx4 a[72:75], v2, s[4:7], s75 offen sc1
    s_add_u32 s75, s75, 16384
    buffer_load_dwordx4 a[76:79], v2, s[4:7], s75 offen sc1
pe_181:
    s_lshl_b32 s70, s62, 3
    s_add_u32 s70, s70, s24
    s_lshl_b32 s70, s70, 13
    s_add_u32 s70, s70, 0x1a00000
    s_lshl_b32 s30, s62, 4
    s_add_u32 s30, s30, s24
    s_lshl_b32 s30, s30, 10
    s_add_u32 s30, s30, 0x1e00000
    s_mov_b32 s100, 0
poll_185:
    buffer_load_dword v6, v10, s[4:7], s89 offen sc1
    s_waitcnt vmcnt(0)
    v_cmp_gt_u32 vcc, s71, v6
    s_nop 3
    s_cbranch_vccz polld_186
    s_cmp_lg_u32 s25, 0
    s_cbranch_scc1 polld_186
    s_cmp_ge_u32 s62, 58
    s_cbranch_scc1 lz_187
    s_sleep 24
lz_187:
    s_add_u32 s100, s100, 1
    s_cmp_lt_u32 s100, 400000
    s_sleep 3
    s_cbranch_scc1 poll_185
    s_mov_b32 s25, 1
    s_lshl_b32 s100, s3, 16
    s_lshl_b32 s101, s62, 8
    s_or_b32 s100, s100, s101
    s_or_b32 s100, s100, 18
    v_mov_b32 v3, s100
    v_mov_b32 v4, 40
    buffer_store_dword v3, v4, s[16:19], 0 offen sc1
    s_nop 3
polld_186:
    buffer_load_dwordx4 a[80:83], v2, s[4:7], s70 offen offset:0 sc1
    buffer_load_dwordx4 a[84:87], v2, s[4:7], s70 offen offset:1024 sc1
    buffer_load_dwordx4 a[88:91], v2, s[4:7], s70 offen offset:2048 sc1
    buffer_load_dwordx4 a[92:95], v2, s[4:7], s70 offen offset:3072 sc1
    s_add_u32 s70, s70, 4096
    buffer_load_dwordx4 a[96:99], v2, s[4:7], s70 offen offset:0 sc1
    buffer_load_dwordx4 a[100:103], v2, s[4:7], s70 offen offset:1024 sc1
    buffer_load_dwordx4 a[104:107], v2, s[4:7], s70 offen offset:2048 sc1
    buffer_load_dwordx4 a[108:111], v2, s[4:7], s70 offen offset:3072 sc1
    buffer_load_dwordx4 a[112:115], v2, s[4:7], s30 offen sc1
    s_add_u32 s30, s30, 8192
    buffer_load_dwordx4 a[116:119], v2, s[4:7], s30 offen sc1
    s_waitcnt vmcnt(8)
    v_mfma_f32_16x16x32_bf16 v[16:19], a[0:3], a[80:83], 0
    v_mfma_f32_16x16x32_bf16 v[20:23], a[4:7], a[80:83], 0
    v_mfma_f32_16x16x32_bf16 v[24:27], a[8:11], a[80:83], 0
    v_mfma_f32_16x16x32_bf16 v[28:31], a[12:15], a[80:83], 0
    v_mfma_f32_16x16x32_bf16 v[32:35], a[0:3], a[84:87], 0
    v_mfma_f32_16x16x32_bf16 v[36:39], a[4:7], a[84:87], 0
    v_mfma_f32_16x16x32_bf16 v[40:43], a[8:11], a[84:87], 0
    v_mfma_f32_16x16x32_bf16 v[44:47], a[12:15], a[84:87], 0
    s_waitcnt vmcnt(6)
    v_mfma_f32_16x16x32_bf16 v[16:19], a[16:19], a[88:91], v[16:19]
    v_mfma_f32_16x16x32_bf16 v[20:23], a[20:23], a[88:91], v[20:23]
    v_mfma_f32_16x16x32_bf16 v[24:27], a[24:27], a[88:91], v[24:27]
    v_mfma_f32_16x16x32_bf16 v[28:31], a[28:31], a[88:91], v[28:31]
    v_mfma_f32_16x16x32_bf16 v[32:35], a[16:19], a[92:95], v[32:35]
    v_mfma_f32_16x16x32_bf16 v[36:39], a[20:23], a[92:95], v[36:39]
    v_mfma_f32_16x16x32_bf16 v[40:43], a[24:27], a[92:95], v[40:43]
    v_mfma_f32_16x16x32_bf16 v[44:47], a[28:31], a[92:95], v[44:47]
    s_waitcnt vmcnt(4)
    v_mfma_f32_16x16x32_bf16 v[16:19], a[32:35], a[96:99], v[16:19]
    v_mfma_f32_16x16x32_bf16 v[20:23], a[36:39], a[96:99], v[20:23]
    v_mfma_f32_16x16x32_bf16 v[24:27], a[40:43], a[96:99], v[24:27]
    v_mfma_f32_16x16x32_bf16 v[28:31], a[44:47], a[96:99], v[28:31]
    v_mfma_f32_16x16x32_bf16 v[32:35], a[32:35], a[100:103], v[32:35]
    v_mfma_f32_16x16x32_bf16 v[36:39], a[36:39], a[100:103], v[36:39]
    v_mfma_f32_16x16x32_bf16 v[40:43], a[40:43], a[100:103], v[40:43]
    v_mfma_f32_16x16x32_bf16 v[44:47], a[44:47], a[100:103], v[44:47]
    s_waitcnt vmcnt(2)
    v_mfma_f32_16x16x32_bf16 v[16:19], a[48:51], a[104:107], v[16:19]
    v_mfma_f32_16x16x32_bf16 v[20:23], a[52:55], a[104:107], v[20:23]
    v_mfma_f32_16x16x32_bf16 v[24:27], a[56:59], a[104:107], v[24:27]
    v_mfma_f32_16x16x32_bf16 v[28:31], a[60:63], a[104:107], v[28:31]
    v_mfma_f32_16x16x32_bf16 v[32:35], a[48:51], a[108:111], v[32:35]
    v_mfma_f32_16x16x32_bf16 v[36:39], a[52:55], a[108:111], v[36:39]
    v_mfma_f32_16x16x32_bf16 v[40:43], a[56:59], a[108:111], v[40:43]
    v_mfma_f32_16x16x32_bf16 v[44:47], a[60:63], a[108:111], v[44:47]
    s_cmp_ge_u32 s62, 63
    s_nop 5
    s_cbranch_scc1 pl_188
    s_add_u32 s30, s62, 3
    s_mov_b32 s100, 0
poll_189:
    buffer_load_dword v6, v9, s[4:7], s89 offen sc1
    s_waitcnt vmcnt(0)
    v_cmp_gt_u32 vcc, s30, v6
    s_nop 3
    s_cbranch_vccz polld_190
    s_cmp_lg_u32 s25, 0
    s_cbranch_scc1 polld_190
    s_cmp_ge_u32 s62, 58
    s_cbranch_scc1 lz_191
    s_sleep 24
lz_191:
    s_add_u32 s100, s100, 1
    s_cmp_lt_u32 s100, 400000
    s_sleep 3
    s_cbranch_scc1 poll_189
    s_mov_b32 s25, 1
    s_lshl_b32 s100, s3, 16
    s_lshl_b32 s101, s62, 8
    s_or_b32 s100, s100, s101
    s_or_b32 s100, s100, 17
    v_mov_b32 v3, s100
    v_mov_b32 v4, 36
    buffer_store_dword v3, v4, s[16:19], 0 offen sc1
    s_nop 3
polld_190:
    buffer_load_dwordx4 a[64:67], v2, s[4:7], s75 offen sc1
    s_add_u32 s75, s75, 16384
    buffer_load_dwordx4 a[68:71], v2, s[4:7], s75 offen sc1
    s_add_u32 s75, s75, 16384
    buffer_load_dwordx4 a[72:75], v2, s[4:7], s75 offen sc1
    s_add_u32 s75, s75, 16384
    buffer_load_dwordx4 a[76:79], v2, s[4:7], s75 offen sc1
pl_188:
    s_waitcnt vmcnt(0)
    v_mfma_f32_16x16x32_bf16 v[16:19], a[64:67], a[112:115], v[16:19]
    v_mfma_f32_16x16x32_bf16 v[20:23], a[68:71], a[112:115], v[20:23]
    v_mfma_f32_16x16x32_bf16 v[24:27], a[72:75], a[112:115], v[24:27]
    v_mfma_f32_16x16x32_bf16 v[28:31], a[76:79], a[112:115], v[28:31]
    v_mfma_f32_16x16x32_bf16 v[32:35], a[64:67], a[116:119], v[32:35]
    v_mfma_f32_16x16x32_bf16 v[36:39], a[68:71], a[116:119], v[36:39]
    v_mfma_f32_16x16x32_bf16 v[40:43], a[72:75], a[116:119], v[40:43]
    v_mfma_f32_16x16x32_bf16 v[44:47], a[76:79], a[116:119], v[44:47]
    v_add_u32 v3, s72, v14
    ds_write_b128 v3, v[16:19] offset:0
    ds_write_b128 v3, v[20:23] offset:1024
    ds_write_b128 v3, v[24:27] offset:2048
    ds_write_b128 v3, v[28:31] offset:3072
    ds_write_b128 v3, v[32:35] offset:4096
    ds_write_b128 v3, v[36:39] offset:5120
    ds_write_b128 v3, v[40:43] offset:6144
    ds_write_b128 v3, v[44:47] offset:7168
    s_waitcnt lgkmcnt(0)
    s_barrier
    s_cmp_ge_u32 s24, 4
    s_cbranch_scc1 PY_next
    s_lshl_b32 s26, s62, 1
    s_add_u32 s26, s26, s74
    s_mul_i32 s27, s26, 20480
    s_lshl_b32 s28, s73, 6
    s_add_u32 s27, s27, s28
    buffer_load_dwordx2 v[80:81], v15, s[20:23], s27 offen
    buffer_load_dwordx2 v[82:83], v15, s[20:23], s27 offen offset:32
    s_lshl_b32 s27, s24, 11
    s_add_u32 s27, s27, s72
    v_add_u32 v3, s27, v2
    ds_read_b128 v[16:19], v3 offset:0
    ds_read_b128 v[20:23], v3 offset:1024
    ds_read_b128 v[24:27], v3 offset:8192
    ds_read_b128 v[28:31], v3 offset:9216
    ds_read_b128 v[32:35], v3 offset:16384
    ds_read_b128 v[36:39], v3 offset:17408
    ds_read_b128 v[40:43], v3 offset:24576
    ds_read_b128 v[44:47], v3 offset:25600
    ds_read_b128 v[48:51], v3 offset:32768
    ds_read_b128 v[52:55], v3 offset:33792
    ds_read_b128 v[56:59], v3 offset:40960
    ds_read_b128 v[60:63], v3 offset:41984
    ds_read_b128 v[64:67], v3 offset:49152
    ds_read_b128 v[68:71], v3 offset:50176
    s_waitcnt lgkmcnt(8)
    ds_read_b128 v[72:75], v3 offset:57344
    ds_read_b128 v[76:79], v3 offset:58368
    s_waitcnt lgkmcnt(12)
    v_add_f32 v16, v16, v24
    v_add_f32 v17, v17, v25
    v_add_f32 v18, v18, v26
    v_add_f32 v19, v19, v27
    v_add_f32 v20, v20, v28
    v_add_f32 v21, v21, v29
    v_add_f32 v22, v22, v30
    v_add_f32 v23, v23, v31
    s_waitcnt lgkmcnt(10)
    v_add_f32 v16, v16, v32
    v_add_f32 v17, v17, v33
    v_add_f32 v18, v18, v34
    v_add_f32 v19, v19, v35
    v_add_f32 v20, v20, v36
    v_add_f32 v21, v21, v37
    v_add_f32 v22, v22, v38
    v_add_f32 v23, v23, v39
    s_waitcnt lgkmcnt(8)
    v_add_f32 v16, v16, v40
    v_add_f32 v17, v17, v41
    v_add_f32 v18, v18, v42
    v_add_f32 v19, v19, v43
    v_add_f32 v20, v20, v44
    v_add_f32 v21, v21, v45
    v_add_f32 v22, v22, v46
    v_add_f32 v23, v23, v47
    s_waitcnt lgkmcnt(6)
    v_add_f32 v16, v16, v48
    v_add_f32 v17, v17, v49
    v_add_f32 v18, v18, v50
    v_add_f32 v19, v19, v51
    v_add_f32 v20, v20, v52
    v_add_f32 v21, v21, v53
    v_add_f32 v22, v22, v54
    v_add_f32 v23, v23, v55
    s_waitcnt lgkmcnt(4)
    v_add_f32 v16, v16, v56
    v_add_f32 v17, v17, v57
    v_add_f32 v18, v18, v58
    v_add_f32 v19, v19, v59
    v_add_f32 v20, v20, v60
    v_add_f32 v21, v21, v61
    v_add_f32 v22, v22, v62
    v_add_f32 v23, v23, v63
    s_waitcnt lgkmcnt(2)
    v_add_f32 v16, v16, v64
    v_add_f32 v17, v17, v65
    v_add_f32 v18, v18, v66
    v_add_f32 v19, v19, v67
    v_add_f32 v20, v20, v68
    v_add_f32 v21, v21, v69
    v_add_f32 v22, v22, v70
    v_add_f32 v23, v23, v71
    s_waitcnt lgkmcnt(0)
    v_add_f32 v16, v16, v72
    v_add_f32 v17, v17, v73
    v_add_f32 v18, v18, v74
    v_add_f32 v19, v19, v75
    v_add_f32 v20, v20, v76
    v_add_f32 v21, v21, v77
    v_add_f32 v22, v22, v78
    v_add_f32 v23, v23, v79
    s_waitcnt vmcnt(0)
    v_lshlrev_b32 v24, 16, v80
    v_and_b32 v25, 0xffff0000, v80
    v_lshlrev_b32 v26, 16, v81
    v_and_b32 v27, 0xffff0000, v81
    v_lshlrev_b32 v28, 16, v82
    v_and_b32 v29, 0xffff0000, v82
    v_lshlrev_b32 v30, 16, v83
    v_and_b32 v31, 0xffff0000, v83
    v_add_f32 v16, v16, v24
    v_add_f32 v17, v17, v25
    v_add_f32 v18, v18, v26
    v_add_f32 v19, v19, v27
    v_add_f32 v20, v20, v28
    v_add_f32 v21, v21, v29
    v_add_f32 v22, v22, v30
    v_add_f32 v23, v23, v31
    v_cvt_pk_bf16_f32 v84, v16, v17
    v_cvt_pk_bf16_f32 v85, v18, v19
    v_cvt_pk_bf16_f32 v86, v20, v21
    v_cvt_pk_bf16_f32 v87, v22, v23
    s_mul_i32 s27, s26, 20
    s_add_u32 s27, s27, s73
    s_lshl_b32 s27, s27, 10
    s_add_u32 s27, s27, 0x900000
    buffer_store_dwordx4 v[84:87], v2, s[4:7], s27 offen sc1
    v_lshlrev_b32 v24, 16, v84
    v_and_b32 v25, 0xffff0000, v84
    v_lshlrev_b32 v26, 16, v85
    v_and_b32 v27, 0xffff0000, v85
    v_lshlrev_b32 v28, 16, v86
    v_and_b32 v29, 0xffff0000, v86
    v_lshlrev_b32 v30, 16, v87
    v_and_b32 v31, 0xffff0000, v87
    v_add_f32 v32, v24, v25
    v_add_f32 v32, v32, v26
    v_add_f32 v32, v32, v27
    v_add_f32 v32, v32, v28
    v_add_f32 v32, v32, v29
    v_add_f32 v32, v32, v30
    v_add_f32 v32, v32, v31
    v_mov_b32 v34, v32
    s_nop 1
    v_permlane16_swap_b32 v32, v34
    v_add_f32 v32, v32, v34
    v_mov_b32 v34, v32
    s_nop 1
    v_permlane32_swap_b32 v32, v34
    v_add_f32 v32, v32, v34
    v_mul_f32 v32, 0x3d000000, v32
    v_sub_f32 v24, v24, v32
    v_sub_f32 v25, v25, v32
    v_sub_f32 v26, v26, v32
    v_sub_f32 v27, v27, v32
    v_sub_f32 v28, v28, v32
    v_sub_f32 v29, v29, v32
    v_sub_f32 v30, v30, v32
    v_sub_f32 v31, v31, v32
    v_mul_f32 v33, v24, v24
    v_fmac_f32 v33, v25, v25
    v_fmac_f32 v33, v26, v26
    v_fmac_f32 v33, v27, v27
    v_fmac_f32 v33, v28, v28
    v_fmac_f32 v33, v29, v29
    v_fmac_f32 v33, v30, v30
    v_fmac_f32 v33, v31, v31
    v_mov_b32 v34, v33
    s_nop 1
    v_permlane16_swap_b32 v33, v34
    v_add_f32 v33, v33, v34
    v_mov_b32 v34, v33
    s_nop 1
    v_permlane32_swap_b32 v33, v34
    v_add_f32 v33, v33, v34
    s_mul_i32 s27, s62, 20
    s_add_u32 s27, s27, s73
    s_lshl_b32 s27, s27, 8
    s_lshl_b32 s28, s74, 7
    s_add_u32 s27, s27, s28
    s_add_u32 s27, s27, 0x1800000
    s_mov_b64 exec, 0xffff
    buffer_store_dwordx2 v[32:33], v88, s[4:7], s27 offen sc1
    s_mov_b64 exec, -1
    s_waitcnt vmcnt(0)
    v_mov_b32 v3, s71
    v_mov_b32 v4, s89
    s_mov_b64 exec, 1
    buffer_store_dword v3, v4, s[4:7], s68 offen sc1
    s_mov_b64 exec, -1
    s_nop 1
PY_next:
    s_add_u32 s62, s62, 2
    s_xor_b32 s72, s72, 65536
    s_cmp_lt_u32 s62, 64
    s_cbranch_scc1 PY_loop
    s_endpgm
R_M:
    s_cmp_ge_u32 s63, 5
    s_cbranch_scc1 md_192
    s_sub_u32 s63, s63, 0
    s_branch R_M1
md_192:
    s_cmp_ge_u32 s63, 10
    s_cbranch_scc1 md_193
    s_sub_u32 s63, s63, 5
    s_branch R_M2
md_193:
    s_cmp_ge_u32 s63, 20
    s_cbranch_scc1 md_194
    s_sub_u32 s63, s63, 10
    s_branch R_M4
md_194:
    s_cmp_ge_u32 s63, 32
    s_cbranch_scc1 md_195
    s_sub_u32 s63, s63, 20
    s_branch R_M3
md_195:
    s_endpgm
R_M1:
    s_and_b32 s26, s24, 3
    s_lshl_b32 s65, s63, 2
    s_add_u32 s65, s65, s26
    s_lshr_b32 s66, s24, 2
    s_lshl_b32 s68, s63, 5
    s_add_u32 s68, s68, s24
    s_lshl_b32 s68, s68, 2
    s_add_u32 s68, s68, 32768
    s_lshl_b32 s27, s87, 11
    s_add_u32 s68, s68, s27
    s_cmp_lg_u32 s24, 0
    s_cbranch_scc1 wst_196
    v_and_b32 v5, 3, v1
    v_lshlrev_b32 v5, 6, v5
    s_mov_b32 s100, 0
    s_nop 3
poll_197:
    buffer_load_dword v6, v5, s[16:19], 0 offen sc1
    s_waitcnt vmcnt(0)
    v_cmp_gt_u32 vcc, 32, v6
    s_nop 3
    s_cbranch_vccz polld_198
    s_cmp_lg_u32 s25, 0
    s_cbranch_scc1 polld_198
    s_add_u32 s100, s100, 1
    s_cmp_lt_u32 s100, 400000
    s_sleep 8
    s_cbranch_scc1 poll_197
    s_mov_b32 s25, 1
    s_lshl_b32 s100, s3, 16
    s_lshl_b32 s101, s62, 8
    s_or_b32 s100, s100, s101
    s_or_b32 s100, s100, 1
    v_mov_b32 v3, s100
    v_mov_b32 v4, 36
    buffer_store_dword v3, v4, s[16:19], 0 offen sc1
    s_nop 3
polld_198:
wst_196:
    s_barrier
    v_mov_b32 v5, 8
    s_mov_b32 s100, 0
    s_nop 3
poll_199:
    buffer_load_dword v6, v5, s[16:19], 0 offen sc1
    s_waitcnt vmcnt(0)
    v_cmp_gt_u32 vcc, 64, v6
    s_nop 3
    s_cbranch_vccz polld_200
    s_cmp_lg_u32 s25, 0
    s_cbranch_scc1 polld_200
    s_add_u32 s100, s100, 1
    s_cmp_lt_u32 s100, 400000
    s_sleep 8
    s_cbranch_scc1 poll_199
    s_mov_b32 s25, 1
    s_lshl_b32 s100, s3, 16
    s_lshl_b32 s101, s62, 8
    s_or_b32 s100, s100, s101
    s_or_b32 s100, s100, 2
    v_mov_b32 v3, s100
    v_mov_b32 v4, 40
    buffer_store_dword v3, v4, s[16:19], 0 offen sc1
    s_nop 3
polld_200:
    v_readfirstlane_b32 s26, v6
    s_and_b32 s88, s26, 1
    s_xor_b32 s89, s88, 1
    s_lshl_b32 s89, s89, 13
    s_xor_b32 s91, s89, 8192
    s_mov_b32 s90, 0
    s_cmp_lg_u32 s24, 0
    s_cbranch_scc1 du_201
    v_mov_b32 v5, 0
    s_mov_b32 s100, 0
    s_nop 3
poll_202:
    buffer_load_dword v6, v5, s[4:7], s91 offen sc1
    s_waitcnt vmcnt(0)
    v_cmp_gt_u32 vcc, 1, v6
    s_nop 3
    s_cbranch_vccz polld_203
    s_cmp_lg_u32 s25, 0
    s_cbranch_scc1 polld_203
    s_add_u32 s100, s100, 1
    s_cmp_lt_u32 s100, 400000
    s_sleep 20
    s_cbranch_scc1 poll_202
    s_mov_b32 s25, 1
    s_lshl_b32 s100, s3, 16
    s_lshl_b32 s101, s62, 8
    s_or_b32 s100, s100, s101
    s_or_b32 s100, s100, 5
    v_mov_b32 v3, s100
    v_mov_b32 v4, 52
    buffer_store_dword v3, v4, s[16:19], 0 offen sc1
    s_nop 3
polld_203:
du_201:
    s_barrier
    s_and_b32 s26, s24, 3
    s_mov_b32 s8, s48
    s_and_b32 s9, s49, 0xffff
    s_mov_b32 s10, 0xc8000
    s_mov_b32 s11, 0x20000
    s_lshl_b32 s67, s63, 8
    s_lshl_b32 s29, s26, 6
    v_lshrrev_b32 v3, 2, v1
    v_mul_u32_u24 v3, 288, v3
    v_and_b32 v4, 3, v1
    v_lshl_add_u32 v3, v4, 3, v3
    v_add_u32 v13, s29, v3
    s_mov_b32 s26, s24
    s_add_u32 s28, s67, 0
    s_nop 2
stg_204:
    s_min_u32 s27, s26, 71
    s_lshl_b32 s27, s27, 6
    v_add_u32 v10, s27, v1
    s_lshl_b32 s27, s27, 4
    v_mul_u32_u24 v11, 58255, v10
    v_lshrrev_b32 v11, 20, v11
    v_mul_u32_u24 v12, 18, v11
    v_sub_u32 v12, v10, v12
    v_min_u32 v12, 15, v12
    v_mul_u32_u24 v11, 1280, v11
    s_add_u32 m0, s27, 0
    v_lshl_add_u32 v11, v12, 4, v11
    s_add_u32 s26, s26, 8
    buffer_load_dwordx4 v11, s[8:11], s28 offen lds
    s_cmp_lt_u32 s26, 72
    s_nop 0
    s_cbranch_scc1 stg_204
    s_mov_b32 s26, s24
    s_add_u32 s28, s67, 327680
stg_205:
    s_min_u32 s27, s26, 71
    s_lshl_b32 s27, s27, 6
    v_add_u32 v10, s27, v1
    s_lshl_b32 s27, s27, 4
    v_mul_u32_u24 v11, 58255, v10
    v_lshrrev_b32 v11, 20, v11
    v_mul_u32_u24 v12, 18, v11
    v_sub_u32 v12, v10, v12
    v_min_u32 v12, 15, v12
    v_mul_u32_u24 v11, 1280, v11
    s_add_u32 m0, s27, 81920
    v_lshl_add_u32 v11, v12, 4, v11
    s_add_u32 s26, s26, 8
    buffer_load_dwordx4 v11, s[8:11], s28 offen lds
    s_cmp_lt_u32 s26, 72
    s_nop 0
    s_cbranch_scc1 stg_205
    s_waitcnt vmcnt(9)
    s_barrier
    v_add_u32 v14, 0, v13
    ds_read_b64_tr_b16 a[0:1], v14 offset:0
    ds_read_b64_tr_b16 a[2:3], v14 offset:4608
    ds_read_b64_tr_b16 a[80:81], v14 offset:32
    ds_read_b64_tr_b16 a[82:83], v14 offset:4640
    ds_read_b64_tr_b16 a[4:5], v14 offset:9216
    ds_read_b64_tr_b16 a[6:7], v14 offset:13824
    ds_read_b64_tr_b16 a[84:85], v14 offset:9248
    ds_read_b64_tr_b16 a[86:87], v14 offset:13856
    ds_read_b64_tr_b16 a[8:9], v14 offset:18432
    ds_read_b64_tr_b16 a[10:11], v14 offset:23040
    ds_read_b64_tr_b16 a[88:89], v14 offset:18464
    ds_read_b64_tr_b16 a[90:91], v14 offset:23072
    ds_read_b64_tr_b16 a[12:13], v14 offset:27648
    ds_read_b64_tr_b16 a[14:15], v14 offset:32256
    ds_read_b64_tr_b16 a[92:93], v14 offset:27680
    ds_read_b64_tr_b16 a[94:95], v14 offset:32288
    ds_read_b64_tr_b16 a[16:17], v14 offset:36864
    ds_read_b64_tr_b16 a[18:19], v14 offset:41472
    ds_read_b64_tr_b16 a[96:97], v14 offset:36896
    ds_read_b64_tr_b16 a[98:99], v14 offset:41504
    ds_read_b64_tr_b16 a[20:21], v14 offset:46080
    ds_read_b64_tr_b16 a[22:23], v14 offset:50688
    ds_read_b64_tr_b16 a[100:101], v14 offset:46112
    ds_read_b64_tr_b16 a[102:103], v14 offset:50720
    ds_read_b64_tr_b16 a[24:25], v14 offset:55296
    ds_read_b64_tr_b16 a[26:27], v14 offset:59904
    ds_read_b64_tr_b16 a[104:105], v14 offset:55328
    ds_read_b64_tr_b16 a[106:107], v14 offset:59936
    ds_read_b64_tr_b16 a[28:29], v14 offset:64512
    v_add_u32 v14, 32768, v14
    ds_read_b64_tr_b16 a[30:31], v14 offset:36352
    ds_read_b64_tr_b16 a[108:109], v14 offset:31776
    ds_read_b64_tr_b16 a[110:111], v14 offset:36384
    s_waitcnt lgkmcnt(0)
    s_barrier
    s_mov_b32 s26, s24
    s_add_u32 s28, s67, 655360
stg_206:
    s_min_u32 s27, s26, 35
    s_lshl_b32 s27, s27, 6
    v_add_u32 v10, s27, v1
    s_lshl_b32 s27, s27, 4
    v_mul_u32_u24 v11, 58255, v10
    v_lshrrev_b32 v11, 20, v11
    v_mul_u32_u24 v12, 18, v11
    v_sub_u32 v12, v10, v12
    v_min_u32 v12, 15, v12
    v_mul_u32_u24 v11, 1280, v11
    s_add_u32 m0, s27, 0
    v_lshl_add_u32 v11, v12, 4, v11
    s_add_u32 s26, s26, 8
    buffer_load_dwordx4 v11, s[8:11], s28 offen lds
    s_cmp_lt_u32 s26, 40
    s_nop 0
    s_cbranch_scc1 stg_206
    s_waitcnt vmcnt(5)
    s_barrier
    v_add_u32 v14, 81920, v13
    ds_read_b64_tr_b16 a[32:33], v14 offset:0
    ds_read_b64_tr_b16 a[34:35], v14 offset:4608
    ds_read_b64_tr_b16 a[112:113], v14 offset:32
    ds_read_b64_tr_b16 a[114:115], v14 offset:4640
    ds_read_b64_tr_b16 a[36:37], v14 offset:9216
    ds_read_b64_tr_b16 a[38:39], v14 offset:13824
    ds_read_b64_tr_b16 a[116:117], v14 offset:9248
    ds_read_b64_tr_b16 a[118:119], v14 offset:13856
    ds_read_b64_tr_b16 a[40:41], v14 offset:18432
    ds_read_b64_tr_b16 a[42:43], v14 offset:23040
    ds_read_b64_tr_b16 a[120:121], v14 offset:18464
    ds_read_b64_tr_b16 a[122:123], v14 offset:23072
    ds_read_b64_tr_b16 a[44:45], v14 offset:27648
    ds_read_b64_tr_b16 a[46:47], v14 offset:32256
    ds_read_b64_tr_b16 a[124:125], v14 offset:27680
    ds_read_b64_tr_b16 a[126:127], v14 offset:32288
    ds_read_b64_tr_b16 a[48:49], v14 offset:36864
    ds_read_b64_tr_b16 a[50:51], v14 offset:41472
    ds_read_b64_tr_b16 a[128:129], v14 offset:36896
    ds_read_b64_tr_b16 a[130:131], v14 offset:41504
    ds_read_b64_tr_b16 a[52:53], v14 offset:46080
    ds_read_b64_tr_b16 a[54:55], v14 offset:50688
    ds_read_b64_tr_b16 a[132:133], v14 offset:46112
    ds_read_b64_tr_b16 a[134:135], v14 offset:50720
    ds_read_b64_tr_b16 a[56:57], v14 offset:55296
    ds_read_b64_tr_b16 a[58:59], v14 offset:59904
    ds_read_b64_tr_b16 a[136:137], v14 offset:55328
    ds_read_b64_tr_b16 a[138:139], v14 offset:59936
    ds_read_b64_tr_b16 a[60:61], v14 offset:64512
    v_add_u32 v14, 32768, v14
    ds_read_b64_tr_b16 a[62:63], v14 offset:36352
    ds_read_b64_tr_b16 a[140:141], v14 offset:31776
    ds_read_b64_tr_b16 a[142:143], v14 offset:36384
    s_waitcnt lgkmcnt(0)
    s_barrier
    s_waitcnt vmcnt(0)
    s_barrier
    v_add_u32 v14, 0, v13
    ds_read_b64_tr_b16 a[64:65], v14 offset:0
    ds_read_b64_tr_b16 a[66:67], v14 offset:4608
    ds_read_b64_tr_b16 a[144:145], v14 offset:32
    ds_read_b64_tr_b16 a[146:147], v14 offset:4640
    ds_read_b64_tr_b16 a[68:69], v14 offset:9216
    ds_read_b64_tr_b16 a[70:71], v14 offset:13824
    ds_read_b64_tr_b16 a[148:149], v14 offset:9248
    ds_read_b64_tr_b16 a[150:151], v14 offset:13856
    ds_read_b64_tr_b16 a[72:73], v14 offset:18432
    ds_read_b64_tr_b16 a[74:75], v14 offset:23040
    ds_read_b64_tr_b16 a[152:153], v14 offset:18464
    ds_read_b64_tr_b16 a[154:155], v14 offset:23072
    ds_read_b64_tr_b16 a[76:77], v14 offset:27648
    ds_read_b64_tr_b16 a[78:79], v14 offset:32256
    ds_read_b64_tr_b16 a[156:157], v14 offset:27680
    ds_read_b64_tr_b16 a[158:159], v14 offset:32288
    s_waitcnt lgkmcnt(0)
    s_barrier
    v_mov_b32 v24, 0x3f803f80
    v_mov_b32 v25, 0x3f803f80
    v_mov_b32 v26, 0x3f803f80
    v_mov_b32 v27, 0x3f803f80
    s_nop 1
    v_mfma_f32_16x16x32_bf16 v[40:43], a[0:3], v[24:27], 0
    v_mfma_f32_16x16x32_bf16 v[44:47], a[80:83], v[24:27], 0
    v_mfma_f32_16x16x32_bf16 v[40:43], a[4:7], v[24:27], v[40:43]
    v_mfma_f32_16x16x32_bf16 v[44:47], a[84:87], v[24:27], v[44:47]
    v_mfma_f32_16x16x32_bf16 v[40:43], a[8:11], v[24:27], v[40:43]
    v_mfma_f32_16x16x32_bf16 v[44:47], a[88:91], v[24:27], v[44:47]
    v_mfma_f32_16x16x32_bf16 v[40:43], a[12:15], v[24:27], v[40:43]
    v_mfma_f32_16x16x32_bf16 v[44:47], a[92:95], v[24:27], v[44:47]
    v_mfma_f32_16x16x32_bf16 v[40:43], a[16:19], v[24:27], v[40:43]
    v_mfma_f32_16x16x32_bf16 v[44:47], a[96:99], v[24:27], v[44:47]
    v_mfma_f32_16x16x32_bf16 v[40:43], a[20:23], v[24:27], v[40:43]
    v_mfma_f32_16x16x32_bf16 v[44:47], a[100:103], v[24:27], v[44:47]
    v_mfma_f32_16x16x32_bf16 v[40:43], a[24:27], v[24:27], v[40:43]
    v_mfma_f32_16x16x32_bf16 v[44:47], a[104:107], v[24:27], v[44:47]
    v_mfma_f32_16x16x32_bf16 v[40:43], a[28:31], v[24:27], v[40:43]
    v_mfma_f32_16x16x32_bf16 v[44:47], a[108:111], v[24:27], v[44:47]
    v_mfma_f32_16x16x32_bf16 v[40:43], a[32:35], v[24:27], v[40:43]
    v_mfma_f32_16x16x32_bf16 v[44:47], a[112:115], v[24:27], v[44:47]
    v_mfma_f32_16x16x32_bf16 v[40:43], a[36:39], v[24:27], v[40:43]
    v_mfma_f32_16x16x32_bf16 v[44:47], a[116:119], v[24:27], v[44:47]
    v_mfma_f32_16x16x32_bf16 v[40:43], a[40:43], v[24:27], v[40:43]
    v_mfma_f32_16x16x32_bf16 v[44:47], a[120:123], v[24:27], v[44:47]
    v_mfma_f32_16x16x32_bf16 v[40:43], a[44:47], v[24:27], v[40:43]
    v_mfma_f32_16x16x32_bf16 v[44:47], a[124:127], v[24:27], v[44:47]
    v_mfma_f32_16x16x32_bf16 v[40:43], a[48:51], v[24:27], v[40:43]
    v_mfma_f32_16x16x32_bf16 v[44:47], a[128:131], v[24:27], v[44:47]
    v_mfma_f32_16x16x32_bf16 v[40:43], a[52:55], v[24:27], v[40:43]
    v_mfma_f32_16x16x32_bf16 v[44:47], a[132:135], v[24:27], v[44:47]
    v_mfma_f32_16x16x32_bf16 v[40:43], a[56:59], v[24:27], v[40:43]
    v_mfma_f32_16x16x32_bf16 v[44:47], a[136:139], v[24:27], v[44:47]
    v_mfma_f32_16x16x32_bf16 v[40:43], a[60:63], v[24:27], v[40:43]
    v_mfma_f32_16x16x32_bf16 v[44:47], a[140:143], v[24:27], v[44:47]
    v_mfma_f32_16x16x32_bf16 v[40:43], a[64:67], v[24:27], v[40:43]
    v_mfma_f32_16x16x32_bf16 v[44:47], a[144:147], v[24:27], v[44:47]
    v_mfma_f32_16x16x32_bf16 v[40:43], a[68:71], v[24:27], v[40:43]
    v_mfma_f32_16x16x32_bf16 v[44:47], a[148:151], v[24:27], v[44:47]
    v_mfma_f32_16x16x32_bf16 v[40:43], a[72:75], v[24:27], v[40:43]
    v_mfma_f32_16x16x32_bf16 v[44:47], a[152:155], v[24:27], v[44:47]
    v_mfma_f32_16x16x32_bf16 v[40:43], a[76:79], v[24:27], v[40:43]
    v_mfma_f32_16x16x32_bf16 v[44:47], a[156:159], v[24:27], v[44:47]
    v_min_u32 v3, 39, v1
    v_lshrrev_b32 v4, 2, v3
    v_and_b32 v3, 3, v3
    v_lshlrev_b32 v4, 7, v4
    v_lshl_add_u32 v3, v3, 2, v4
    v_add_u32 v9, 20480, v3
    v_and_b32 v3, 15, v1
    v_lshrrev_b32 v4, 4, v1
    v_mul_u32_u24 v4, 160, v4
    v_add_u32 v4, v4, v3
    s_lshl_b32 s26, s66, 4
    v_add_u32 v4, s26, v4
    v_lshlrev_b32 v10, 3, v4
    v_lshlrev_b32 v61, 3, v3
    s_mov_b32 s69, 0xc0135761
    s_mov_b32 s70, 0xbdd2d3e8
    s_mov_b32 s71, 0
    s_mov_b32 s75, 0
    s_cmp_lg_u32 s24, 0
    s_cbranch_scc1 wst_207
    v_and_b32 v5, 3, v1
    v_lshlrev_b32 v5, 6, v5
    s_mov_b32 s100, 0
    s_nop 3
poll_208:
    buffer_load_dword v6, v5, s[16:19], 0 offen sc1
    s_waitcnt vmcnt(0)
    v_cmp_gt_u32 vcc, 32, v6
    s_nop 3
    s_cbranch_vccz polld_209
    s_cmp_lg_u32 s25, 0
    s_cbranch_scc1 polld_209
    s_add_u32 s100, s100, 1
    s_cmp_lt_u32 s100, 400000
    s_sleep 8
    s_cbranch_scc1 poll_208
    s_mov_b32 s25, 1
    s_lshl_b32 s100, s3, 16
    s_lshl_b32 s101, s62, 8
    s_or_b32 s100, s100, s101
    s_or_b32 s100, s100, 1
    v_mov_b32 v3, s100
    v_mov_b32 v4, 36
    buffer_store_dword v3, v4, s[16:19], 0 offen sc1
    s_nop 3
polld_209:
wst_207:
    s_barrier
    s_mul_i32 s62, s87, 45
M1_loop:
    s_add_u32 s72, s62, 1
    s_cmp_ge_u32 s62, 44
    s_cselect_b32 s77, 2, 1
    s_add_u32 s77, s77, s62
    s_cmp_lg_u32 s75, 0
    s_cbranch_scc1 mh_210
    s_cmp_lg_u32 s24, 0
    s_cbranch_scc1 p1_211
    s_and_b32 s26, s62, 1
    s_mul_i32 s26, s26, 1280
    v_add_u32 v5, s26, v9
    s_add_u32 s30, s62, 1
    s_mov_b32 s100, 0
    s_nop 2
poll_212:
    buffer_load_dword v6, v5, s[4:7], s89 offen sc1
    s_waitcnt vmcnt(0)
    v_cmp_gt_u32 vcc, s30, v6
    s_nop 3
    s_cbranch_vccz polld_213
    s_cmp_lg_u32 s25, 0
    s_cbranch_scc1 polld_213
    s_cmp_ge_u32 s62, 58
    s_cbranch_scc1 lz_214
    s_sleep 24
lz_214:
    s_add_u32 s100, s100, 1
    s_cmp_lt_u32 s100, 400000
    s_sleep 3
    s_cbranch_scc1 poll_212
    s_mov_b32 s25, 1
    s_lshl_b32 s100, s3, 16
    s_lshl_b32 s101, s62, 8
    s_or_b32 s100, s100, s101
    s_or_b32 s100, s100, 25
    v_mov_b32 v3, s100
    v_mov_b32 v4, 36
    buffer_store_dword v3, v4, s[16:19], 0 offen sc1
    s_nop 3
polld_213:
p1_211:
    s_barrier
    s_mul_i32 s73, s62, 40960
    s_add_u32 s73, s73, 0x900000
    s_mul_i32 s26, s24, 5120
    s_add_u32 s27, s26, s73
    s_add_u32 s26, s26, s71
    s_add_u32 m0, s26, 0
    s_nop 0
    buffer_load_dwordx4 v2, s[4:7], s27 offen offset:0 sc1 lds
    buffer_load_dwordx4 v2, s[4:7], s27 offen offset:1024 sc1 lds
    buffer_load_dwordx4 v2, s[4:7], s27 offen offset:2048 sc1 lds
    buffer_load_dwordx4 v2, s[4:7], s27 offen offset:3072 sc1 lds
    s_add_u32 m0, s26, 4096
    s_add_u32 s27, s27, 4096
    buffer_load_dwordx4 v2, s[4:7], s27 offen offset:0 sc1 lds
    s_mul_i32 s26, s62, 5120
    s_add_u32 s26, s26, 0x1800000
    buffer_load_dwordx2 v[48:49], v10, s[4:7], s26 offen offset:0 sc1
    buffer_load_dwordx2 v[50:51], v10, s[4:7], s26 offen offset:256 sc1
    buffer_load_dwordx2 v[52:53], v10, s[4:7], s26 offen offset:512 sc1
    buffer_load_dwordx2 v[54:55], v10, s[4:7], s26 offen offset:768 sc1
    buffer_load_dwordx2 v[56:57], v10, s[4:7], s26 offen offset:1024 sc1
mh_210:
    s_lshl_b32 s76, s62, 1
    s_add_u32 s76, s76, s66
    s_mul_i32 s76, s76, 20
    s_add_u32 s76, s76, s65
    s_lshl_b32 s76, s76, 10
    s_mul_i32 s26, s66, 20480
    s_add_u32 s26, s26, s71
    v_add_u32 v11, s26, v2
    s_cmp_lg_u32 s24, 0
    s_nop 2
    s_cbranch_scc1 lf_215
    s_and_b32 s26, s77, 1
    s_mul_i32 s26, s26, 1280
    v_add_u32 v5, s26, v9
    s_add_u32 s30, s77, 1
    buffer_load_dword v63, v5, s[4:7], s89 offen sc1
    s_waitcnt vmcnt(0)
    v_cmp_gt_u32 vcc, s30, v63
    s_cmp_eq_u64 vcc, 0
    s_cselect_b32 s26, 1, 0
    s_cmp_lt_u32 s77, 64
    s_cselect_b32 s26, s26, 0
    s_lshr_b32 s27, s71, 13
    s_add_u32 s27, s27, 81920
    s_andn2_b32 s27, s27, 3
    v_mov_b32 v3, s27
    v_mov_b32 v4, s26
    ds_write_b32 v3, v4
    s_nop 3
lf_215:
    s_waitcnt vmcnt(0) lgkmcnt(0)
    s_barrier
    s_lshr_b32 s27, s71, 13
    s_add_u32 s27, s27, 81920
    s_andn2_b32 s27, s27, 3
    v_mov_b32 v3, s27
    ds_read_b32 v63, v3
    v_add_f32 v58, v48, v50
    v_add_f32 v58, v58, v52
    v_add_f32 v58, v58, v54
    v_add_f32 v58, v58, v56
    v_mov_b32 v60, v58
    s_nop 1
    v_permlane16_swap_b32 v58, v60
    v_add_f32 v58, v58, v60
    v_mov_b32 v60, v58
    s_nop 1
    v_permlane32_swap_b32 v58, v60
    v_add_f32 v58, v58, v60
    v_mul_f32 v58, 0x3d4ccccd, v58
    v_sub_f32 v48, v48, v58
    v_sub_f32 v50, v50, v58
    v_sub_f32 v52, v52, v58
    v_sub_f32 v54, v54, v58
    v_sub_f32 v56, v56, v58
    v_mul_f32 v59, v48, v48
    v_fmac_f32 v59, v50, v50
    v_fmac_f32 v59, v52, v52
    v_fmac_f32 v59, v54, v54
    v_fmac_f32 v59, v56, v56
    v_mul_f32 v59, 0x42000000, v59
    v_add_f32 v59, v59, v49
    v_add_f32 v59, v59, v51
    v_add_f32 v59, v59, v53
    v_add_f32 v59, v59, v55
    v_add_f32 v59, v59, v57
    v_mov_b32 v60, v59
    s_nop 1
    v_permlane16_swap_b32 v59, v60
    v_add_f32 v59, v59, v60
    v_mov_b32 v60, v59
    s_nop 1
    v_permlane32_swap_b32 v59, v60
    v_add_f32 v59, v59, v60
    v_mul_f32 v59, 0x3acccccd, v59
    s_waitcnt lgkmcnt(0)
    v_readfirstlane_b32 s75, v63
    s_xor_b32 s71, s71, 40960
    s_cmp_eq_u32 s75, 0
    s_nop 1
    s_cbranch_scc1 np_216
    s_mul_i32 s73, s77, 40960
    s_add_u32 s73, s73, 0x900000
    s_mul_i32 s26, s24, 5120
    s_add_u32 s27, s26, s73
    s_add_u32 s26, s26, s71
    s_add_u32 m0, s26, 0
    s_nop 0
    buffer_load_dwordx4 v2, s[4:7], s27 offen offset:0 sc1 lds
    buffer_load_dwordx4 v2, s[4:7], s27 offen offset:1024 sc1 lds
    buffer_load_dwordx4 v2, s[4:7], s27 offen offset:2048 sc1 lds
    buffer_load_dwordx4 v2, s[4:7], s27 offen offset:3072 sc1 lds
    s_add_u32 m0, s26, 4096
    s_add_u32 s27, s27, 4096
    buffer_load_dwordx4 v2, s[4:7], s27 offen offset:0 sc1 lds
    s_mul_i32 s26, s77, 5120
    s_add_u32 s26, s26, 0x1800000
    buffer_load_dwordx2 v[48:49], v10, s[4:7], s26 offen offset:0 sc1
    buffer_load_dwordx2 v[50:51], v10, s[4:7], s26 offen offset:256 sc1
    buffer_load_dwordx2 v[52:53], v10, s[4:7], s26 offen offset:512 sc1
    buffer_load_dwordx2 v[54:55], v10, s[4:7], s26 offen offset:768 sc1
    buffer_load_dwordx2 v[56:57], v10, s[4:7], s26 offen offset:1024 sc1
np_216:
    ds_read_b128 v[24:27], v11 offset:0
    ds_read_b128 v[28:31], v11 offset:1024
    ds_read_b128 v[32:35], v11 offset:2048
    ds_read_b128 v[36:39], v11 offset:3072
    s_waitcnt lgkmcnt(3)
    v_mfma_f32_16x16x32_bf16 v[12:15], a[0:3], v[24:27], 0
    v_mfma_f32_16x16x32_bf16 v[16:19], a[80:83], v[24:27], 0
    ds_read_b128 v[24:27], v11 offset:4096
    s_waitcnt lgkmcnt(3)
    v_mfma_f32_16x16x32_bf16 v[12:15], a[4:7], v[28:31], v[12:15]
    v_mfma_f32_16x16x32_bf16 v[16:19], a[84:87], v[28:31], v[16:19]
    ds_read_b128 v[28:31], v11 offset:5120
    s_waitcnt lgkmcnt(3)
    v_mfma_f32_16x16x32_bf16 v[12:15], a[8:11], v[32:35], v[12:15]
    v_mfma_f32_16x16x32_bf16 v[16:19], a[88:91], v[32:35], v[16:19]
    ds_read_b128 v[32:35], v11 offset:6144
    s_waitcnt lgkmcnt(3)
    v_mfma_f32_16x16x32_bf16 v[12:15], a[12:15], v[36:39], v[12:15]
    v_mfma_f32_16x16x32_bf16 v[16:19], a[92:95], v[36:39], v[16:19]
    ds_read_b128 v[36:39], v11 offset:7168
    s_waitcnt lgkmcnt(3)
    v_mfma_f32_16x16x32_bf16 v[12:15], a[16:19], v[24:27], v[12:15]
    v_mfma_f32_16x16x32_bf16 v[16:19], a[96:99], v[24:27], v[16:19]
    ds_read_b128 v[24:27], v11 offset:8192
    s_waitcnt lgkmcnt(3)
    v_mfma_f32_16x16x32_bf16 v[12:15], a[20:23], v[28:31], v[12:15]
    v_mfma_f32_16x16x32_bf16 v[16:19], a[100:103], v[28:31], v[16:19]
    ds_read_b128 v[28:31], v11 offset:9216
    s_waitcnt lgkmcnt(3)
    v_mfma_f32_16x16x32_bf16 v[12:15], a[24:27], v[32:35], v[12:15]
    v_mfma_f32_16x16x32_bf16 v[16:19], a[104:107], v[32:35], v[16:19]
    ds_read_b128 v[32:35], v11 offset:10240
    s_waitcnt lgkmcnt(3)
    v_mfma_f32_16x16x32_bf16 v[12:15], a[28:31], v[36:39], v[12:15]
    v_mfma_f32_16x16x32_bf16 v[16:19], a[108:111], v[36:39], v[16:19]
    ds_read_b128 v[36:39], v11 offset:11264
    s_waitcnt lgkmcnt(3)
    v_mfma_f32_16x16x32_bf16 v[12:15], a[32:35], v[24:27], v[12:15]
    v_mfma_f32_16x16x32_bf16 v[16:19], a[112:115], v[24:27], v[16:19]
    ds_read_b128 v[24:27], v11 offset:12288
    s_waitcnt lgkmcnt(3)
    v_mfma_f32_16x16x32_bf16 v[12:15], a[36:39], v[28:31], v[12:15]
    v_mfma_f32_16x16x32_bf16 v[16:19], a[116:119], v[28:31], v[16:19]
    ds_read_b128 v[28:31], v11 offset:13312
    s_waitcnt lgkmcnt(3)
    v_mfma_f32_16x16x32_bf16 v[12:15], a[40:43], v[32:35], v[12:15]
    v_mfma_f32_16x16x32_bf16 v[16:19], a[120:123], v[32:35], v[16:19]
    ds_read_b128 v[32:35], v11 offset:14336
    s_waitcnt lgkmcnt(3)
    v_mfma_f32_16x16x32_bf16 v[12:15], a[44:47], v[36:39], v[12:15]
    v_mfma_f32_16x16x32_bf16 v[16:19], a[124:127], v[36:39], v[16:19]
    ds_read_b128 v[36:39], v11 offset:15360
    s_waitcnt lgkmcnt(3)
    v_mfma_f32_16x16x32_bf16 v[12:15], a[48:51], v[24:27], v[12:15]
    v_mfma_f32_16x16x32_bf16 v[16:19], a[128:131], v[24:27], v[16:19]
    ds_read_b128 v[24:27], v11 offset:16384
    s_waitcnt lgkmcnt(3)
    v_mfma_f32_16x16x32_bf16 v[12:15], a[52:55], v[28:31], v[12:15]
    v_mfma_f32_16x16x32_bf16 v[16:19], a[132:135], v[28:31], v[16:19]
    ds_read_b128 v[28:31], v11 offset:17408
    s_waitcnt lgkmcnt(3)
    v_mfma_f32_16x16x32_bf16 v[12:15], a[56:59], v[32:35], v[12:15]
    v_mfma_f32_16x16x32_bf16 v[16:19], a[136:139], v[32:35], v[16:19]
    ds_read_b128 v[32:35], v11 offset:18432
    s_waitcnt lgkmcnt(3)
    v_mfma_f32_16x16x32_bf16 v[12:15], a[60:63], v[36:39], v[12:15]
    v_mfma_f32_16x16x32_bf16 v[16:19], a[140:143], v[36:39], v[16:19]
    ds_read_b128 v[36:39], v11 offset:19456
    s_waitcnt lgkmcnt(3)
    v_mfma_f32_16x16x32_bf16 v[12:15], a[64:67], v[24:27], v[12:15]
    v_mfma_f32_16x16x32_bf16 v[16:19], a[144:147], v[24:27], v[16:19]
    s_waitcnt lgkmcnt(2)
    v_mfma_f32_16x16x32_bf16 v[12:15], a[68:71], v[28:31], v[12:15]
    v_mfma_f32_16x16x32_bf16 v[16:19], a[148:151], v[28:31], v[16:19]
    s_waitcnt lgkmcnt(1)
    v_mfma_f32_16x16x32_bf16 v[12:15], a[72:75], v[32:35], v[12:15]
    v_mfma_f32_16x16x32_bf16 v[16:19], a[152:155], v[32:35], v[16:19]
    s_waitcnt lgkmcnt(0)
    v_mfma_f32_16x16x32_bf16 v[12:15], a[76:79], v[36:39], v[12:15]
    v_mfma_f32_16x16x32_bf16 v[16:19], a[156:159], v[36:39], v[16:19]
    v_add_f32 v60, 0x3727c5ac, v59
    v_rsq_f32 v60, v60
    s_nop 0
    v_mul_f32 v59, v59, v60
    v_mul_f32 v59, v59, v60
    v_add_f32 v59, 0x3727c5ac, v59
    v_rsq_f32 v59, v59
    s_nop 0
    v_mul_f32 v60, v60, v59
    v_fma_f32 v12, -v58, v40, v12
    v_fma_f32 v13, -v58, v41, v13
    v_fma_f32 v14, -v58, v42, v14
    v_fma_f32 v15, -v58, v43, v15
    v_fma_f32 v16, -v58, v44, v16
    v_fma_f32 v17, -v58, v45, v17
    v_fma_f32 v18, -v58, v46, v18
    v_fma_f32 v19, -v58, v47, v19
    v_mul_f32 v12, v12, v60
    v_mul_f32 v13, v13, v60
    v_mul_f32 v14, v14, v60
    v_mul_f32 v15, v15, v60
    v_mul_f32 v16, v16, v60
    v_mul_f32 v17, v17, v60
    v_mul_f32 v18, v18, v60
    v_mul_f32 v19, v19, v60
    v_mul_f32 v24, v12, v12
    v_mul_f32 v25, v13, v13
    v_mul_f32 v26, v14, v14
    v_mul_f32 v27, v15, v15
    v_mul_f32 v28, v16, v16
    v_mul_f32 v29, v17, v17
    v_mul_f32 v30, v18, v18
    v_mul_f32 v31, v19, v19
    v_mul_f32 v24, s70, v24
    v_mul_f32 v25, s70, v25
    v_mul_f32 v26, s70, v26
    v_mul_f32 v27, s70, v27
    v_mul_f32 v28, s70, v28
    v_mul_f32 v29, s70, v29
    v_mul_f32 v30, s70, v30
    v_mul_f32 v31, s70, v31
    v_add_f32 v24, s69, v24
    v_add_f32 v25, s69, v25
    v_add_f32 v26, s69, v26
    v_add_f32 v27, s69, v27
    v_add_f32 v28, s69, v28
    v_add_f32 v29, s69, v29
    v_add_f32 v30, s69, v30
    v_add_f32 v31, s69, v31
    v_mul_f32 v24, v24, v12
    v_mul_f32 v25, v25, v13
    v_mul_f32 v26, v26, v14
    v_mul_f32 v27, v27, v15
    v_mul_f32 v28, v28, v16
    v_mul_f32 v29, v29, v17
    v_mul_f32 v30, v30, v18
    v_mul_f32 v31, v31, v19
    v_exp_f32 v24, v24
    v_exp_f32 v25, v25
    v_exp_f32 v26, v26
    v_exp_f32 v27, v27
    v_exp_f32 v28, v28
    v_exp_f32 v29, v29
    v_exp_f32 v30, v30
    v_exp_f32 v31, v31
    v_add_f32 v24, 1.0, v24
    v_add_f32 v25, 1.0, v25
    v_add_f32 v26, 1.0, v26
    v_add_f32 v27, 1.0, v27
    v_add_f32 v28, 1.0, v28
    v_add_f32 v29, 1.0, v29
    v_add_f32 v30, 1.0, v30
    v_add_f32 v31, 1.0, v31
    v_rcp_f32 v24, v24
    v_rcp_f32 v25, v25
    v_rcp_f32 v26, v26
    v_rcp_f32 v27, v27
    v_rcp_f32 v28, v28
    v_rcp_f32 v29, v29
    v_rcp_f32 v30, v30
    v_rcp_f32 v31, v31
    v_mul_f32 v12, v12, v24
    v_mul_f32 v13, v13, v25
    v_mul_f32 v14, v14, v26
    v_mul_f32 v15, v15, v27
    v_mul_f32 v16, v16, v28
    v_mul_f32 v17, v17, v29
    v_mul_f32 v18, v18, v30
    v_mul_f32 v19, v19, v31
    v_cvt_pk_bf16_f32 v20, v12, v13
    v_cvt_pk_bf16_f32 v21, v14, v15
    v_cvt_pk_bf16_f32 v22, v16, v17
    v_cvt_pk_bf16_f32 v23, v18, v19
    s_add_u32 s26, s76, 0xc00000
    buffer_store_dwordx4 v[20:23], v2, s[4:7], s26 offen sc1
    s_waitcnt vmcnt(0)
    v_mov_b32 v3, s72
    v_mov_b32 v4, s91
    s_mov_b64 exec, 1
    buffer_store_dword v3, v4, s[4:7], s68 offen sc1
    s_mov_b64 exec, -1
    s_mov_b32 s62, s77
    s_cmp_lt_u32 s62, 64
    s_cbranch_scc1 M1_loop
    s_endpgm
R_M2:
    s_and_b32 s26, s24, 3
    s_lshl_b32 s65, s63, 2
    s_add_u32 s65, s65, s26
    s_lshr_b32 s66, s24, 2
    s_lshl_b32 s68, s63, 5
    s_add_u32 s68, s68, s24
    s_lshl_b32 s68, s68, 2
    s_add_u32 s68, s68, 36864
    s_lshl_b32 s27, s87, 11
    s_add_u32 s68, s68, s27
    s_cmp_lg_u32 s24, 0
    s_cbranch_scc1 wst_217
    v_and_b32 v5, 3, v1
    v_lshlrev_b32 v5, 6, v5
    s_mov_b32 s100, 0
    s_nop 3
poll_218:
    buffer_load_dword v6, v5, s[16:19], 0 offen sc1
    s_waitcnt vmcnt(0)
    v_cmp_gt_u32 vcc, 32, v6
    s_nop 3
    s_cbranch_vccz polld_219
    s_cmp_lg_u32 s25, 0
    s_cbranch_scc1 polld_219
    s_add_u32 s100, s100, 1
    s_cmp_lt_u32 s100, 400000
    s_sleep 8
    s_cbranch_scc1 poll_218
    s_mov_b32 s25, 1
    s_lshl_b32 s100, s3, 16
    s_lshl_b32 s101, s62, 8
    s_or_b32 s100, s100, s101
    s_or_b32 s100, s100, 1
    v_mov_b32 v3, s100
    v_mov_b32 v4, 36
    buffer_store_dword v3, v4, s[16:19], 0 offen sc1
    s_nop 3
polld_219:
wst_217:
    s_barrier
    v_mov_b32 v5, 8
    s_mov_b32 s100, 0
    s_nop 3
poll_220:
    buffer_load_dword v6, v5, s[16:19], 0 offen sc1
    s_waitcnt vmcnt(0)
    v_cmp_gt_u32 vcc, 64, v6
    s_nop 3
    s_cbranch_vccz polld_221
    s_cmp_lg_u32 s25, 0
    s_cbranch_scc1 polld_221
    s_add_u32 s100, s100, 1
    s_cmp_lt_u32 s100, 400000
    s_sleep 8
    s_cbranch_scc1 poll_220
    s_mov_b32 s25, 1
    s_lshl_b32 s100, s3, 16
    s_lshl_b32 s101, s62, 8
    s_or_b32 s100, s100, s101
    s_or_b32 s100, s100, 2
    v_mov_b32 v3, s100
    v_mov_b32 v4, 40
    buffer_store_dword v3, v4, s[16:19], 0 offen sc1
    s_nop 3
polld_221:
    v_readfirstlane_b32 s26, v6
    s_and_b32 s88, s26, 1
    s_xor_b32 s89, s88, 1
    s_lshl_b32 s89, s89, 13
    s_xor_b32 s91, s89, 8192
    s_mov_b32 s90, 0
    s_cmp_lg_u32 s24, 0
    s_cbranch_scc1 du_222
    v_mov_b32 v5, 0
    s_mov_b32 s100, 0
    s_nop 3
poll_223:
    buffer_load_dword v6, v5, s[4:7], s91 offen sc1
    s_waitcnt vmcnt(0)
    v_cmp_gt_u32 vcc, 1, v6
    s_nop 3
    s_cbranch_vccz polld_224
    s_cmp_lg_u32 s25, 0
    s_cbranch_scc1 polld_224
    s_add_u32 s100, s100, 1
    s_cmp_lt_u32 s100, 400000
    s_sleep 20
    s_cbranch_scc1 poll_223
    s_mov_b32 s25, 1
    s_lshl_b32 s100, s3, 16
    s_lshl_b32 s101, s62, 8
    s_or_b32 s100, s100, s101
    s_or_b32 s100, s100, 5
    v_mov_b32 v3, s100
    v_mov_b32 v4, 52
    buffer_store_dword v3, v4, s[16:19], 0 offen sc1
    s_nop 3
polld_224:
du_222:
    s_barrier
    s_and_b32 s26, s24, 3
    s_mov_b32 s8, s50
    s_and_b32 s9, s51, 0xffff
    s_mov_b32 s10, 0xc8000
    s_mov_b32 s11, 0x20000
    s_lshl_b32 s67, s63, 8
    s_lshl_b32 s29, s26, 6
    v_lshrrev_b32 v3, 2, v1
    v_mul_u32_u24 v3, 288, v3
    v_and_b32 v4, 3, v1
    v_lshl_add_u32 v3, v4, 3, v3
    v_add_u32 v13, s29, v3
    s_mov_b32 s26, s24
    s_add_u32 s28, s67, 0
    s_nop 2
stg_225:
    s_min_u32 s27, s26, 71
    s_lshl_b32 s27, s27, 6
    v_add_u32 v10, s27, v1
    s_lshl_b32 s27, s27, 4
    v_mul_u32_u24 v11, 58255, v10
    v_lshrrev_b32 v11, 20, v11
    v_mul_u32_u24 v12, 18, v11
    v_sub_u32 v12, v10, v12
    v_min_u32 v12, 15, v12
    v_mul_u32_u24 v11, 1280, v11
    s_add_u32 m0, s27, 0
    v_lshl_add_u32 v11, v12, 4, v11
    s_add_u32 s26, s26, 8
    buffer_load_dwordx4 v11, s[8:11], s28 offen lds
    s_cmp_lt_u32 s26, 72
    s_nop 0
    s_cbranch_scc1 stg_225
    s_mov_b32 s26, s24
    s_add_u32 s28, s67, 327680
stg_226:
    s_min_u32 s27, s26, 71
    s_lshl_b32 s27, s27, 6
    v_add_u32 v10, s27, v1
    s_lshl_b32 s27, s27, 4
    v_mul_u32_u24 v11, 58255, v10
    v_lshrrev_b32 v11, 20, v11
    v_mul_u32_u24 v12, 18, v11
    v_sub_u32 v12, v10, v12
    v_min_u32 v12, 15, v12
    v_mul_u32_u24 v11, 1280, v11
    s_add_u32 m0, s27, 81920
    v_lshl_add_u32 v11, v12, 4, v11
    s_add_u32 s26, s26, 8
    buffer_load_dwordx4 v11, s[8:11], s28 offen lds
    s_cmp_lt_u32 s26, 72
    s_nop 0
    s_cbranch_scc1 stg_226
    s_waitcnt vmcnt(9)
    s_barrier
    v_add_u32 v14, 0, v13
    ds_read_b64_tr_b16 a[0:1], v14 offset:0
    ds_read_b64_tr_b16 a[2:3], v14 offset:4608
    ds_read_b64_tr_b16 a[80:81], v14 offset:32
    ds_read_b64_tr_b16 a[82:83], v14 offset:4640
    ds_read_b64_tr_b16 a[4:5], v14 offset:9216
    ds_read_b64_tr_b16 a[6:7], v14 offset:13824
    ds_read_b64_tr_b16 a[84:85], v14 offset:9248
    ds_read_b64_tr_b16 a[86:87], v14 offset:13856
    ds_read_b64_tr_b16 a[8:9], v14 offset:18432
    ds_read_b64_tr_b16 a[10:11], v14 offset:23040
    ds_read_b64_tr_b16 a[88:89], v14 offset:18464
    ds_read_b64_tr_b16 a[90:91], v14 offset:23072
    ds_read_b64_tr_b16 a[12:13], v14 offset:27648
    ds_read_b64_tr_b16 a[14:15], v14 offset:32256
    ds_read_b64_tr_b16 a[92:93], v14 offset:27680
    ds_read_b64_tr_b16 a[94:95], v14 offset:32288
    ds_read_b64_tr_b16 a[16:17], v14 offset:36864
    ds_read_b64_tr_b16 a[18:19], v14 offset:41472
    ds_read_b64_tr_b16 a[96:97], v14 offset:36896
    ds_read_b64_tr_b16 a[98:99], v14 offset:41504
    ds_read_b64_tr_b16 a[20:21], v14 offset:46080
    ds_read_b64_tr_b16 a[22:23], v14 offset:50688
    ds_read_b64_tr_b16 a[100:101], v14 offset:46112
    ds_read_b64_tr_b16 a[102:103], v14 offset:50720
    ds_read_b64_tr_b16 a[24:25], v14 offset:55296
    ds_read_b64_tr_b16 a[26:27], v14 offset:59904
    ds_read_b64_tr_b16 a[104:105], v14 offset:55328
    ds_read_b64_tr_b16 a[106:107], v14 offset:59936
    ds_read_b64_tr_b16 a[28:29], v14 offset:64512
    v_add_u32 v14, 32768, v14
    ds_read_b64_tr_b16 a[30:31], v14 offset:36352
    ds_read_b64_tr_b16 a[108:109], v14 offset:31776
    ds_read_b64_tr_b16 a[110:111], v14 offset:36384
    s_waitcnt lgkmcnt(0)
    s_barrier
    s_mov_b32 s26, s24
    s_add_u32 s28, s67, 655360
stg_227:
    s_min_u32 s27, s26, 35
    s_lshl_b32 s27, s27, 6
    v_add_u32 v10, s27, v1
    s_lshl_b32 s27, s27, 4
    v_mul_u32_u24 v11, 58255, v10
    v_lshrrev_b32 v11, 20, v11
    v_mul_u32_u24 v12, 18, v11
    v_sub_u32 v12, v10, v12
    v_min_u32 v12, 15, v12
    v_mul_u32_u24 v11, 1280, v11
    s_add_u32 m0, s27, 0
    v_lshl_add_u32 v11, v12, 4, v11
    s_add_u32 s26, s26, 8
    buffer_load_dwordx4 v11, s[8:11], s28 offen lds
    s_cmp_lt_u32 s26, 40
    s_nop 0
    s_cbranch_scc1 stg_227
    s_waitcnt vmcnt(5)
    s_barrier
    v_add_u32 v14, 81920, v13
    ds_read_b64_tr_b16 a[32:33], v14 offset:0
    ds_read_b64_tr_b16 a[34:35], v14 offset:4608
    ds_read_b64_tr_b16 a[112:113], v14 offset:32
    ds_read_b64_tr_b16 a[114:115], v14 offset:4640
    ds_read_b64_tr_b16 a[36:37], v14 offset:9216
    ds_read_b64_tr_b16 a[38:39], v14 offset:13824
    ds_read_b64_tr_b16 a[116:117], v14 offset:9248
    ds_read_b64_tr_b16 a[118:119], v14 offset:13856
    ds_read_b64_tr_b16 a[40:41], v14 offset:18432
    ds_read_b64_tr_b16 a[42:43], v14 offset:23040
    ds_read_b64_tr_b16 a[120:121], v14 offset:18464
    ds_read_b64_tr_b16 a[122:123], v14 offset:23072
    ds_read_b64_tr_b16 a[44:45], v14 offset:27648
    ds_read_b64_tr_b16 a[46:47], v14 offset:32256
    ds_read_b64_tr_b16 a[124:125], v14 offset:27680
    ds_read_b64_tr_b16 a[126:127], v14 offset:32288
    ds_read_b64_tr_b16 a[48:49], v14 offset:36864
    ds_read_b64_tr_b16 a[50:51], v14 offset:41472
    ds_read_b64_tr_b16 a[128:129], v14 offset:36896
    ds_read_b64_tr_b16 a[130:131], v14 offset:41504
    ds_read_b64_tr_b16 a[52:53], v14 offset:46080
    ds_read_b64_tr_b16 a[54:55], v14 offset:50688
    ds_read_b64_tr_b16 a[132:133], v14 offset:46112
    ds_read_b64_tr_b16 a[134:135], v14 offset:50720
    ds_read_b64_tr_b16 a[56:57], v14 offset:55296
    ds_read_b64_tr_b16 a[58:59], v14 offset:59904
    ds_read_b64_tr_b16 a[136:137], v14 offset:55328
    ds_read_b64_tr_b16 a[138:139], v14 offset:59936
    ds_read_b64_tr_b16 a[60:61], v14 offset:64512
    v_add_u32 v14, 32768, v14
    ds_read_b64_tr_b16 a[62:63], v14 offset:36352
    ds_read_b64_tr_b16 a[140:141], v14 offset:31776
    ds_read_b64_tr_b16 a[142:143], v14 offset:36384
    s_waitcnt lgkmcnt(0)
    s_barrier
    s_waitcnt vmcnt(0)
    s_barrier
    v_add_u32 v14, 0, v13
    ds_read_b64_tr_b16 a[64:65], v14 offset:0
    ds_read_b64_tr_b16 a[66:67], v14 offset:4608
    ds_read_b64_tr_b16 a[144:145], v14 offset:32
    ds_read_b64_tr_b16 a[146:147], v14 offset:4640
    ds_read_b64_tr_b16 a[68:69], v14 offset:9216
    ds_read_b64_tr_b16 a[70:71], v14 offset:13824
    ds_read_b64_tr_b16 a[148:149], v14 offset:9248
    ds_read_b64_tr_b16 a[150:151], v14 offset:13856
    ds_read_b64_tr_b16 a[72:73], v14 offset:18432
    ds_read_b64_tr_b16 a[74:75], v14 offset:23040
    ds_read_b64_tr_b16 a[152:153], v14 offset:18464
    ds_read_b64_tr_b16 a[154:155], v14 offset:23072
    ds_read_b64_tr_b16 a[76:77], v14 offset:27648
    ds_read_b64_tr_b16 a[78:79], v14 offset:32256
    ds_read_b64_tr_b16 a[156:157], v14 offset:27680
    ds_read_b64_tr_b16 a[158:159], v14 offset:32288
    s_waitcnt lgkmcnt(0)
    s_barrier
    v_min_u32 v3, 39, v1
    v_lshrrev_b32 v4, 3, v3
    v_and_b32 v3, 7, v3
    v_lshlrev_b32 v4, 7, v4
    v_lshl_add_u32 v3, v3, 2, v4
    v_add_u32 v9, 32768, v3
    v_and_b32 v3, 15, v1
    v_lshrrev_b32 v4, 4, v1
    v_mul_u32_u24 v4, 160, v4
    v_add_u32 v4, v4, v3
    s_lshl_b32 s26, s66, 4
    v_add_u32 v4, s26, v4
    v_lshlrev_b32 v10, 3, v4
    v_lshlrev_b32 v61, 3, v3
    s_mov_b32 s69, 0xc0135761
    s_mov_b32 s70, 0xbdd2d3e8
    s_mov_b32 s71, 0
    s_mov_b32 s75, 0
    s_and_b32 s26, s24, 3
    s_lshr_b32 s27, s26, 1
    s_add_u32 s27, s27, 1
    s_sub_u32 s28, 0, s27
    s_bitcmp1_b32 s26, 0
    s_cselect_b32 s74, s27, s28
    s_lshl_b32 s27, s66, 4
    s_add_u32 s74, s74, s27
    v_add_u32 v62, s74, v3
    s_cmp_lg_u32 s24, 0
    s_nop 2
    s_cbranch_scc1 wst_228
    v_and_b32 v5, 3, v1
    v_lshlrev_b32 v5, 6, v5
    s_mov_b32 s100, 0
    s_nop 3
poll_229:
    buffer_load_dword v6, v5, s[16:19], 0 offen sc1
    s_waitcnt vmcnt(0)
    v_cmp_gt_u32 vcc, 32, v6
    s_nop 3
    s_cbranch_vccz polld_230
    s_cmp_lg_u32 s25, 0
    s_cbranch_scc1 polld_230
    s_add_u32 s100, s100, 1
    s_cmp_lt_u32 s100, 400000
    s_sleep 8
    s_cbranch_scc1 poll_229
    s_mov_b32 s25, 1
    s_lshl_b32 s100, s3, 16
    s_lshl_b32 s101, s62, 8
    s_or_b32 s100, s100, s101
    s_or_b32 s100, s100, 1
    v_mov_b32 v3, s100
    v_mov_b32 v4, 36
    buffer_store_dword v3, v4, s[16:19], 0 offen sc1
    s_nop 3
polld_230:
wst_228:
    s_barrier
    s_mul_i32 s62, s87, 45
M2_loop:
    s_add_u32 s72, s62, 1
    s_cmp_ge_u32 s62, 44
    s_cselect_b32 s77, 2, 1
    s_add_u32 s77, s77, s62
    s_cmp_lg_u32 s75, 0
    s_cbranch_scc1 mh_231
    s_cmp_lg_u32 s24, 0
    s_cbranch_scc1 p1_232
    s_min_u32 s30, s62, 62
    s_and_b32 s26, s30, 1
    s_cmp_lt_u32 s30, 44
    s_cselect_b32 s26, 0, s26
    s_lshl_b32 s26, s26, 11
    v_add_u32 v5, s26, v9
    s_add_u32 s30, s30, 1
    s_mov_b32 s100, 0
    s_nop 2
poll_233:
    buffer_load_dword v6, v5, s[4:7], s91 offen sc1
    s_waitcnt vmcnt(0)
    v_cmp_gt_u32 vcc, s30, v6
    s_nop 3
    s_cbranch_vccz polld_234
    s_cmp_lg_u32 s25, 0
    s_cbranch_scc1 polld_234
    s_cmp_ge_u32 s62, 58
    s_cbranch_scc1 lz_235
    s_sleep 24
lz_235:
    s_add_u32 s100, s100, 1
    s_cmp_lt_u32 s100, 400000
    s_sleep 3
    s_cbranch_scc1 poll_233
    s_mov_b32 s25, 1
    s_lshl_b32 s100, s3, 16
    s_lshl_b32 s101, s62, 8
    s_or_b32 s100, s100, s101
    s_or_b32 s100, s100, 26
    v_mov_b32 v3, s100
    v_mov_b32 v4, 40
    buffer_store_dword v3, v4, s[16:19], 0 offen sc1
    s_nop 3
polld_234:
    s_add_u32 s30, s62, 1
    s_min_u32 s30, s30, 63
    s_and_b32 s26, s30, 1
    s_cmp_lt_u32 s30, 44
    s_cselect_b32 s26, 0, s26
    s_lshl_b32 s26, s26, 11
    v_add_u32 v5, s26, v9
    s_add_u32 s30, s30, 1
    s_mov_b32 s100, 0
    s_nop 2
poll_236:
    buffer_load_dword v6, v5, s[4:7], s91 offen sc1
    s_waitcnt vmcnt(0)
    v_cmp_gt_u32 vcc, s30, v6
    s_nop 3
    s_cbranch_vccz polld_237
    s_cmp_lg_u32 s25, 0
    s_cbranch_scc1 polld_237
    s_cmp_ge_u32 s62, 58
    s_cbranch_scc1 lz_238
    s_sleep 24
lz_238:
    s_add_u32 s100, s100, 1
    s_cmp_lt_u32 s100, 400000
    s_sleep 3
    s_cbranch_scc1 poll_236
    s_mov_b32 s25, 1
    s_lshl_b32 s100, s3, 16
    s_lshl_b32 s101, s62, 8
    s_or_b32 s100, s100, s101
    s_or_b32 s100, s100, 26
    v_mov_b32 v3, s100
    v_mov_b32 v4, 40
    buffer_store_dword v3, v4, s[16:19], 0 offen sc1
    s_nop 3
polld_237:
p1_232:
    s_barrier
    s_lshl_b32 s26, s62, 5
    v_add_u32 v3, s26, v62
    v_lshrrev_b32 v4, 4, v3
    v_mul_u32_u24 v4, 20480, v4
    v_and_b32 v5, 15, v3
    v_and_b32 v6, 48, v1
    v_add_u32 v5, v5, v6
    v_lshl_add_u32 v4, v5, 4, v4
    v_mov_b32 v5, 0x7ff00000
    v_cmp_gt_u32 vcc, 2048, v3
    s_nop 1
    v_cndmask_b32 v4, v5, v4, vcc
    s_and_b32 s27, s24, 3
    s_mul_i32 s27, s27, 5120
    s_add_u32 s27, s27, 0xc00000
    s_mul_i32 s26, s24, 5120
    s_add_u32 s26, s26, s71
    s_add_u32 m0, s26, 0
    s_nop 0
    buffer_load_dwordx4 v4, s[4:7], s27 offen offset:0 sc1 lds
    buffer_load_dwordx4 v4, s[4:7], s27 offen offset:1024 sc1 lds
    buffer_load_dwordx4 v4, s[4:7], s27 offen offset:2048 sc1 lds
    buffer_load_dwordx4 v4, s[4:7], s27 offen offset:3072 sc1 lds
    s_add_u32 m0, s26, 4096
    s_add_u32 s27, s27, 4096
    buffer_load_dwordx4 v4, s[4:7], s27 offen offset:0 sc1 lds
    s_mul_i32 s26, s62, 5120
    s_add_u32 s26, s26, 0x1800000
    buffer_load_dwordx2 v[48:49], v10, s[4:7], s26 offen offset:0 sc1
    buffer_load_dwordx2 v[50:51], v10, s[4:7], s26 offen offset:256 sc1
    buffer_load_dwordx2 v[52:53], v10, s[4:7], s26 offen offset:512 sc1
    buffer_load_dwordx2 v[54:55], v10, s[4:7], s26 offen offset:768 sc1
    buffer_load_dwordx2 v[56:57], v10, s[4:7], s26 offen offset:1024 sc1
mh_231:
    s_lshl_b32 s76, s62, 1
    s_add_u32 s76, s76, s66
    s_mul_i32 s76, s76, 20
    s_add_u32 s76, s76, s65
    s_lshl_b32 s76, s76, 10
    s_mul_i32 s26, s66, 20480
    s_add_u32 s26, s26, s71
    v_add_u32 v11, s26, v2
    s_cmp_lg_u32 s24, 0
    s_nop 2
    s_cbranch_scc1 lf_239
    s_min_u32 s30, s77, 62
    s_and_b32 s26, s30, 1
    s_cmp_lt_u32 s30, 44
    s_cselect_b32 s26, 0, s26
    s_lshl_b32 s26, s26, 11
    v_add_u32 v5, s26, v9
    s_add_u32 s30, s30, 1
    s_mov_b32 s31, s30
    buffer_load_dword v7, v5, s[4:7], s91 offen sc1
    s_add_u32 s30, s77, 1
    s_min_u32 s30, s30, 63
    s_and_b32 s26, s30, 1
    s_cmp_lt_u32 s30, 44
    s_cselect_b32 s26, 0, s26
    s_lshl_b32 s26, s26, 11
    v_add_u32 v5, s26, v9
    s_add_u32 s30, s30, 1
    buffer_load_dword v63, v5, s[4:7], s91 offen sc1
    s_waitcnt vmcnt(0)
    v_cmp_gt_u32 vcc, s30, v63
    v_cmp_gt_u32 s[28:29], s31, v7
    s_or_b64 vcc, vcc, s[28:29]
    s_cmp_eq_u64 vcc, 0
    s_cselect_b32 s26, 1, 0
    s_cmp_lt_u32 s77, 64
    s_cselect_b32 s26, s26, 0
    s_lshr_b32 s27, s71, 13
    s_add_u32 s27, s27, 81920
    s_andn2_b32 s27, s27, 3
    v_mov_b32 v3, s27
    v_mov_b32 v4, s26
    ds_write_b32 v3, v4
    s_nop 3
lf_239:
    s_waitcnt vmcnt(0) lgkmcnt(0)
    s_barrier
    s_lshr_b32 s27, s71, 13
    s_add_u32 s27, s27, 81920
    s_andn2_b32 s27, s27, 3
    v_mov_b32 v3, s27
    ds_read_b32 v63, v3
    s_add_u32 s26, s76, 0x900000
    buffer_load_dwordx4 v[72:75], v2, s[4:7], s26 offen sc1
    v_add_f32 v58, v48, v50
    v_add_f32 v58, v58, v52
    v_add_f32 v58, v58, v54
    v_add_f32 v58, v58, v56
    v_mov_b32 v60, v58
    s_nop 1
    v_permlane16_swap_b32 v58, v60
    v_add_f32 v58, v58, v60
    v_mov_b32 v60, v58
    s_nop 1
    v_permlane32_swap_b32 v58, v60
    v_add_f32 v58, v58, v60
    v_mul_f32 v58, 0x3d4ccccd, v58
    v_sub_f32 v48, v48, v58
    v_sub_f32 v50, v50, v58
    v_sub_f32 v52, v52, v58
    v_sub_f32 v54, v54, v58
    v_sub_f32 v56, v56, v58
    v_mul_f32 v59, v48, v48
    v_fmac_f32 v59, v50, v50
    v_fmac_f32 v59, v52, v52
    v_fmac_f32 v59, v54, v54
    v_fmac_f32 v59, v56, v56
    v_mul_f32 v59, 0x42000000, v59
    v_add_f32 v59, v59, v49
    v_add_f32 v59, v59, v51
    v_add_f32 v59, v59, v53
    v_add_f32 v59, v59, v55
    v_add_f32 v59, v59, v57
    v_mov_b32 v60, v59
    s_nop 1
    v_permlane16_swap_b32 v59, v60
    v_add_f32 v59, v59, v60
    v_mov_b32 v60, v59
    s_nop 1
    v_permlane32_swap_b32 v59, v60
    v_add_f32 v59, v59, v60
    v_mul_f32 v59, 0x3acccccd, v59
    s_waitcnt lgkmcnt(0)
    v_readfirstlane_b32 s75, v63
    s_xor_b32 s71, s71, 40960
    s_cmp_eq_u32 s75, 0
    s_nop 1
    s_cbranch_scc1 np_240
    s_lshl_b32 s26, s77, 5
    v_add_u32 v3, s26, v62
    v_lshrrev_b32 v4, 4, v3
    v_mul_u32_u24 v4, 20480, v4
    v_and_b32 v5, 15, v3
    v_and_b32 v6, 48, v1
    v_add_u32 v5, v5, v6
    v_lshl_add_u32 v4, v5, 4, v4
    v_mov_b32 v5, 0x7ff00000
    v_cmp_gt_u32 vcc, 2048, v3
    s_nop 1
    v_cndmask_b32 v4, v5, v4, vcc
    s_and_b32 s27, s24, 3
    s_mul_i32 s27, s27, 5120
    s_add_u32 s27, s27, 0xc00000
    s_mul_i32 s26, s24, 5120
    s_add_u32 s26, s26, s71
    s_add_u32 m0, s26, 0
    s_nop 0
    buffer_load_dwordx4 v4, s[4:7], s27 offen offset:0 sc1 lds
    buffer_load_dwordx4 v4, s[4:7], s27 offen offset:1024 sc1 lds
    buffer_load_dwordx4 v4, s[4:7], s27 offen offset:2048 sc1 lds
    buffer_load_dwordx4 v4, s[4:7], s27 offen offset:3072 sc1 lds
    s_add_u32 m0, s26, 4096
    s_add_u32 s27, s27, 4096
    buffer_load_dwordx4 v4, s[4:7], s27 offen offset:0 sc1 lds
    s_mul_i32 s26, s77, 5120
    s_add_u32 s26, s26, 0x1800000
    buffer_load_dwordx2 v[48:49], v10, s[4:7], s26 offen offset:0 sc1
    buffer_load_dwordx2 v[50:51], v10, s[4:7], s26 offen offset:256 sc1
    buffer_load_dwordx2 v[52:53], v10, s[4:7], s26 offen offset:512 sc1
    buffer_load_dwordx2 v[54:55], v10, s[4:7], s26 offen offset:768 sc1
    buffer_load_dwordx2 v[56:57], v10, s[4:7], s26 offen offset:1024 sc1
np_240:
    ds_read_b128 v[24:27], v11 offset:0
    ds_read_b128 v[28:31], v11 offset:1024
    ds_read_b128 v[32:35], v11 offset:2048
    ds_read_b128 v[36:39], v11 offset:3072
    s_waitcnt lgkmcnt(3)
    v_mfma_f32_16x16x32_bf16 v[12:15], a[0:3], v[24:27], 0
    v_mfma_f32_16x16x32_bf16 v[16:19], a[80:83], v[24:27], 0
    ds_read_b128 v[24:27], v11 offset:4096
    s_waitcnt lgkmcnt(3)
    v_mfma_f32_16x16x32_bf16 v[12:15], a[4:7], v[28:31], v[12:15]
    v_mfma_f32_16x16x32_bf16 v[16:19], a[84:87], v[28:31], v[16:19]
    ds_read_b128 v[28:31], v11 offset:5120
    s_waitcnt lgkmcnt(3)
    v_mfma_f32_16x16x32_bf16 v[12:15], a[8:11], v[32:35], v[12:15]
    v_mfma_f32_16x16x32_bf16 v[16:19], a[88:91], v[32:35], v[16:19]
    ds_read_b128 v[32:35], v11 offset:6144
    s_waitcnt lgkmcnt(3)
    v_mfma_f32_16x16x32_bf16 v[12:15], a[12:15], v[36:39], v[12:15]
    v_mfma_f32_16x16x32_bf16 v[16:19], a[92:95], v[36:39], v[16:19]
    ds_read_b128 v[36:39], v11 offset:7168
    s_waitcnt lgkmcnt(3)
    v_mfma_f32_16x16x32_bf16 v[12:15], a[16:19], v[24:27], v[12:15]
    v_mfma_f32_16x16x32_bf16 v[16:19], a[96:99], v[24:27], v[16:19]
    ds_read_b128 v[24:27], v11 offset:8192
    s_waitcnt lgkmcnt(3)
    v_mfma_f32_16x16x32_bf16 v[12:15], a[20:23], v[28:31], v[12:15]
    v_mfma_f32_16x16x32_bf16 v[16:19], a[100:103], v[28:31], v[16:19]
    ds_read_b128 v[28:31], v11 offset:9216
    s_waitcnt lgkmcnt(3)
    v_mfma_f32_16x16x32_bf16 v[12:15], a[24:27], v[32:35], v[12:15]
    v_mfma_f32_16x16x32_bf16 v[16:19], a[104:107], v[32:35], v[16:19]
    ds_read_b128 v[32:35], v11 offset:10240
    s_waitcnt lgkmcnt(3)
    v_mfma_f32_16x16x32_bf16 v[12:15], a[28:31], v[36:39], v[12:15]
    v_mfma_f32_16x16x32_bf16 v[16:19], a[108:111], v[36:39], v[16:19]
    ds_read_b128 v[36:39], v11 offset:11264
    s_waitcnt lgkmcnt(3)
    v_mfma_f32_16x16x32_bf16 v[12:15], a[32:35], v[24:27], v[12:15]
    v_mfma_f32_16x16x32_bf16 v[16:19], a[112:115], v[24:27], v[16:19]
    ds_read_b128 v[24:27], v11 offset:12288
    s_waitcnt lgkmcnt(3)
    v_mfma_f32_16x16x32_bf16 v[12:15], a[36:39], v[28:31], v[12:15]
    v_mfma_f32_16x16x32_bf16 v[16:19], a[116:119], v[28:31], v[16:19]
    ds_read_b128 v[28:31], v11 offset:13312
    s_waitcnt lgkmcnt(3)
    v_mfma_f32_16x16x32_bf16 v[12:15], a[40:43], v[32:35], v[12:15]
    v_mfma_f32_16x16x32_bf16 v[16:19], a[120:123], v[32:35], v[16:19]
    ds_read_b128 v[32:35], v11 offset:14336
    s_waitcnt lgkmcnt(3)
    v_mfma_f32_16x16x32_bf16 v[12:15], a[44:47], v[36:39], v[12:15]
    v_mfma_f32_16x16x32_bf16 v[16:19], a[124:127], v[36:39], v[16:19]
    ds_read_b128 v[36:39], v11 offset:15360
    s_waitcnt lgkmcnt(3)
    v_mfma_f32_16x16x32_bf16 v[12:15], a[48:51], v[24:27], v[12:15]
    v_mfma_f32_16x16x32_bf16 v[16:19], a[128:131], v[24:27], v[16:19]
    ds_read_b128 v[24:27], v11 offset:16384
    s_waitcnt lgkmcnt(3)
    v_mfma_f32_16x16x32_bf16 v[12:15], a[52:55], v[28:31], v[12:15]
    v_mfma_f32_16x16x32_bf16 v[16:19], a[132:135], v[28:31], v[16:19]
    ds_read_b128 v[28:31], v11 offset:17408
    s_waitcnt lgkmcnt(3)
    v_mfma_f32_16x16x32_bf16 v[12:15], a[56:59], v[32:35], v[12:15]
    v_mfma_f32_16x16x32_bf16 v[16:19], a[136:139], v[32:35], v[16:19]
    ds_read_b128 v[32:35], v11 offset:18432
    s_waitcnt lgkmcnt(3)
    v_mfma_f32_16x16x32_bf16 v[12:15], a[60:63], v[36:39], v[12:15]
    v_mfma_f32_16x16x32_bf16 v[16:19], a[140:143], v[36:39], v[16:19]
    ds_read_b128 v[36:39], v11 offset:19456
    s_waitcnt lgkmcnt(3)
    v_mfma_f32_16x16x32_bf16 v[12:15], a[64:67], v[24:27], v[12:15]
    v_mfma_f32_16x16x32_bf16 v[16:19], a[144:147], v[24:27], v[16:19]
    s_waitcnt lgkmcnt(2)
    v_mfma_f32_16x16x32_bf16 v[12:15], a[68:71], v[28:31], v[12:15]
    v_mfma_f32_16x16x32_bf16 v[16:19], a[148:151], v[28:31], v[16:19]
    s_waitcnt lgkmcnt(1)
    v_mfma_f32_16x16x32_bf16 v[12:15], a[72:75], v[32:35], v[12:15]
    v_mfma_f32_16x16x32_bf16 v[16:19], a[152:155], v[32:35], v[16:19]
    s_waitcnt lgkmcnt(0)
    v_mfma_f32_16x16x32_bf16 v[12:15], a[76:79], v[36:39], v[12:15]
    v_mfma_f32_16x16x32_bf16 v[16:19], a[156:159], v[36:39], v[16:19]
    s_waitcnt vmcnt(0)
    v_add_f32 v60, 0x3727c5ac, v59
    v_rsq_f32 v60, v60
    v_lshlrev_b32 v24, 16, v72
    v_and_b32 v25, 0xffff0000, v72
    v_lshlrev_b32 v26, 16, v73
    v_and_b32 v27, 0xffff0000, v73
    v_lshlrev_b32 v28, 16, v74
    v_and_b32 v29, 0xffff0000, v74
    v_lshlrev_b32 v30, 16, v75
    v_and_b32 v31, 0xffff0000, v75
    v_sub_f32 v24, v24, v58
    v_sub_f32 v25, v25, v58
    v_sub_f32 v26, v26, v58
    v_sub_f32 v27, v27, v58
    v_sub_f32 v28, v28, v58
    v_sub_f32 v29, v29, v58
    v_sub_f32 v30, v30, v58
    v_sub_f32 v31, v31, v58
    v_fmac_f32 v12, v24, v60
    v_fmac_f32 v13, v25, v60
    v_fmac_f32 v14, v26, v60
    v_fmac_f32 v15, v27, v60
    v_fmac_f32 v16, v28, v60
    v_fmac_f32 v17, v29, v60
    v_fmac_f32 v18, v30, v60
    v_fmac_f32 v19, v31, v60
    v_cvt_pk_bf16_f32 v20, v12, v13
    v_cvt_pk_bf16_f32 v21, v14, v15
    v_cvt_pk_bf16_f32 v22, v16, v17
    v_cvt_pk_bf16_f32 v23, v18, v19
    s_add_u32 s26, s76, 0xf00000
    buffer_store_dwordx4 v[20:23], v2, s[4:7], s26 offen sc1
    v_lshlrev_b32 v24, 16, v20
    v_and_b32 v25, 0xffff0000, v20
    v_lshlrev_b32 v26, 16, v21
    v_and_b32 v27, 0xffff0000, v21
    v_lshlrev_b32 v28, 16, v22
    v_and_b32 v29, 0xffff0000, v22
    v_lshlrev_b32 v30, 16, v23
    v_and_b32 v31, 0xffff0000, v23
    v_add_f32 v32, v24, v25
    v_add_f32 v32, v32, v26
    v_add_f32 v32, v32, v27
    v_add_f32 v32, v32, v28
    v_add_f32 v32, v32, v29
    v_add_f32 v32, v32, v30
    v_add_f32 v32, v32, v31
    v_mov_b32 v60, v32
    s_nop 1
    v_permlane16_swap_b32 v32, v60
    v_add_f32 v32, v32, v60
    v_mov_b32 v60, v32
    s_nop 1
    v_permlane32_swap_b32 v32, v60
    v_add_f32 v32, v32, v60
    v_mul_f32 v32, 0x3d000000, v32
    v_sub_f32 v24, v24, v32
    v_sub_f32 v25, v25, v32
    v_sub_f32 v26, v26, v32
    v_sub_f32 v27, v27, v32
    v_sub_f32 v28, v28, v32
    v_sub_f32 v29, v29, v32
    v_sub_f32 v30, v30, v32
    v_sub_f32 v31, v31, v32
    v_mul_f32 v33, v24, v24
    v_fmac_f32 v33, v25, v25
    v_fmac_f32 v33, v26, v26
    v_fmac_f32 v33, v27, v27
    v_fmac_f32 v33, v28, v28
    v_fmac_f32 v33, v29, v29
    v_fmac_f32 v33, v30, v30
    v_fmac_f32 v33, v31, v31
    v_mov_b32 v60, v33
    s_nop 1
    v_permlane16_swap_b32 v33, v60
    v_add_f32 v33, v33, v60
    v_mov_b32 v60, v33
    s_nop 1
    v_permlane32_swap_b32 v33, v60
    v_add_f32 v33, v33, v60
    s_mul_i32 s27, s62, 20
    s_add_u32 s27, s27, s65
    s_lshl_b32 s27, s27, 8
    s_lshl_b32 s28, s66, 7
    s_add_u32 s27, s27, s28
    s_add_u32 s27, s27, 0x1900000
    s_mov_b64 exec, 0xffff
    buffer_store_dwordx2 v[32:33], v61, s[4:7], s27 offen sc1
    s_mov_b64 exec, -1
    s_waitcnt vmcnt(0)
    v_mov_b32 v3, s72
    v_mov_b32 v4, s91
    s_mov_b64 exec, 1
    buffer_store_dword v3, v4, s[4:7], s68 offen sc1
    s_mov_b64 exec, -1
    s_mov_b32 s62, s77
    s_cmp_lt_u32 s62, 64
    s_cbranch_scc1 M2_loop
    s_endpgm
R_M3:
    s_and_b32 s26, s24, 3
    s_lshl_b32 s65, s63, 2
    s_add_u32 s65, s65, s26
    s_lshr_b32 s66, s24, 2
    s_lshl_b32 s68, s63, 5
    s_add_u32 s68, s68, s24
    s_lshl_b32 s68, s68, 2
    s_add_u32 s68, s68, 49152
    s_lshl_b32 s27, s87, 11
    s_add_u32 s68, s68, s27
    s_cmp_lg_u32 s24, 0
    s_cbranch_scc1 wst_241
    v_and_b32 v5, 3, v1
    v_lshlrev_b32 v5, 6, v5
    s_mov_b32 s100, 0
    s_nop 3
poll_242:
    buffer_load_dword v6, v5, s[16:19], 0 offen sc1
    s_waitcnt vmcnt(0)
    v_cmp_gt_u32 vcc, 32, v6
    s_nop 3
    s_cbranch_vccz polld_243
    s_cmp_lg_u32 s25, 0
    s_cbranch_scc1 polld_243
    s_add_u32 s100, s100, 1
    s_cmp_lt_u32 s100, 400000
    s_sleep 8
    s_cbranch_scc1 poll_242
    s_mov_b32 s25, 1
    s_lshl_b32 s100, s3, 16
    s_lshl_b32 s101, s62, 8
    s_or_b32 s100, s100, s101
    s_or_b32 s100, s100, 1
    v_mov_b32 v3, s100
    v_mov_b32 v4, 36
    buffer_store_dword v3, v4, s[16:19], 0 offen sc1
    s_nop 3
polld_243:
wst_241:
    s_barrier
    v_mov_b32 v5, 8
    s_mov_b32 s100, 0
    s_nop 3
poll_244:
    buffer_load_dword v6, v5, s[16:19], 0 offen sc1
    s_waitcnt vmcnt(0)
    v_cmp_gt_u32 vcc, 64, v6
    s_nop 3
    s_cbranch_vccz polld_245
    s_cmp_lg_u32 s25, 0
    s_cbranch_scc1 polld_245
    s_add_u32 s100, s100, 1
    s_cmp_lt_u32 s100, 400000
    s_sleep 8
    s_cbranch_scc1 poll_244
    s_mov_b32 s25, 1
    s_lshl_b32 s100, s3, 16
    s_lshl_b32 s101, s62, 8
    s_or_b32 s100, s100, s101
    s_or_b32 s100, s100, 2
    v_mov_b32 v3, s100
    v_mov_b32 v4, 40
    buffer_store_dword v3, v4, s[16:19], 0 offen sc1
    s_nop 3
polld_245:
    v_readfirstlane_b32 s26, v6
    s_and_b32 s88, s26, 1
    s_xor_b32 s89, s88, 1
    s_lshl_b32 s89, s89, 13
    s_xor_b32 s91, s89, 8192
    s_mov_b32 s90, 0
    s_cmp_lg_u32 s24, 0
    s_cbranch_scc1 du_246
    v_mov_b32 v5, 0
    s_mov_b32 s100, 0
    s_nop 3
poll_247:
    buffer_load_dword v6, v5, s[4:7], s91 offen sc1
    s_waitcnt vmcnt(0)
    v_cmp_gt_u32 vcc, 1, v6
    s_nop 3
    s_cbranch_vccz polld_248
    s_cmp_lg_u32 s25, 0
    s_cbranch_scc1 polld_248
    s_add_u32 s100, s100, 1
    s_cmp_lt_u32 s100, 400000
    s_sleep 20
    s_cbranch_scc1 poll_247
    s_mov_b32 s25, 1
    s_lshl_b32 s100, s3, 16
    s_lshl_b32 s101, s62, 8
    s_or_b32 s100, s100, s101
    s_or_b32 s100, s100, 5
    v_mov_b32 v3, s100
    v_mov_b32 v4, 52
    buffer_store_dword v3, v4, s[16:19], 0 offen sc1
    s_nop 3
polld_248:
du_246:
    s_barrier
    s_and_b32 s26, s24, 3
    s_mov_b32 s8, s52
    s_and_b32 s9, s53, 0xffff
    s_mov_b32 s10, 0x1e0000
    s_mov_b32 s11, 0x20000
    s_lshl_b32 s67, s63, 8
    s_lshl_b32 s29, s26, 6
    v_lshrrev_b32 v3, 2, v1
    v_mul_u32_u24 v3, 288, v3
    v_and_b32 v4, 3, v1
    v_lshl_add_u32 v3, v4, 3, v3
    v_add_u32 v13, s29, v3
    s_mov_b32 s26, s24
    s_add_u32 s28, s67, 0
    s_nop 2
stg_249:
    s_min_u32 s27, s26, 71
    s_lshl_b32 s27, s27, 6
    v_add_u32 v10, s27, v1
    s_lshl_b32 s27, s27, 4
    v_mul_u32_u24 v11, 58255, v10
    v_lshrrev_b32 v11, 20, v11
    v_mul_u32_u24 v12, 18, v11
    v_sub_u32 v12, v10, v12
    v_min_u32 v12, 15, v12
    v_mul_u32_u24 v11, 3072, v11
    s_add_u32 m0, s27, 0
    v_lshl_add_u32 v11, v12, 4, v11
    s_add_u32 s26, s26, 8
    buffer_load_dwordx4 v11, s[8:11], s28 offen lds
    s_cmp_lt_u32 s26, 72
    s_nop 0
    s_cbranch_scc1 stg_249
    s_mov_b32 s26, s24
    s_add_u32 s28, s67, 786432
stg_250:
    s_min_u32 s27, s26, 71
    s_lshl_b32 s27, s27, 6
    v_add_u32 v10, s27, v1
    s_lshl_b32 s27, s27, 4
    v_mul_u32_u24 v11, 58255, v10
    v_lshrrev_b32 v11, 20, v11
    v_mul_u32_u24 v12, 18, v11
    v_sub_u32 v12, v10, v12
    v_min_u32 v12, 15, v12
    v_mul_u32_u24 v11, 3072, v11
    s_add_u32 m0, s27, 81920
    v_lshl_add_u32 v11, v12, 4, v11
    s_add_u32 s26, s26, 8
    buffer_load_dwordx4 v11, s[8:11], s28 offen lds
    s_cmp_lt_u32 s26, 72
    s_nop 0
    s_cbranch_scc1 stg_250
    s_waitcnt vmcnt(9)
    s_barrier
    v_add_u32 v14, 0, v13
    ds_read_b64_tr_b16 a[0:1], v14 offset:0
    ds_read_b64_tr_b16 a[2:3], v14 offset:4608
    ds_read_b64_tr_b16 a[80:81], v14 offset:32
    ds_read_b64_tr_b16 a[82:83], v14 offset:4640
    ds_read_b64_tr_b16 a[4:5], v14 offset:9216
    ds_read_b64_tr_b16 a[6:7], v14 offset:13824
    ds_read_b64_tr_b16 a[84:85], v14 offset:9248
    ds_read_b64_tr_b16 a[86:87], v14 offset:13856
    ds_read_b64_tr_b16 a[8:9], v14 offset:18432
    ds_read_b64_tr_b16 a[10:11], v14 offset:23040
    ds_read_b64_tr_b16 a[88:89], v14 offset:18464
    ds_read_b64_tr_b16 a[90:91], v14 offset:23072
    ds_read_b64_tr_b16 a[12:13], v14 offset:27648
    ds_read_b64_tr_b16 a[14:15], v14 offset:32256
    ds_read_b64_tr_b16 a[92:93], v14 offset:27680
    ds_read_b64_tr_b16 a[94:95], v14 offset:32288
    ds_read_b64_tr_b16 a[16:17], v14 offset:36864
    ds_read_b64_tr_b16 a[18:19], v14 offset:41472
    ds_read_b64_tr_b16 a[96:97], v14 offset:36896
    ds_read_b64_tr_b16 a[98:99], v14 offset:41504
    ds_read_b64_tr_b16 a[20:21], v14 offset:46080
    ds_read_b64_tr_b16 a[22:23], v14 offset:50688
    ds_read_b64_tr_b16 a[100:101], v14 offset:46112
    ds_read_b64_tr_b16 a[102:103], v14 offset:50720
    ds_read_b64_tr_b16 a[24:25], v14 offset:55296
    ds_read_b64_tr_b16 a[26:27], v14 offset:59904
    ds_read_b64_tr_b16 a[104:105], v14 offset:55328
    ds_read_b64_tr_b16 a[106:107], v14 offset:59936
    ds_read_b64_tr_b16 a[28:29], v14 offset:64512
    v_add_u32 v14, 32768, v14
    ds_read_b64_tr_b16 a[30:31], v14 offset:36352
    ds_read_b64_tr_b16 a[108:109], v14 offset:31776
    ds_read_b64_tr_b16 a[110:111], v14 offset:36384
    s_waitcnt lgkmcnt(0)
    s_barrier
    s_mov_b32 s26, s24
    s_add_u32 s28, s67, 1572864
stg_251:
    s_min_u32 s27, s26, 35
    s_lshl_b32 s27, s27, 6
    v_add_u32 v10, s27, v1
    s_lshl_b32 s27, s27, 4
    v_mul_u32_u24 v11, 58255, v10
    v_lshrrev_b32 v11, 20, v11
    v_mul_u32_u24 v12, 18, v11
    v_sub_u32 v12, v10, v12
    v_min_u32 v12, 15, v12
    v_mul_u32_u24 v11, 3072, v11
    s_add_u32 m0, s27, 0
    v_lshl_add_u32 v11, v12, 4, v11
    s_add_u32 s26, s26, 8
    buffer_load_dwordx4 v11, s[8:11], s28 offen lds
    s_cmp_lt_u32 s26, 40
    s_nop 0
    s_cbranch_scc1 stg_251
    s_waitcnt vmcnt(5)
    s_barrier
    v_add_u32 v14, 81920, v13
    ds_read_b64_tr_b16 a[32:33], v14 offset:0
    ds_read_b64_tr_b16 a[34:35], v14 offset:4608
    ds_read_b64_tr_b16 a[112:113], v14 offset:32
    ds_read_b64_tr_b16 a[114:115], v14 offset:4640
    ds_read_b64_tr_b16 a[36:37], v14 offset:9216
    ds_read_b64_tr_b16 a[38:39], v14 offset:13824
    ds_read_b64_tr_b16 a[116:117], v14 offset:9248
    ds_read_b64_tr_b16 a[118:119], v14 offset:13856
    ds_read_b64_tr_b16 a[40:41], v14 offset:18432
    ds_read_b64_tr_b16 a[42:43], v14 offset:23040
    ds_read_b64_tr_b16 a[120:121], v14 offset:18464
    ds_read_b64_tr_b16 a[122:123], v14 offset:23072
    ds_read_b64_tr_b16 a[44:45], v14 offset:27648
    ds_read_b64_tr_b16 a[46:47], v14 offset:32256
    ds_read_b64_tr_b16 a[124:125], v14 offset:27680
    ds_read_b64_tr_b16 a[126:127], v14 offset:32288
    ds_read_b64_tr_b16 a[48:49], v14 offset:36864
    ds_read_b64_tr_b16 a[50:51], v14 offset:41472
    ds_read_b64_tr_b16 a[128:129], v14 offset:36896
    ds_read_b64_tr_b16 a[130:131], v14 offset:41504
    ds_read_b64_tr_b16 a[52:53], v14 offset:46080
    ds_read_b64_tr_b16 a[54:55], v14 offset:50688
    ds_read_b64_tr_b16 a[132:133], v14 offset:46112
    ds_read_b64_tr_b16 a[134:135], v14 offset:50720
    ds_read_b64_tr_b16 a[56:57], v14 offset:55296
    ds_read_b64_tr_b16 a[58:59], v14 offset:59904
    ds_read_b64_tr_b16 a[136:137], v14 offset:55328
    ds_read_b64_tr_b16 a[138:139], v14 offset:59936
    ds_read_b64_tr_b16 a[60:61], v14 offset:64512
    v_add_u32 v14, 32768, v14
    ds_read_b64_tr_b16 a[62:63], v14 offset:36352
    ds_read_b64_tr_b16 a[140:141], v14 offset:31776
    ds_read_b64_tr_b16 a[142:143], v14 offset:36384
    s_waitcnt lgkmcnt(0)
    s_barrier
    s_waitcnt vmcnt(0)
    s_barrier
    v_add_u32 v14, 0, v13
    ds_read_b64_tr_b16 a[64:65], v14 offset:0
    ds_read_b64_tr_b16 a[66:67], v14 offset:4608
    ds_read_b64_tr_b16 a[144:145], v14 offset:32
    ds_read_b64_tr_b16 a[146:147], v14 offset:4640
    ds_read_b64_tr_b16 a[68:69], v14 offset:9216
    ds_read_b64_tr_b16 a[70:71], v14 offset:13824
    ds_read_b64_tr_b16 a[148:149], v14 offset:9248
    ds_read_b64_tr_b16 a[150:151], v14 offset:13856
    ds_read_b64_tr_b16 a[72:73], v14 offset:18432
    ds_read_b64_tr_b16 a[74:75], v14 offset:23040
    ds_read_b64_tr_b16 a[152:153], v14 offset:18464
    ds_read_b64_tr_b16 a[154:155], v14 offset:23072
    ds_read_b64_tr_b16 a[76:77], v14 offset:27648
    ds_read_b64_tr_b16 a[78:79], v14 offset:32256
    ds_read_b64_tr_b16 a[156:157], v14 offset:27680
    ds_read_b64_tr_b16 a[158:159], v14 offset:32288
    s_waitcnt lgkmcnt(0)
    s_barrier
    v_mov_b32 v24, 0x3f803f80
    v_mov_b32 v25, 0x3f803f80
    v_mov_b32 v26, 0x3f803f80
    v_mov_b32 v27, 0x3f803f80
    s_nop 1
    v_mfma_f32_16x16x32_bf16 v[40:43], a[0:3], v[24:27], 0
    v_mfma_f32_16x16x32_bf16 v[44:47], a[80:83], v[24:27], 0
    v_mfma_f32_16x16x32_bf16 v[40:43], a[4:7], v[24:27], v[40:43]
    v_mfma_f32_16x16x32_bf16 v[44:47], a[84:87], v[24:27], v[44:47]
    v_mfma_f32_16x16x32_bf16 v[40:43], a[8:11], v[24:27], v[40:43]
    v_mfma_f32_16x16x32_bf16 v[44:47], a[88:91], v[24:27], v[44:47]
    v_mfma_f32_16x16x32_bf16 v[40:43], a[12:15], v[24:27], v[40:43]
    v_mfma_f32_16x16x32_bf16 v[44:47], a[92:95], v[24:27], v[44:47]
    v_mfma_f32_16x16x32_bf16 v[40:43], a[16:19], v[24:27], v[40:43]
    v_mfma_f32_16x16x32_bf16 v[44:47], a[96:99], v[24:27], v[44:47]
    v_mfma_f32_16x16x32_bf16 v[40:43], a[20:23], v[24:27], v[40:43]
    v_mfma_f32_16x16x32_bf16 v[44:47], a[100:103], v[24:27], v[44:47]
    v_mfma_f32_16x16x32_bf16 v[40:43], a[24:27], v[24:27], v[40:43]
    v_mfma_f32_16x16x32_bf16 v[44:47], a[104:107], v[24:27], v[44:47]
    v_mfma_f32_16x16x32_bf16 v[40:43], a[28:31], v[24:27], v[40:43]
    v_mfma_f32_16x16x32_bf16 v[44:47], a[108:111], v[24:27], v[44:47]
    v_mfma_f32_16x16x32_bf16 v[40:43], a[32:35], v[24:27], v[40:43]
    v_mfma_f32_16x16x32_bf16 v[44:47], a[112:115], v[24:27], v[44:47]
    v_mfma_f32_16x16x32_bf16 v[40:43], a[36:39], v[24:27], v[40:43]
    v_mfma_f32_16x16x32_bf16 v[44:47], a[116:119], v[24:27], v[44:47]
    v_mfma_f32_16x16x32_bf16 v[40:43], a[40:43], v[24:27], v[40:43]
    v_mfma_f32_16x16x32_bf16 v[44:47], a[120:123], v[24:27], v[44:47]
    v_mfma_f32_16x16x32_bf16 v[40:43], a[44:47], v[24:27], v[40:43]
    v_mfma_f32_16x16x32_bf16 v[44:47], a[124:127], v[24:27], v[44:47]
    v_mfma_f32_16x16x32_bf16 v[40:43], a[48:51], v[24:27], v[40:43]
    v_mfma_f32_16x16x32_bf16 v[44:47], a[128:131], v[24:27], v[44:47]
    v_mfma_f32_16x16x32_bf16 v[40:43], a[52:55], v[24:27], v[40:43]
    v_mfma_f32_16x16x32_bf16 v[44:47], a[132:135], v[24:27], v[44:47]
    v_mfma_f32_16x16x32_bf16 v[40:43], a[56:59], v[24:27], v[40:43]
    v_mfma_f32_16x16x32_bf16 v[44:47], a[136:139], v[24:27], v[44:47]
    v_mfma_f32_16x16x32_bf16 v[40:43], a[60:63], v[24:27], v[40:43]
    v_mfma_f32_16x16x32_bf16 v[44:47], a[140:143], v[24:27], v[44:47]
    v_mfma_f32_16x16x32_bf16 v[40:43], a[64:67], v[24:27], v[40:43]
    v_mfma_f32_16x16x32_bf16 v[44:47], a[144:147], v[24:27], v[44:47]
    v_mfma_f32_16x16x32_bf16 v[40:43], a[68:71], v[24:27], v[40:43]
    v_mfma_f32_16x16x32_bf16 v[44:47], a[148:151], v[24:27], v[44:47]
    v_mfma_f32_16x16x32_bf16 v[40:43], a[72:75], v[24:27], v[40:43]
    v_mfma_f32_16x16x32_bf16 v[44:47], a[152:155], v[24:27], v[44:47]
    v_mfma_f32_16x16x32_bf16 v[40:43], a[76:79], v[24:27], v[40:43]
    v_mfma_f32_16x16x32_bf16 v[44:47], a[156:159], v[24:27], v[44:47]
    v_min_u32 v3, 39, v1
    v_lshrrev_b32 v4, 3, v3
    v_and_b32 v3, 7, v3
    v_lshlrev_b32 v4, 7, v4
    v_lshl_add_u32 v3, v3, 2, v4
    v_add_u32 v9, 36864, v3
    v_and_b32 v3, 15, v1
    v_lshrrev_b32 v4, 4, v1
    v_mul_u32_u24 v4, 160, v4
    v_add_u32 v4, v4, v3
    s_lshl_b32 s26, s66, 4
    v_add_u32 v4, s26, v4
    v_lshlrev_b32 v10, 3, v4
    v_lshlrev_b32 v61, 3, v3
    s_mov_b32 s69, 0xc0135761
    s_mov_b32 s70, 0xbdd2d3e8
    s_mov_b32 s71, 0
    s_mov_b32 s75, 0
    s_cmp_lg_u32 s24, 0
    s_cbranch_scc1 wst_252
    v_and_b32 v5, 3, v1
    v_lshlrev_b32 v5, 6, v5
    s_mov_b32 s100, 0
    s_nop 3
poll_253:
    buffer_load_dword v6, v5, s[16:19], 0 offen sc1
    s_waitcnt vmcnt(0)
    v_cmp_gt_u32 vcc, 32, v6
    s_nop 3
    s_cbranch_vccz polld_254
    s_cmp_lg_u32 s25, 0
    s_cbranch_scc1 polld_254
    s_add_u32 s100, s100, 1
    s_cmp_lt_u32 s100, 400000
    s_sleep 8
    s_cbranch_scc1 poll_253
    s_mov_b32 s25, 1
    s_lshl_b32 s100, s3, 16
    s_lshl_b32 s101, s62, 8
    s_or_b32 s100, s100, s101
    s_or_b32 s100, s100, 1
    v_mov_b32 v3, s100
    v_mov_b32 v4, 36
    buffer_store_dword v3, v4, s[16:19], 0 offen sc1
    s_nop 3
polld_254:
wst_252:
    s_barrier
    s_mul_i32 s62, s87, 45
M3_loop:
    s_add_u32 s72, s62, 1
    s_cmp_ge_u32 s62, 44
    s_cselect_b32 s77, 2, 1
    s_add_u32 s77, s77, s62
    s_cmp_lg_u32 s75, 0
    s_cbranch_scc1 mh_255
    s_cmp_lg_u32 s24, 0
    s_cbranch_scc1 p1_256
    s_mov_b32 s30, s62
    s_and_b32 s26, s30, 1
    s_cmp_lt_u32 s30, 44
    s_cselect_b32 s26, 0, s26
    s_lshl_b32 s26, s26, 11
    v_add_u32 v5, s26, v9
    s_add_u32 s30, s30, 1
    s_mov_b32 s100, 0
    s_nop 2
poll_257:
    buffer_load_dword v6, v5, s[4:7], s91 offen sc1
    s_waitcnt vmcnt(0)
    v_cmp_gt_u32 vcc, s30, v6
    s_nop 3
    s_cbranch_vccz polld_258
    s_cmp_lg_u32 s25, 0
    s_cbranch_scc1 polld_258
    s_cmp_ge_u32 s62, 58
    s_cbranch_scc1 lz_259
    s_sleep 24
lz_259:
    s_add_u32 s100, s100, 1
    s_cmp_lt_u32 s100, 400000
    s_sleep 3
    s_cbranch_scc1 poll_257
    s_mov_b32 s25, 1
    s_lshl_b32 s100, s3, 16
    s_lshl_b32 s101, s62, 8
    s_or_b32 s100, s100, s101
    s_or_b32 s100, s100, 27
    v_mov_b32 v3, s100
    v_mov_b32 v4, 44
    buffer_store_dword v3, v4, s[16:19], 0 offen sc1
    s_nop 3
polld_258:
p1_256:
    s_barrier
    s_mul_i32 s73, s62, 40960
    s_add_u32 s73, s73, 0xf00000
    s_mul_i32 s26, s24, 5120
    s_add_u32 s27, s26, s73
    s_add_u32 s26, s26, s71
    s_add_u32 m0, s26, 0
    s_nop 0
    buffer_load_dwordx4 v2, s[4:7], s27 offen offset:0 sc1 lds
    buffer_load_dwordx4 v2, s[4:7], s27 offen offset:1024 sc1 lds
    buffer_load_dwordx4 v2, s[4:7], s27 offen offset:2048 sc1 lds
    buffer_load_dwordx4 v2, s[4:7], s27 offen offset:3072 sc1 lds
    s_add_u32 m0, s26, 4096
    s_add_u32 s27, s27, 4096
    buffer_load_dwordx4 v2, s[4:7], s27 offen offset:0 sc1 lds
    s_mul_i32 s26, s62, 5120
    s_add_u32 s26, s26, 0x1900000
    buffer_load_dwordx2 v[48:49], v10, s[4:7], s26 offen offset:0 sc1
    buffer_load_dwordx2 v[50:51], v10, s[4:7], s26 offen offset:256 sc1
    buffer_load_dwordx2 v[52:53], v10, s[4:7], s26 offen offset:512 sc1
    buffer_load_dwordx2 v[54:55], v10, s[4:7], s26 offen offset:768 sc1
    buffer_load_dwordx2 v[56:57], v10, s[4:7], s26 offen offset:1024 sc1
mh_255:
    s_lshl_b32 s76, s62, 1
    s_add_u32 s76, s76, s66
    s_mul_i32 s76, s76, 48
    s_add_u32 s76, s76, s65
    s_lshl_b32 s76, s76, 10
    s_mul_i32 s26, s66, 20480
    s_add_u32 s26, s26, s71
    v_add_u32 v11, s26, v2
    s_cmp_lg_u32 s24, 0
    s_nop 2
    s_cbranch_scc1 lf_260
    s_mov_b32 s30, s77
    s_and_b32 s26, s30, 1
    s_cmp_lt_u32 s30, 44
    s_cselect_b32 s26, 0, s26
    s_lshl_b32 s26, s26, 11
    v_add_u32 v5, s26, v9
    s_add_u32 s30, s30, 1
    buffer_load_dword v63, v5, s[4:7], s91 offen sc1
    s_waitcnt vmcnt(0)
    v_cmp_gt_u32 vcc, s30, v63
    s_cmp_eq_u64 vcc, 0
    s_cselect_b32 s26, 1, 0
    s_cmp_lt_u32 s77, 64
    s_cselect_b32 s26, s26, 0
    s_lshr_b32 s27, s71, 13
    s_add_u32 s27, s27, 81920
    s_andn2_b32 s27, s27, 3
    v_mov_b32 v3, s27
    v_mov_b32 v4, s26
    ds_write_b32 v3, v4
    s_nop 3
lf_260:
    s_waitcnt vmcnt(0) lgkmcnt(0)
    s_barrier
    s_lshr_b32 s27, s71, 13
    s_add_u32 s27, s27, 81920
    s_andn2_b32 s27, s27, 3
    v_mov_b32 v3, s27
    ds_read_b32 v63, v3
    v_add_f32 v58, v48, v50
    v_add_f32 v58, v58, v52
    v_add_f32 v58, v58, v54
    v_add_f32 v58, v58, v56
    v_mov_b32 v60, v58
    s_nop 1
    v_permlane16_swap_b32 v58, v60
    v_add_f32 v58, v58, v60
    v_mov_b32 v60, v58
    s_nop 1
    v_permlane32_swap_b32 v58, v60
    v_add_f32 v58, v58, v60
    v_mul_f32 v58, 0x3d4ccccd, v58
    v_sub_f32 v48, v48, v58
    v_sub_f32 v50, v50, v58
    v_sub_f32 v52, v52, v58
    v_sub_f32 v54, v54, v58
    v_sub_f32 v56, v56, v58
    v_mul_f32 v59, v48, v48
    v_fmac_f32 v59, v50, v50
    v_fmac_f32 v59, v52, v52
    v_fmac_f32 v59, v54, v54
    v_fmac_f32 v59, v56, v56
    v_mul_f32 v59, 0x42000000, v59
    v_add_f32 v59, v59, v49
    v_add_f32 v59, v59, v51
    v_add_f32 v59, v59, v53
    v_add_f32 v59, v59, v55
    v_add_f32 v59, v59, v57
    v_mov_b32 v60, v59
    s_nop 1
    v_permlane16_swap_b32 v59, v60
    v_add_f32 v59, v59, v60
    v_mov_b32 v60, v59
    s_nop 1
    v_permlane32_swap_b32 v59, v60
    v_add_f32 v59, v59, v60
    v_mul_f32 v59, 0x3acccccd, v59
    s_waitcnt lgkmcnt(0)
    v_readfirstlane_b32 s75, v63
    s_xor_b32 s71, s71, 40960
    s_cmp_eq_u32 s75, 0
    s_nop 1
    s_cbranch_scc1 np_261
    s_mul_i32 s73, s77, 40960
    s_add_u32 s73, s73, 0xf00000
    s_mul_i32 s26, s24, 5120
    s_add_u32 s27, s26, s73
    s_add_u32 s26, s26, s71
    s_add_u32 m0, s26, 0
    s_nop 0
    buffer_load_dwordx4 v2, s[4:7], s27 offen offset:0 sc1 lds
    buffer_load_dwordx4 v2, s[4:7], s27 offen offset:1024 sc1 lds
    buffer_load_dwordx4 v2, s[4:7], s27 offen offset:2048 sc1 lds
    buffer_load_dwordx4 v2, s[4:7], s27 offen offset:3072 sc1 lds
    s_add_u32 m0, s26, 4096
    s_add_u32 s27, s27, 4096
    buffer_load_dwordx4 v2, s[4:7], s27 offen offset:0 sc1 lds
    s_mul_i32 s26, s77, 5120
    s_add_u32 s26, s26, 0x1900000
    buffer_load_dwordx2 v[48:49], v10, s[4:7], s26 offen offset:0 sc1
    buffer_load_dwordx2 v[50:51], v10, s[4:7], s26 offen offset:256 sc1
    buffer_load_dwordx2 v[52:53], v10, s[4:7], s26 offen offset:512 sc1
    buffer_load_dwordx2 v[54:55], v10, s[4:7], s26 offen offset:768 sc1
    buffer_load_dwordx2 v[56:57], v10, s[4:7], s26 offen offset:1024 sc1
np_261:
    ds_read_b128 v[24:27], v11 offset:0
    ds_read_b128 v[28:31], v11 offset:1024
    ds_read_b128 v[32:35], v11 offset:2048
    ds_read_b128 v[36:39], v11 offset:3072
    s_waitcnt lgkmcnt(3)
    v_mfma_f32_16x16x32_bf16 v[12:15], a[0:3], v[24:27], 0
    v_mfma_f32_16x16x32_bf16 v[16:19], a[80:83], v[24:27], 0
    ds_read_b128 v[24:27], v11 offset:4096
    s_waitcnt lgkmcnt(3)
    v_mfma_f32_16x16x32_bf16 v[12:15], a[4:7], v[28:31], v[12:15]
    v_mfma_f32_16x16x32_bf16 v[16:19], a[84:87], v[28:31], v[16:19]
    ds_read_b128 v[28:31], v11 offset:5120
    s_waitcnt lgkmcnt(3)
    v_mfma_f32_16x16x32_bf16 v[12:15], a[8:11], v[32:35], v[12:15]
    v_mfma_f32_16x16x32_bf16 v[16:19], a[88:91], v[32:35], v[16:19]
    ds_read_b128 v[32:35], v11 offset:6144
    s_waitcnt lgkmcnt(3)
    v_mfma_f32_16x16x32_bf16 v[12:15], a[12:15], v[36:39], v[12:15]
    v_mfma_f32_16x16x32_bf16 v[16:19], a[92:95], v[36:39], v[16:19]
    ds_read_b128 v[36:39], v11 offset:7168
    s_waitcnt lgkmcnt(3)
    v_mfma_f32_16x16x32_bf16 v[12:15], a[16:19], v[24:27], v[12:15]
    v_mfma_f32_16x16x32_bf16 v[16:19], a[96:99], v[24:27], v[16:19]
    ds_read_b128 v[24:27], v11 offset:8192
    s_waitcnt lgkmcnt(3)
    v_mfma_f32_16x16x32_bf16 v[12:15], a[20:23], v[28:31], v[12:15]
    v_mfma_f32_16x16x32_bf16 v[16:19], a[100:103], v[28:31], v[16:19]
    ds_read_b128 v[28:31], v11 offset:9216
    s_waitcnt lgkmcnt(3)
    v_mfma_f32_16x16x32_bf16 v[12:15], a[24:27], v[32:35], v[12:15]
    v_mfma_f32_16x16x32_bf16 v[16:19], a[104:107], v[32:35], v[16:19]
    ds_read_b128 v[32:35], v11 offset:10240
    s_waitcnt lgkmcnt(3)
    v_mfma_f32_16x16x32_bf16 v[12:15], a[28:31], v[36:39], v[12:15]
    v_mfma_f32_16x16x32_bf16 v[16:19], a[108:111], v[36:39], v[16:19]
    ds_read_b128 v[36:39], v11 offset:11264
    s_waitcnt lgkmcnt(3)
    v_mfma_f32_16x16x32_bf16 v[12:15], a[32:35], v[24:27], v[12:15]
    v_mfma_f32_16x16x32_bf16 v[16:19], a[112:115], v[24:27], v[16:19]
    ds_read_b128 v[24:27], v11 offset:12288
    s_waitcnt lgkmcnt(3)
    v_mfma_f32_16x16x32_bf16 v[12:15], a[36:39], v[28:31], v[12:15]
    v_mfma_f32_16x16x32_bf16 v[16:19], a[116:119], v[28:31], v[16:19]
    ds_read_b128 v[28:31], v11 offset:13312
    s_waitcnt lgkmcnt(3)
    v_mfma_f32_16x16x32_bf16 v[12:15], a[40:43], v[32:35], v[12:15]
    v_mfma_f32_16x16x32_bf16 v[16:19], a[120:123], v[32:35], v[16:19]
    ds_read_b128 v[32:35], v11 offset:14336
    s_waitcnt lgkmcnt(3)
    v_mfma_f32_16x16x32_bf16 v[12:15], a[44:47], v[36:39], v[12:15]
    v_mfma_f32_16x16x32_bf16 v[16:19], a[124:127], v[36:39], v[16:19]
    ds_read_b128 v[36:39], v11 offset:15360
    s_waitcnt lgkmcnt(3)
    v_mfma_f32_16x16x32_bf16 v[12:15], a[48:51], v[24:27], v[12:15]
    v_mfma_f32_16x16x32_bf16 v[16:19], a[128:131], v[24:27], v[16:19]
    ds_read_b128 v[24:27], v11 offset:16384
    s_waitcnt lgkmcnt(3)
    v_mfma_f32_16x16x32_bf16 v[12:15], a[52:55], v[28:31], v[12:15]
    v_mfma_f32_16x16x32_bf16 v[16:19], a[132:135], v[28:31], v[16:19]
    ds_read_b128 v[28:31], v11 offset:17408
    s_waitcnt lgkmcnt(3)
    v_mfma_f32_16x16x32_bf16 v[12:15], a[56:59], v[32:35], v[12:15]
    v_mfma_f32_16x16x32_bf16 v[16:19], a[136:139], v[32:35], v[16:19]
    ds_read_b128 v[32:35], v11 offset:18432
    s_waitcnt lgkmcnt(3)
    v_mfma_f32_16x16x32_bf16 v[12:15], a[60:63], v[36:39], v[12:15]
    v_mfma_f32_16x16x32_bf16 v[16:19], a[140:143], v[36:39], v[16:19]
    ds_read_b128 v[36:39], v11 offset:19456
    s_waitcnt lgkmcnt(3)
    v_mfma_f32_16x16x32_bf16 v[12:15], a[64:67], v[24:27], v[12:15]
    v_mfma_f32_16x16x32_bf16 v[16:19], a[144:147], v[24:27], v[16:19]
    s_waitcnt lgkmcnt(2)
    v_mfma_f32_16x16x32_bf16 v[12:15], a[68:71], v[28:31], v[12:15]
    v_mfma_f32_16x16x32_bf16 v[16:19], a[148:151], v[28:31], v[16:19]
    s_waitcnt lgkmcnt(1)
    v_mfma_f32_16x16x32_bf16 v[12:15], a[72:75], v[32:35], v[12:15]
    v_mfma_f32_16x16x32_bf16 v[16:19], a[152:155], v[32:35], v[16:19]
    s_waitcnt lgkmcnt(0)
    v_mfma_f32_16x16x32_bf16 v[12:15], a[76:79], v[36:39], v[12:15]
    v_mfma_f32_16x16x32_bf16 v[16:19], a[156:159], v[36:39], v[16:19]
    v_add_f32 v60, 0x3727c5ac, v59
    v_rsq_f32 v60, v60
    s_nop 4
    v_fma_f32 v12, -v58, v40, v12
    v_fma_f32 v13, -v58, v41, v13
    v_fma_f32 v14, -v58, v42, v14
    v_fma_f32 v15, -v58, v43, v15
    v_fma_f32 v16, -v58, v44, v16
    v_fma_f32 v17, -v58, v45, v17
    v_fma_f32 v18, -v58, v46, v18
    v_fma_f32 v19, -v58, v47, v19
    v_mul_f32 v12, v12, v60
    v_mul_f32 v13, v13, v60
    v_mul_f32 v14, v14, v60
    v_mul_f32 v15, v15, v60
    v_mul_f32 v16, v16, v60
    v_mul_f32 v17, v17, v60
    v_mul_f32 v18, v18, v60
    v_mul_f32 v19, v19, v60
    v_mul_f32 v24, v12, v12
    v_mul_f32 v25, v13, v13
    v_mul_f32 v26, v14, v14
    v_mul_f32 v27, v15, v15
    v_mul_f32 v28, v16, v16
    v_mul_f32 v29, v17, v17
    v_mul_f32 v30, v18, v18
    v_mul_f32 v31, v19, v19
    v_mul_f32 v24, s70, v24
    v_mul_f32 v25, s70, v25
    v_mul_f32 v26, s70, v26
    v_mul_f32 v27, s70, v27
    v_mul_f32 v28, s70, v28
    v_mul_f32 v29, s70, v29
    v_mul_f32 v30, s70, v30
    v_mul_f32 v31, s70, v31
    v_add_f32 v24, s69, v24
    v_add_f32 v25, s69, v25
    v_add_f32 v26, s69, v26
    v_add_f32 v27, s69, v27
    v_add_f32 v28, s69, v28
    v_add_f32 v29, s69, v29
    v_add_f32 v30, s69, v30
    v_add_f32 v31, s69, v31
    v_mul_f32 v24, v24, v12
    v_mul_f32 v25, v25, v13
    v_mul_f32 v26, v26, v14
    v_mul_f32 v27, v27, v15
    v_mul_f32 v28, v28, v16
    v_mul_f32 v29, v29, v17
    v_mul_f32 v30, v30, v18
    v_mul_f32 v31, v31, v19
    v_exp_f32 v24, v24
    v_exp_f32 v25, v25
    v_exp_f32 v26, v26
    v_exp_f32 v27, v27
    v_exp_f32 v28, v28
    v_exp_f32 v29, v29
    v_exp_f32 v30, v30
    v_exp_f32 v31, v31
    v_add_f32 v24, 1.0, v24
    v_add_f32 v25, 1.0, v25
    v_add_f32 v26, 1.0, v26
    v_add_f32 v27, 1.0, v27
    v_add_f32 v28, 1.0, v28
    v_add_f32 v29, 1.0, v29
    v_add_f32 v30, 1.0, v30
    v_add_f32 v31, 1.0, v31
    v_rcp_f32 v24, v24
    v_rcp_f32 v25, v25
    v_rcp_f32 v26, v26
    v_rcp_f32 v27, v27
    v_rcp_f32 v28, v28
    v_rcp_f32 v29, v29
    v_rcp_f32 v30, v30
    v_rcp_f32 v31, v31
    v_mul_f32 v12, v12, v24
    v_mul_f32 v13, v13, v25
    v_mul_f32 v14, v14, v26
    v_mul_f32 v15, v15, v27
    v_mul_f32 v16, v16, v28
    v_mul_f32 v17, v17, v29
    v_mul_f32 v18, v18, v30
    v_mul_f32 v19, v19, v31
    v_cvt_pk_bf16_f32 v20, v12, v13
    v_cvt_pk_bf16_f32 v21, v14, v15
    v_cvt_pk_bf16_f32 v22, v16, v17
    v_cvt_pk_bf16_f32 v23, v18, v19
    s_add_u32 s26, s76, 0x1200000
    buffer_store_dwordx4 v[20:23], v2, s[4:7], s26 offen sc1
    s_waitcnt vmcnt(0)
    v_mov_b32 v3, s72
    v_mov_b32 v4, s89
    s_mov_b64 exec, 1
    buffer_store_dword v3, v4, s[4:7], s68 offen sc1
    s_mov_b64 exec, -1
    s_mov_b32 s62, s77
    s_cmp_lt_u32 s62, 64
    s_cbranch_scc1 M3_loop
    s_endpgm
R_M4:
    s_cmp_lg_u32 s24, 0
    s_cbranch_scc1 wst_262
    v_and_b32 v5, 3, v1
    v_lshlrev_b32 v5, 6, v5
    s_mov_b32 s100, 0
    s_nop 3
poll_263:
    buffer_load_dword v6, v5, s[16:19], 0 offen sc1
    s_waitcnt vmcnt(0)
    v_cmp_gt_u32 vcc, 32, v6
    s_nop 3
    s_cbranch_vccz polld_264
    s_cmp_lg_u32 s25, 0
    s_cbranch_scc1 polld_264
    s_add_u32 s100, s100, 1
    s_cmp_lt_u32 s100, 400000
    s_sleep 8
    s_cbranch_scc1 poll_263
    s_mov_b32 s25, 1
    s_lshl_b32 s100, s3, 16
    s_lshl_b32 s101, s62, 8
    s_or_b32 s100, s100, s101
    s_or_b32 s100, s100, 1
    v_mov_b32 v3, s100
    v_mov_b32 v4, 36
    buffer_store_dword v3, v4, s[16:19], 0 offen sc1
    s_nop 3
polld_264:
wst_262:
    s_barrier
    v_mov_b32 v5, 8
    s_mov_b32 s100, 0
    s_nop 3
poll_265:
    buffer_load_dword v6, v5, s[16:19], 0 offen sc1
    s_waitcnt vmcnt(0)
    v_cmp_gt_u32 vcc, 64, v6
    s_nop 3
    s_cbranch_vccz polld_266
    s_cmp_lg_u32 s25, 0
    s_cbranch_scc1 polld_266
    s_add_u32 s100, s100, 1
    s_cmp_lt_u32 s100, 400000
    s_sleep 8
    s_cbranch_scc1 poll_265
    s_mov_b32 s25, 1
    s_lshl_b32 s100, s3, 16
    s_lshl_b32 s101, s62, 8
    s_or_b32 s100, s100, s101
    s_or_b32 s100, s100, 2
    v_mov_b32 v3, s100
    v_mov_b32 v4, 40
    buffer_store_dword v3, v4, s[16:19], 0 offen sc1
    s_nop 3
polld_266:
    v_readfirstlane_b32 s26, v6
    s_and_b32 s88, s26, 1
    s_xor_b32 s89, s88, 1
    s_lshl_b32 s89, s89, 13
    s_xor_b32 s91, s89, 8192
    s_mov_b32 s90, 0
    s_cmp_lg_u32 s24, 0
    s_cbranch_scc1 du_267
    v_mov_b32 v5, 0
    s_mov_b32 s100, 0
    s_nop 3
poll_268:
    buffer_load_dword v6, v5, s[4:7], s91 offen sc1
    s_waitcnt vmcnt(0)
    v_cmp_gt_u32 vcc, 1, v6
    s_nop 3
    s_cbranch_vccz polld_269
    s_cmp_lg_u32 s25, 0
    s_cbranch_scc1 polld_269
    s_add_u32 s100, s100, 1
    s_cmp_lt_u32 s100, 400000
    s_sleep 20
    s_cbranch_scc1 poll_268
    s_mov_b32 s25, 1
    s_lshl_b32 s100, s3, 16
    s_lshl_b32 s101, s62, 8
    s_or_b32 s100, s100, s101
    s_or_b32 s100, s100, 5
    v_mov_b32 v3, s100
    v_mov_b32 v4, 52
    buffer_store_dword v3, v4, s[16:19], 0 offen sc1
    s_nop 3
polld_269:
du_267:
    s_barrier
    s_and_b32 s26, s24, 3
    s_and_b32 s66, s63, 1
    s_lshr_b32 s26, s63, 1
    s_lshl_b32 s65, s26, 3
    s_add_u32 s65, s65, s24
    s_mov_b32 s8, s54
    s_and_b32 s9, s55, 0xffff
    s_mov_b32 s10, 0x1e0000
    s_mov_b32 s11, 0x20000
    s_mov_b32 s12, s56
    s_and_b32 s13, s57, 0xffff
    s_mov_b32 s14, 0x280000
    s_mov_b32 s15, 0x20000
    s_lshl_b32 s67, s26, 8
    s_lshl_b32 s29, s24, 5
    v_lshrrev_b32 v3, 2, v1
    v_mul_u32_u24 v3, 288, v3
    v_and_b32 v4, 3, v1
    v_lshl_add_u32 v3, v4, 3, v3
    v_add_u32 v13, s29, v3
    s_mov_b32 s26, s24
    s_add_u32 s28, s67, 0
    s_nop 2
stg_270:
    s_min_u32 s27, s26, 71
    s_lshl_b32 s27, s27, 6
    v_add_u32 v10, s27, v1
    s_lshl_b32 s27, s27, 4
    v_mul_u32_u24 v11, 58255, v10
    v_lshrrev_b32 v11, 20, v11
    v_mul_u32_u24 v12, 18, v11
    v_sub_u32 v12, v10, v12
    v_min_u32 v12, 15, v12
    v_mul_u32_u24 v11, 1280, v11
    s_add_u32 m0, s27, 0
    v_lshl_add_u32 v11, v12, 4, v11
    s_add_u32 s26, s26, 8
    buffer_load_dwordx4 v11, s[8:11], s28 offen lds
    s_cmp_lt_u32 s26, 72
    s_nop 0
    s_cbranch_scc1 stg_270
    s_mov_b32 s26, s24
    s_add_u32 s28, s67, 327680
stg_271:
    s_min_u32 s27, s26, 71
    s_lshl_b32 s27, s27, 6
    v_add_u32 v10, s27, v1
    s_lshl_b32 s27, s27, 4
    v_mul_u32_u24 v11, 58255, v10
    v_lshrrev_b32 v11, 20, v11
    v_mul_u32_u24 v12, 18, v11
    v_sub_u32 v12, v10, v12
    v_min_u32 v12, 15, v12
    v_mul_u32_u24 v11, 1280, v11
    s_add_u32 m0, s27, 81920
    v_lshl_add_u32 v11, v12, 4, v11
    s_add_u32 s26, s26, 8
    buffer_load_dwordx4 v11, s[8:11], s28 offen lds
    s_cmp_lt_u32 s26, 72
    s_nop 0
    s_cbranch_scc1 stg_271
    s_waitcnt vmcnt(9)
    s_barrier
    v_add_u32 v14, 0, v13
    ds_read_b64_tr_b16 a[0:1], v14 offset:0
    ds_read_b64_tr_b16 a[2:3], v14 offset:4608
    ds_read_b64_tr_b16 a[4:5], v14 offset:9216
    ds_read_b64_tr_b16 a[6:7], v14 offset:13824
    ds_read_b64_tr_b16 a[8:9], v14 offset:18432
    ds_read_b64_tr_b16 a[10:11], v14 offset:23040
    ds_read_b64_tr_b16 a[12:13], v14 offset:27648
    ds_read_b64_tr_b16 a[14:15], v14 offset:32256
    ds_read_b64_tr_b16 a[16:17], v14 offset:36864
    ds_read_b64_tr_b16 a[18:19], v14 offset:41472
    ds_read_b64_tr_b16 a[20:21], v14 offset:46080
    ds_read_b64_tr_b16 a[22:23], v14 offset:50688
    ds_read_b64_tr_b16 a[24:25], v14 offset:55296
    ds_read_b64_tr_b16 a[26:27], v14 offset:59904
    ds_read_b64_tr_b16 a[28:29], v14 offset:64512
    v_add_u32 v14, 32768, v14
    ds_read_b64_tr_b16 a[30:31], v14 offset:36352
    s_waitcnt lgkmcnt(0)
    s_barrier
    s_mov_b32 s26, s24
    s_add_u32 s28, s67, 655360
stg_272:
    s_min_u32 s27, s26, 71
    s_lshl_b32 s27, s27, 6
    v_add_u32 v10, s27, v1
    s_lshl_b32 s27, s27, 4
    v_mul_u32_u24 v11, 58255, v10
    v_lshrrev_b32 v11, 20, v11
    v_mul_u32_u24 v12, 18, v11
    v_sub_u32 v12, v10, v12
    v_min_u32 v12, 15, v12
    v_mul_u32_u24 v11, 1280, v11
    s_add_u32 m0, s27, 0
    v_lshl_add_u32 v11, v12, 4, v11
    s_add_u32 s26, s26, 8
    buffer_load_dwordx4 v11, s[8:11], s28 offen lds
    s_cmp_lt_u32 s26, 72
    s_nop 0
    s_cbranch_scc1 stg_272
    s_waitcnt vmcnt(9)
    s_barrier
    v_add_u32 v14, 81920, v13
    ds_read_b64_tr_b16 a[32:33], v14 offset:0
    ds_read_b64_tr_b16 a[34:35], v14 offset:4608
    ds_read_b64_tr_b16 a[36:37], v14 offset:9216
    ds_read_b64_tr_b16 a[38:39], v14 offset:13824
    ds_read_b64_tr_b16 a[40:41], v14 offset:18432
    ds_read_b64_tr_b16 a[42:43], v14 offset:23040
    ds_read_b64_tr_b16 a[44:45], v14 offset:27648
    ds_read_b64_tr_b16 a[46:47], v14 offset:32256
    ds_read_b64_tr_b16 a[48:49], v14 offset:36864
    ds_read_b64_tr_b16 a[50:51], v14 offset:41472
    ds_read_b64_tr_b16 a[52:53], v14 offset:46080
    ds_read_b64_tr_b16 a[54:55], v14 offset:50688
    ds_read_b64_tr_b16 a[56:57], v14 offset:55296
    ds_read_b64_tr_b16 a[58:59], v14 offset:59904
    ds_read_b64_tr_b16 a[60:61], v14 offset:64512
    v_add_u32 v14, 32768, v14
    ds_read_b64_tr_b16 a[62:63], v14 offset:36352
    s_waitcnt lgkmcnt(0)
    s_barrier
    s_mov_b32 s26, s24
    s_add_u32 s28, s67, 983040
stg_273:
    s_min_u32 s27, s26, 71
    s_lshl_b32 s27, s27, 6
    v_add_u32 v10, s27, v1
    s_lshl_b32 s27, s27, 4
    v_mul_u32_u24 v11, 58255, v10
    v_lshrrev_b32 v11, 20, v11
    v_mul_u32_u24 v12, 18, v11
    v_sub_u32 v12, v10, v12
    v_min_u32 v12, 15, v12
    v_mul_u32_u24 v11, 1280, v11
    s_add_u32 m0, s27, 81920
    v_lshl_add_u32 v11, v12, 4, v11
    s_add_u32 s26, s26, 8
    buffer_load_dwordx4 v11, s[8:11], s28 offen lds
    s_cmp_lt_u32 s26, 72
    s_nop 0
    s_cbranch_scc1 stg_273
    s_waitcnt vmcnt(9)
    s_barrier
    v_add_u32 v14, 0, v13
    ds_read_b64_tr_b16 a[64:65], v14 offset:0
    ds_read_b64_tr_b16 a[66:67], v14 offset:4608
    ds_read_b64_tr_b16 a[68:69], v14 offset:9216
    ds_read_b64_tr_b16 a[70:71], v14 offset:13824
    ds_read_b64_tr_b16 a[72:73], v14 offset:18432
    ds_read_b64_tr_b16 a[74:75], v14 offset:23040
    ds_read_b64_tr_b16 a[76:77], v14 offset:27648
    ds_read_b64_tr_b16 a[78:79], v14 offset:32256
    ds_read_b64_tr_b16 a[80:81], v14 offset:36864
    ds_read_b64_tr_b16 a[82:83], v14 offset:41472
    ds_read_b64_tr_b16 a[84:85], v14 offset:46080
    ds_read_b64_tr_b16 a[86:87], v14 offset:50688
    ds_read_b64_tr_b16 a[88:89], v14 offset:55296
    ds_read_b64_tr_b16 a[90:91], v14 offset:59904
    ds_read_b64_tr_b16 a[92:93], v14 offset:64512
    v_add_u32 v14, 32768, v14
    ds_read_b64_tr_b16 a[94:95], v14 offset:36352
    s_waitcnt lgkmcnt(0)
    s_barrier
    s_mov_b32 s26, s24
    s_add_u32 s28, s67, 1310720
stg_274:
    s_min_u32 s27, s26, 71
    s_lshl_b32 s27, s27, 6
    v_add_u32 v10, s27, v1
    s_lshl_b32 s27, s27, 4
    v_mul_u32_u24 v11, 58255, v10
    v_lshrrev_b32 v11, 20, v11
    v_mul_u32_u24 v12, 18, v11
    v_sub_u32 v12, v10, v12
    v_min_u32 v12, 15, v12
    v_mul_u32_u24 v11, 1280, v11
    s_add_u32 m0, s27, 0
    v_lshl_add_u32 v11, v12, 4, v11
    s_add_u32 s26, s26, 8
    buffer_load_dwordx4 v11, s[8:11], s28 offen lds
    s_cmp_lt_u32 s26, 72
    s_nop 0
    s_cbranch_scc1 stg_274
    s_waitcnt vmcnt(9)
    s_barrier
    v_add_u32 v14, 81920, v13
    ds_read_b64_tr_b16 a[96:97], v14 offset:0
    ds_read_b64_tr_b16 a[98:99], v14 offset:4608
    ds_read_b64_tr_b16 a[100:101], v14 offset:9216
    ds_read_b64_tr_b16 a[102:103], v14 offset:13824
    ds_read_b64_tr_b16 a[104:105], v14 offset:18432
    ds_read_b64_tr_b16 a[106:107], v14 offset:23040
    ds_read_b64_tr_b16 a[108:109], v14 offset:27648
    ds_read_b64_tr_b16 a[110:111], v14 offset:32256
    ds_read_b64_tr_b16 a[112:113], v14 offset:36864
    ds_read_b64_tr_b16 a[114:115], v14 offset:41472
    ds_read_b64_tr_b16 a[116:117], v14 offset:46080
    ds_read_b64_tr_b16 a[118:119], v14 offset:50688
    ds_read_b64_tr_b16 a[120:121], v14 offset:55296
    ds_read_b64_tr_b16 a[122:123], v14 offset:59904
    ds_read_b64_tr_b16 a[124:125], v14 offset:64512
    v_add_u32 v14, 32768, v14
    ds_read_b64_tr_b16 a[126:127], v14 offset:36352
    s_waitcnt lgkmcnt(0)
    s_barrier
    s_mov_b32 s26, s24
    s_add_u32 s28, s67, 1638400
stg_275:
    s_min_u32 s27, s26, 71
    s_lshl_b32 s27, s27, 6
    v_add_u32 v10, s27, v1
    s_lshl_b32 s27, s27, 4
    v_mul_u32_u24 v11, 58255, v10
    v_lshrrev_b32 v11, 20, v11
    v_mul_u32_u24 v12, 18, v11
    v_sub_u32 v12, v10, v12
    v_min_u32 v12, 15, v12
    v_mul_u32_u24 v11, 1280, v11
    s_add_u32 m0, s27, 81920
    v_lshl_add_u32 v11, v12, 4, v11
    s_add_u32 s26, s26, 8
    buffer_load_dwordx4 v11, s[8:11], s28 offen lds
    s_cmp_lt_u32 s26, 72
    s_nop 0
    s_cbranch_scc1 stg_275
    s_waitcnt vmcnt(9)
    s_barrier
    v_add_u32 v14, 0, v13
    ds_read_b64_tr_b16 a[128:129], v14 offset:0
    ds_read_b64_tr_b16 a[130:131], v14 offset:4608
    ds_read_b64_tr_b16 a[132:133], v14 offset:9216
    ds_read_b64_tr_b16 a[134:135], v14 offset:13824
    ds_read_b64_tr_b16 a[136:137], v14 offset:18432
    ds_read_b64_tr_b16 a[138:139], v14 offset:23040
    ds_read_b64_tr_b16 a[140:141], v14 offset:27648
    ds_read_b64_tr_b16 a[142:143], v14 offset:32256
    ds_read_b64_tr_b16 a[144:145], v14 offset:36864
    ds_read_b64_tr_b16 a[146:147], v14 offset:41472
    ds_read_b64_tr_b16 a[148:149], v14 offset:46080
    ds_read_b64_tr_b16 a[150:151], v14 offset:50688
    ds_read_b64_tr_b16 a[152:153], v14 offset:55296
    ds_read_b64_tr_b16 a[154:155], v14 offset:59904
    ds_read_b64_tr_b16 a[156:157], v14 offset:64512
    v_add_u32 v14, 32768, v14
    ds_read_b64_tr_b16 a[158:159], v14 offset:36352
    s_waitcnt lgkmcnt(0)
    s_barrier
    s_waitcnt vmcnt(0)
    s_barrier
    v_add_u32 v14, 81920, v13
    ds_read_b64_tr_b16 v[64:65], v14 offset:0
    ds_read_b64_tr_b16 v[66:67], v14 offset:4608
    ds_read_b64_tr_b16 v[68:69], v14 offset:9216
    ds_read_b64_tr_b16 v[70:71], v14 offset:13824
    ds_read_b64_tr_b16 v[72:73], v14 offset:18432
    ds_read_b64_tr_b16 v[74:75], v14 offset:23040
    ds_read_b64_tr_b16 v[76:77], v14 offset:27648
    ds_read_b64_tr_b16 v[78:79], v14 offset:32256
    ds_read_b64_tr_b16 v[80:81], v14 offset:36864
    ds_read_b64_tr_b16 v[82:83], v14 offset:41472
    ds_read_b64_tr_b16 v[84:85], v14 offset:46080
    ds_read_b64_tr_b16 v[86:87], v14 offset:50688
    ds_read_b64_tr_b16 v[88:89], v14 offset:55296
    ds_read_b64_tr_b16 v[90:91], v14 offset:59904
    ds_read_b64_tr_b16 v[92:93], v14 offset:64512
    v_add_u32 v14, 32768, v14
    ds_read_b64_tr_b16 v[94:95], v14 offset:36352
    s_waitcnt lgkmcnt(0)
    s_barrier
    v_min_u32 v3, 47, v1
    v_lshrrev_b32 v4, 2, v3
    v_and_b32 v3, 3, v3
    s_lshl_b32 s26, s66, 2
    v_add_u32 v3, s26, v3
    v_lshlrev_b32 v4, 7, v4
    v_lshl_add_u32 v3, v3, 2, v4
    v_add_u32 v9, 49152, v3
    v_and_b32 v3, 15, v1
    v_lshrrev_b32 v4, 4, v1
    s_and_b32 s26, s65, 1
    s_lshl_b32 s26, s26, 3
    v_add_u32 v10, s26, v2
    v_mul_u32_u24 v5, 1280, v3
    v_lshl_add_u32 v48, v4, 3, v5
    s_mov_b32 s69, 0xc0135761
    s_mov_b32 s70, 0xbdd2d3e8
    s_mov_b32 s71, 0
    s_mov_b32 s75, 0
    s_cmp_lg_u32 s24, 0
    s_cbranch_scc1 wst_276
    v_and_b32 v5, 3, v1
    v_lshlrev_b32 v5, 6, v5
    s_mov_b32 s100, 0
    s_nop 3
poll_277:
    buffer_load_dword v6, v5, s[16:19], 0 offen sc1
    s_waitcnt vmcnt(0)
    v_cmp_gt_u32 vcc, 32, v6
    s_nop 3
    s_cbranch_vccz polld_278
    s_cmp_lg_u32 s25, 0
    s_cbranch_scc1 polld_278
    s_add_u32 s100, s100, 1
    s_cmp_lt_u32 s100, 400000
    s_sleep 8
    s_cbranch_scc1 poll_277
    s_mov_b32 s25, 1
    s_lshl_b32 s100, s3, 16
    s_lshl_b32 s101, s62, 8
    s_or_b32 s100, s100, s101
    s_or_b32 s100, s100, 1
    v_mov_b32 v3, s100
    v_mov_b32 v4, 36
    buffer_store_dword v3, v4, s[16:19], 0 offen sc1
    s_nop 3
polld_278:
wst_276:
    s_barrier
    s_mul_i32 s62, s87, 45
M4_loop:
    s_add_u32 s72, s62, 1
    s_cmp_ge_u32 s62, 44
    s_cselect_b32 s77, 2, 1
    s_add_u32 s77, s77, s62
    s_cmp_lg_u32 s75, 0
    s_cbranch_scc1 mh_279
    s_cmp_lg_u32 s24, 0
    s_cbranch_scc1 p1_280
    s_mov_b32 s30, s62
    s_and_b32 s26, s30, 1
    s_cmp_lt_u32 s30, 44
    s_cselect_b32 s26, 0, s26
    s_lshl_b32 s26, s26, 11
    v_add_u32 v5, s26, v9
    s_add_u32 s30, s30, 1
    s_mov_b32 s100, 0
    s_nop 2
poll_281:
    buffer_load_dword v6, v5, s[4:7], s89 offen sc1
    s_waitcnt vmcnt(0)
    v_cmp_gt_u32 vcc, s30, v6
    s_nop 3
    s_cbranch_vccz polld_282
    s_cmp_lg_u32 s25, 0
    s_cbranch_scc1 polld_282
    s_cmp_ge_u32 s62, 58
    s_cbranch_scc1 lz_283
    s_sleep 24
lz_283:
    s_add_u32 s100, s100, 1
    s_cmp_lt_u32 s100, 400000
    s_sleep 3
    s_cbranch_scc1 poll_281
    s_mov_b32 s25, 1
    s_lshl_b32 s100, s3, 16
    s_lshl_b32 s101, s62, 8
    s_or_b32 s100, s100, s101
    s_or_b32 s100, s100, 28
    v_mov_b32 v3, s100
    v_mov_b32 v4, 48
    buffer_store_dword v3, v4, s[16:19], 0 offen sc1
    s_nop 3
polld_282:
p1_280:
    s_barrier
    s_lshl_b32 s31, s62, 1
    s_add_u32 s31, s31, s66
    s_mul_i32 s73, s31, 49152
    s_add_u32 s73, s73, 0x1200000
    s_mul_i32 s26, s24, 6144
    s_add_u32 s27, s26, s73
    s_add_u32 s26, s26, s71
    s_add_u32 m0, s26, 0
    s_nop 0
    buffer_load_dwordx4 v2, s[4:7], s27 offen offset:0 sc1 lds
    buffer_load_dwordx4 v2, s[4:7], s27 offen offset:1024 sc1 lds
    buffer_load_dwordx4 v2, s[4:7], s27 offen offset:2048 sc1 lds
    buffer_load_dwordx4 v2, s[4:7], s27 offen offset:3072 sc1 lds
    s_add_u32 m0, s26, 4096
    s_add_u32 s27, s27, 4096
    buffer_load_dwordx4 v2, s[4:7], s27 offen offset:0 sc1 lds
    buffer_load_dwordx4 v2, s[4:7], s27 offen offset:1024 sc1 lds
mh_279:
    s_lshl_b32 s76, s62, 1
    s_add_u32 s76, s76, s66
    v_add_u32 v11, s71, v2
    s_cmp_lg_u32 s24, 0
    s_nop 2
    s_cbranch_scc1 lf_284
    s_mov_b32 s30, s77
    s_and_b32 s26, s30, 1
    s_cmp_lt_u32 s30, 44
    s_cselect_b32 s26, 0, s26
    s_lshl_b32 s26, s26, 11
    v_add_u32 v5, s26, v9
    s_add_u32 s30, s30, 1
    buffer_load_dword v63, v5, s[4:7], s89 offen sc1
    s_waitcnt vmcnt(0)
    v_cmp_gt_u32 vcc, s30, v63
    s_cmp_eq_u64 vcc, 0
    s_cselect_b32 s26, 1, 0
    s_cmp_lt_u32 s77, 64
    s_cselect_b32 s26, s26, 0
    s_lshr_b32 s27, s71, 13
    s_add_u32 s27, s27, 98304
    s_andn2_b32 s27, s27, 3
    v_mov_b32 v3, s27
    v_mov_b32 v4, s26
    ds_write_b32 v3, v4
    s_nop 3
lf_284:
    s_waitcnt vmcnt(0) lgkmcnt(0)
    s_barrier
    s_lshr_b32 s27, s71, 13
    s_add_u32 s27, s27, 98304
    s_andn2_b32 s27, s27, 3
    v_mov_b32 v3, s27
    ds_read_b32 v63, v3
    s_mul_i32 s26, s76, 20
    s_lshr_b32 s27, s65, 1
    s_add_u32 s26, s26, s27
    s_lshl_b32 s26, s26, 10
    s_add_u32 s27, s26, 0x900000
    buffer_load_dwordx2 v[16:17], v10, s[4:7], s27 offen sc1
    s_add_u32 s27, s26, 0xf00000
    buffer_load_dwordx2 v[18:19], v10, s[4:7], s27 offen sc1
    s_waitcnt lgkmcnt(0)
    v_readfirstlane_b32 s75, v63
    s_xor_b32 s71, s71, 49152
    s_cmp_eq_u32 s75, 0
    s_nop 1
    s_cbranch_scc1 np_285
    s_lshl_b32 s31, s77, 1
    s_add_u32 s31, s31, s66
    s_mul_i32 s73, s31, 49152
    s_add_u32 s73, s73, 0x1200000
    s_mul_i32 s26, s24, 6144
    s_add_u32 s27, s26, s73
    s_add_u32 s26, s26, s71
    s_add_u32 m0, s26, 0
    s_nop 0
    buffer_load_dwordx4 v2, s[4:7], s27 offen offset:0 sc1 lds
    buffer_load_dwordx4 v2, s[4:7], s27 offen offset:1024 sc1 lds
    buffer_load_dwordx4 v2, s[4:7], s27 offen offset:2048 sc1 lds
    buffer_load_dwordx4 v2, s[4:7], s27 offen offset:3072 sc1 lds
    s_add_u32 m0, s26, 4096
    s_add_u32 s27, s27, 4096
    buffer_load_dwordx4 v2, s[4:7], s27 offen offset:0 sc1 lds
    buffer_load_dwordx4 v2, s[4:7], s27 offen offset:1024 sc1 lds
np_285:
    ds_read_b128 v[24:27], v11 offset:0
    ds_read_b128 v[28:31], v11 offset:1024
    ds_read_b128 v[32:35], v11 offset:2048
    ds_read_b128 v[36:39], v11 offset:3072
    ds_read_b128 v[40:43], v11 offset:4096
    ds_read_b128 v[44:47], v11 offset:5120
    s_waitcnt lgkmcnt(5)
    v_mfma_f32_16x16x32_bf16 v[12:15], a[0:3], v[24:27], 0
    ds_read_b128 v[24:27], v11 offset:6144
    s_waitcnt lgkmcnt(5)
    v_mfma_f32_16x16x32_bf16 v[12:15], a[4:7], v[28:31], v[12:15]
    ds_read_b128 v[28:31], v11 offset:7168
    s_waitcnt lgkmcnt(5)
    v_mfma_f32_16x16x32_bf16 v[12:15], a[8:11], v[32:35], v[12:15]
    ds_read_b128 v[32:35], v11 offset:8192
    s_waitcnt lgkmcnt(5)
    v_mfma_f32_16x16x32_bf16 v[12:15], a[12:15], v[36:39], v[12:15]
    ds_read_b128 v[36:39], v11 offset:9216
    s_waitcnt lgkmcnt(5)
    v_mfma_f32_16x16x32_bf16 v[12:15], a[16:19], v[40:43], v[12:15]
    ds_read_b128 v[40:43], v11 offset:10240
    s_waitcnt lgkmcnt(5)
    v_mfma_f32_16x16x32_bf16 v[12:15], a[20:23], v[44:47], v[12:15]
    ds_read_b128 v[44:47], v11 offset:11264
    s_waitcnt lgkmcnt(5)
    v_mfma_f32_16x16x32_bf16 v[12:15], a[24:27], v[24:27], v[12:15]
    ds_read_b128 v[24:27], v11 offset:12288
    s_waitcnt lgkmcnt(5)
    v_mfma_f32_16x16x32_bf16 v[12:15], a[28:31], v[28:31], v[12:15]
    ds_read_b128 v[28:31], v11 offset:13312
    s_waitcnt lgkmcnt(5)
    v_mfma_f32_16x16x32_bf16 v[12:15], a[32:35], v[32:35], v[12:15]
    ds_read_b128 v[32:35], v11 offset:14336
    s_waitcnt lgkmcnt(5)
    v_mfma_f32_16x16x32_bf16 v[12:15], a[36:39], v[36:39], v[12:15]
    ds_read_b128 v[36:39], v11 offset:15360
    s_waitcnt lgkmcnt(5)
    v_mfma_f32_16x16x32_bf16 v[12:15], a[40:43], v[40:43], v[12:15]
    ds_read_b128 v[40:43], v11 offset:16384
    s_waitcnt lgkmcnt(5)
    v_mfma_f32_16x16x32_bf16 v[12:15], a[44:47], v[44:47], v[12:15]
    ds_read_b128 v[44:47], v11 offset:17408
    s_waitcnt lgkmcnt(5)
    v_mfma_f32_16x16x32_bf16 v[12:15], a[48:51], v[24:27], v[12:15]
    ds_read_b128 v[24:27], v11 offset:18432
    s_waitcnt lgkmcnt(5)
    v_mfma_f32_16x16x32_bf16 v[12:15], a[52:55], v[28:31], v[12:15]
    ds_read_b128 v[28:31], v11 offset:19456
    s_waitcnt lgkmcnt(5)
    v_mfma_f32_16x16x32_bf16 v[12:15], a[56:59], v[32:35], v[12:15]
    ds_read_b128 v[32:35], v11 offset:20480
    s_waitcnt lgkmcnt(5)
    v_mfma_f32_16x16x32_bf16 v[12:15], a[60:63], v[36:39], v[12:15]
    ds_read_b128 v[36:39], v11 offset:21504
    s_waitcnt lgkmcnt(5)
    v_mfma_f32_16x16x32_bf16 v[12:15], a[64:67], v[40:43], v[12:15]
    ds_read_b128 v[40:43], v11 offset:22528
    s_waitcnt lgkmcnt(5)
    v_mfma_f32_16x16x32_bf16 v[12:15], a[68:71], v[44:47], v[12:15]
    ds_read_b128 v[44:47], v11 offset:23552
    s_waitcnt lgkmcnt(5)
    v_mfma_f32_16x16x32_bf16 v[12:15], a[72:75], v[24:27], v[12:15]
    ds_read_b128 v[24:27], v11 offset:24576
    s_waitcnt lgkmcnt(5)
    v_mfma_f32_16x16x32_bf16 v[12:15], a[76:79], v[28:31], v[12:15]
    ds_read_b128 v[28:31], v11 offset:25600
    s_waitcnt lgkmcnt(5)
    v_mfma_f32_16x16x32_bf16 v[12:15], a[80:83], v[32:35], v[12:15]
    ds_read_b128 v[32:35], v11 offset:26624
    s_waitcnt lgkmcnt(5)
    v_mfma_f32_16x16x32_bf16 v[12:15], a[84:87], v[36:39], v[12:15]
    ds_read_b128 v[36:39], v11 offset:27648
    s_waitcnt lgkmcnt(5)
    v_mfma_f32_16x16x32_bf16 v[12:15], a[88:91], v[40:43], v[12:15]
    ds_read_b128 v[40:43], v11 offset:28672
    s_waitcnt lgkmcnt(5)
    v_mfma_f32_16x16x32_bf16 v[12:15], a[92:95], v[44:47], v[12:15]
    ds_read_b128 v[44:47], v11 offset:29696
    s_waitcnt lgkmcnt(5)
    v_mfma_f32_16x16x32_bf16 v[12:15], a[96:99], v[24:27], v[12:15]
    ds_read_b128 v[24:27], v11 offset:30720
    s_waitcnt lgkmcnt(5)
    v_mfma_f32_16x16x32_bf16 v[12:15], a[100:103], v[28:31], v[12:15]
    ds_read_b128 v[28:31], v11 offset:31744
    s_waitcnt lgkmcnt(5)
    v_mfma_f32_16x16x32_bf16 v[12:15], a[104:107], v[32:35], v[12:15]
    ds_read_b128 v[32:35], v11 offset:32768
    s_waitcnt lgkmcnt(5)
    v_mfma_f32_16x16x32_bf16 v[12:15], a[108:111], v[36:39], v[12:15]
    ds_read_b128 v[36:39], v11 offset:33792
    s_waitcnt lgkmcnt(5)
    v_mfma_f32_16x16x32_bf16 v[12:15], a[112:115], v[40:43], v[12:15]
    ds_read_b128 v[40:43], v11 offset:34816
    s_waitcnt lgkmcnt(5)
    v_mfma_f32_16x16x32_bf16 v[12:15], a[116:119], v[44:47], v[12:15]
    ds_read_b128 v[44:47], v11 offset:35840
    s_waitcnt lgkmcnt(5)
    v_mfma_f32_16x16x32_bf16 v[12:15], a[120:123], v[24:27], v[12:15]
    ds_read_b128 v[24:27], v11 offset:36864
    s_waitcnt lgkmcnt(5)
    v_mfma_f32_16x16x32_bf16 v[12:15], a[124:127], v[28:31], v[12:15]
    ds_read_b128 v[28:31], v11 offset:37888
    s_waitcnt lgkmcnt(5)
    v_mfma_f32_16x16x32_bf16 v[12:15], a[128:131], v[32:35], v[12:15]
    ds_read_b128 v[32:35], v11 offset:38912
    s_waitcnt lgkmcnt(5)
    v_mfma_f32_16x16x32_bf16 v[12:15], a[132:135], v[36:39], v[12:15]
    ds_read_b128 v[36:39], v11 offset:39936
    s_waitcnt lgkmcnt(5)
    v_mfma_f32_16x16x32_bf16 v[12:15], a[136:139], v[40:43], v[12:15]
    ds_read_b128 v[40:43], v11 offset:40960
    s_waitcnt lgkmcnt(5)
    v_mfma_f32_16x16x32_bf16 v[12:15], a[140:143], v[44:47], v[12:15]
    ds_read_b128 v[44:47], v11 offset:41984
    s_waitcnt lgkmcnt(5)
    v_mfma_f32_16x16x32_bf16 v[12:15], a[144:147], v[24:27], v[12:15]
    ds_read_b128 v[24:27], v11 offset:43008
    s_waitcnt lgkmcnt(5)
    v_mfma_f32_16x16x32_bf16 v[12:15], a[148:151], v[28:31], v[12:15]
    ds_read_b128 v[28:31], v11 offset:44032
    s_waitcnt lgkmcnt(5)
    v_mfma_f32_16x16x32_bf16 v[12:15], a[152:155], v[32:35], v[12:15]
    ds_read_b128 v[32:35], v11 offset:45056
    s_waitcnt lgkmcnt(5)
    v_mfma_f32_16x16x32_bf16 v[12:15], a[156:159], v[36:39], v[12:15]
    ds_read_b128 v[36:39], v11 offset:46080
    s_waitcnt lgkmcnt(5)
    v_mfma_f32_16x16x32_bf16 v[12:15], v[64:67], v[40:43], v[12:15]
    ds_read_b128 v[40:43], v11 offset:47104
    s_waitcnt lgkmcnt(5)
    v_mfma_f32_16x16x32_bf16 v[12:15], v[68:71], v[44:47], v[12:15]
    ds_read_b128 v[44:47], v11 offset:48128
    s_waitcnt lgkmcnt(5)
    v_mfma_f32_16x16x32_bf16 v[12:15], v[72:75], v[24:27], v[12:15]
    s_waitcnt lgkmcnt(4)
    v_mfma_f32_16x16x32_bf16 v[12:15], v[76:79], v[28:31], v[12:15]
    s_waitcnt lgkmcnt(3)
    v_mfma_f32_16x16x32_bf16 v[12:15], v[80:83], v[32:35], v[12:15]
    s_waitcnt lgkmcnt(2)
    v_mfma_f32_16x16x32_bf16 v[12:15], v[84:87], v[36:39], v[12:15]
    s_waitcnt lgkmcnt(1)
    v_mfma_f32_16x16x32_bf16 v[12:15], v[88:91], v[40:43], v[12:15]
    s_waitcnt lgkmcnt(0)
    v_mfma_f32_16x16x32_bf16 v[12:15], v[92:95], v[44:47], v[12:15]
    s_waitcnt vmcnt(0)
    v_lshlrev_b32 v24, 16, v16
    v_and_b32 v25, 0xffff0000, v16
    v_lshlrev_b32 v26, 16, v17
    v_and_b32 v27, 0xffff0000, v17
    v_lshlrev_b32 v28, 16, v18
    v_and_b32 v29, 0xffff0000, v18
    v_lshlrev_b32 v30, 16, v19
    v_and_b32 v31, 0xffff0000, v19
    v_add_f32 v24, v24, v28
    v_add_f32 v25, v25, v29
    v_add_f32 v26, v26, v30
    v_add_f32 v27, v27, v31
    v_add_f32 v12, v12, v24
    v_add_f32 v13, v13, v25
    v_add_f32 v14, v14, v26
    v_add_f32 v15, v15, v27
    v_cvt_pk_bf16_f32 v20, v12, v13
    v_cvt_pk_bf16_f32 v21, v14, v15
    s_mul_i32 s26, s76, 20480
    s_lshl_b32 s27, s65, 5
    s_add_u32 s26, s26, s27
    buffer_store_dwordx2 v[20:21], v48, s[12:15], s26 offen
    s_mov_b32 s62, s77
    s_cmp_lt_u32 s62, 64
    s_cbranch_scc1 M4_loop
    s_endpgm
L_end:
    s_endpgm
.section .rodata,"a"
.p2align 6
.amdhsa_kernel sequential_preLN__memory_aug_recurrent_mem_tr__mixer_s_mlp__prompt_kernel
  .amdhsa_next_free_vgpr 256
  .amdhsa_next_free_sgpr 102
  .amdhsa_accum_offset 96
  .amdhsa_group_segment_fixed_size 0
  .amdhsa_kernarg_size 120
  .amdhsa_user_sgpr_count 2
  .amdhsa_user_sgpr_kernarg_segment_ptr 1
  .amdhsa_system_sgpr_workgroup_id_x 1
  .amdhsa_float_denorm_mode_32 3
.end_amdhsa_kernel
```
